```python
import torch

def _softmax(x, axis=-1):
    return torch.softmax(x, dim=axis)
def _gelu(x):
    return torch.nn.functional.gelu(x, approximate="tanh")
def _silu(x):
    return torch.nn.functional.silu(x)
def _sigmoid(x):
    return torch.sigmoid(x)
def _layernorm(x, axis=-1, eps=1e-5):
    m = x.mean(dim=axis, keepdim=True)
    v = x.var(dim=axis, keepdim=True, unbiased=False)
    return (x - m) / torch.sqrt(v + eps)
def _scatter_add(tgt, idx, src, axis=0):
    return tgt.clone().index_add_(axis, idx, src)
def _segment_sum(src, seg, n):
    out = torch.zeros((n,) + src.shape[1:], dtype=src.dtype)
    return out.index_add_(0, seg, src)
def _pad(x, pw):
    flat = tuple(v for pair in reversed(pw) for v in pair)
    return torch.nn.functional.pad(x, flat)

kernel_name = 'standalone__mha_block_cached__near_ridge'

def setup_inputs():

    _w = (lambda a: (lambda t: t.to(torch.bfloat16) if t.is_floating_point() else t)(torch.as_tensor(a)))
    B, Sq, D = 8, 288, 512
    H, Sk, Dh = 32, 1024, 128
    return {
        "x": _w((lambda *s: torch.randn(*s, dtype=torch.bfloat16) * 0.8)(B, Sq, D)),
        "k_cache": _w((lambda *s: torch.randn(*s, dtype=torch.bfloat16) * 0.8)(B, H, Sk, Dh)),
        "v_cache": _w((lambda *s: torch.randn(*s, dtype=torch.bfloat16) * 0.05)(B, H, Sk, Dh)),
        "wq": _w((lambda *s: torch.randn(*s, dtype=torch.bfloat16) * 0.8)(D, H * Dh) * (D ** -0.5)),
        "wo": _w((lambda *s: torch.randn(*s, dtype=torch.bfloat16) * 0.05)(H * Dh, D) * ((H * Dh) ** -0.5)),
    }

def reference(x, k_cache, v_cache, wq, wo):
    B, Sq, D = x.shape
    H, Dh = 32, 128
    q = (lambda x, *d: x.permute(*d))((x @ wq).reshape(B, Sq, H, Dh), 0, 2, 1, 3)
    scores = torch.einsum("bhqd,bhkd->bhqk", q, k_cache) * (Dh ** -0.5)
    p = _softmax(scores, axis=-1)
    o = torch.einsum("bhqk,bhkd->bhqd", p, v_cache)
    return (lambda x, *d: x.permute(*d))(o, 0, 2, 1, 3).reshape(B, Sq, H * Dh) @ wo
```

```asm
; @launch grid=(256,1,1) block=(256,1,1) lds=163840
.amdgcn_target "amdgcn-amd-amdhsa--gfx950"
.text
.globl standalone__mha_block_cached__near_ridge_kernel
.p2align 8
.type standalone__mha_block_cached__near_ridge_kernel,@function
standalone__mha_block_cached__near_ridge_kernel:

    s_cmp_ge_u32 s2, 256
    s_cbranch_scc1 L_k1_end
    s_load_dwordx16 s[4:19], s[0:1], 0
    v_lshrrev_b32 v1, 6, v0
    v_and_b32 v0, 63, v0
    v_readfirstlane_b32 s40, v1
    s_lshr_b32 s62, s2, 3
    s_and_b32 s62, s62, 7
    s_lshl_b32 s62, s62, 2
    s_add_u32 s62, s62, s40
    s_getpc_b64 s[66:67]
L_pc0:
    s_add_u32 s66, s66, L_code0-L_pc0
    s_addc_u32 s67, s67, 0
    s_lshl_b32 s61, s62, 10
    v_and_b32 v94, 7, v0
    v_lshlrev_b32 v94, 7, v94
    v_add_u32 v94, s61, v94
    v_min_u32 v94, L_k1_end-L_code0, v94
    v_mov_b32 v95, s67
    v_add_co_u32 v94, vcc, s66, v94
    s_nop 1
    v_addc_co_u32 v95, vcc, 0, v95, vcc
    global_load_dword v92, v[94:95], off
    s_mov_b32 s101, 0
L_again:
    s_and_b32 s61, s2, 7
    s_lshr_b32 s62, s2, 3
    s_and_b32 s43, s61, 1
    s_lshl_b32 s43, s43, 2
    s_and_b32 s63, s62, 3
    s_add_u32 s43, s43, s63
    s_lshr_b32 s44, s61, 1
    s_lshl_b32 s44, s44, 3
    s_lshr_b32 s64, s62, 2
    s_add_u32 s44, s44, s64
    s_lshl_b32 s45, s63, 1
    s_add_u32 s45, s45, s64
    s_and_b32 s45, s45, 3
    s_and_b32 s41, s40, 1
    s_lshr_b32 s42, s40, 1
    v_lshrrev_b32 v2, 3, v0
    v_lshrrev_b32 v3, 4, v0
    v_and_b32 v4, 7, v0
    v_xor_b32 v4, v4, v3
    v_lshlrev_b32 v4, 4, v4
    v_lshl_add_u32 v4, v2, 10, v4
    v_xor_b32 v5, 64, v4
    s_mul_i32 s61, s42, 147456
    s_lshl_b32 s62, s41, 16
    s_add_u32 s62, s62, s61
    v_add_u32 v20, s62, v4
    s_add_u32 s62, s62, 7168
    v_add_u32 v21, s62, v5
    s_add_u32 s62, s62, 7168
    v_add_u32 v22, s62, v4
    s_add_u32 s62, s62, 7168
    v_add_u32 v23, s62, v5
    s_lshl_b32 s62, s41, 6
    v_xor_b32 v6, s62, v4
    s_lshl_b32 s62, s41, 13
    s_add_u32 s61, s61, s62
    s_add_u32 s61, s61, 131072
    v_add_u32 v24, s61, v6
    v_lshrrev_b32 v5, 5, v0
    v_lshlrev_b32 v5, 18, v5
    v_and_b32 v6, 1, v3
    v_lshl_add_u32 v5, v6, 15, v5
    v_and_b32 v7, 15, v0
    v_lshl_add_u32 v5, v7, 4, v5
    s_lshl_b32 s61, s40, 16
    v_add_u32 v25, s61, v5
    v_add_u32 v26, 7160, v25
    v_add_u32 v27, 14272, v25
    v_add_u32 v28, 21432, v25
    s_lshl_b32 s52, s40, 13
    s_lshl_b32 s53, s40, 10
    s_add_u32 s53, s53, 32768
    s_mul_i32 s60, s40, 4224
    s_add_u32 s54, s60, 36864
    s_waitcnt lgkmcnt(0)
    s_mul_i32 s61, s43, 294912
    s_add_u32 s20, s4, s61
    s_addc_u32 s21, s5, 0
    s_mov_b32 s22, 294912
    s_mov_b32 s23, 0x20000
    s_lshl_b32 s61, s44, 8
    s_add_u32 s24, s10, s61
    s_addc_u32 s25, s11, 0
    s_sub_u32 s26, 0x400000, s61
    s_mov_b32 s27, 0x20000
    s_lshl_b32 s50, s45, 19
    s_add_u32 m0, s54, 53760
    s_nop 0
    buffer_load_dwordx4 v25, s[24:27], s50 offen offset:0 lds
    buffer_load_dwordx4 v26, s[24:27], s50 offen offset:1032 lds
    buffer_load_dwordx4 v27, s[24:27], s50 offen offset:2112 lds
    buffer_load_dwordx4 v28, s[24:27], s50 offen offset:3144 lds
    s_lshl_b32 s48, s45, 7
    s_add_u32 m0, s52, 53760
    s_nop 0
    buffer_load_dwordx4 v20, s[20:23], s48 offen offset:0 lds
    buffer_load_dwordx4 v21, s[20:23], s48 offen offset:1024 lds
    buffer_load_dwordx4 v22, s[20:23], s48 offen offset:2048 lds
    buffer_load_dwordx4 v23, s[20:23], s48 offen offset:3072 lds
    s_add_u32 s49, s48, 32768
    s_add_u32 m0, s52, 57856
    s_nop 0
    buffer_load_dwordx4 v20, s[20:23], s49 offen offset:0 lds
    buffer_load_dwordx4 v21, s[20:23], s49 offen offset:1024 lds
    buffer_load_dwordx4 v22, s[20:23], s49 offen offset:2048 lds
    buffer_load_dwordx4 v23, s[20:23], s49 offen offset:3072 lds
    s_add_u32 s45, s45, 1
    s_and_b32 s45, s45, 3
    s_or_b32 s45, s45, 0
    s_add_u32 m0, s53, 53760
    s_nop 0
    buffer_load_dwordx4 v24, s[20:23], s48 offen lds
    s_lshl_b32 s61, s40, 12
    v_lshlrev_b32 v5, 4, v0
    v_add_u32 v88, s61, v5
    v_lshlrev_b32 v5, 12, v2
    v_and_b32 v6, 7, v0
    s_lshl_b32 s61, s40, 1
    v_xor_b32 v6, s61, v6
    v_lshl_add_u32 v90, v6, 4, v5
    s_mov_b32 s77, 33792
    s_lshl_b32 s61, s43, 5
    s_add_u32 s61, s61, s44
    s_lshl_b32 s61, s61, 18
    s_add_u32 s28, s6, s61
    s_addc_u32 s29, s7, 0
    s_mov_b32 s30, 0x40000
    s_mov_b32 s31, 0x20000
    s_add_u32 s32, s8, s61
    s_addc_u32 s33, s9, 0
    s_mov_b32 s34, 0x40000
    s_mov_b32 s35, 0x20000
    s_mul_i32 s61, s43, 2359296
    s_lshl_b32 s62, s44, 12
    s_add_u32 s61, s61, s62
    s_add_u32 s36, s18, s61
    s_addc_u32 s37, s19, 0
    s_sub_u32 s38, 2359296, s62
    s_mov_b32 s39, 0x20000
    s_and_b32 s91, s2, 7
    s_lshr_b32 s62, s2, 3
    s_and_b32 s89, s62, 3
    s_lshr_b32 s90, s62, 2
    s_xor_b32 s90, s90, 1
    s_lshl_b32 s61, s40, 20
    s_lshl_b32 s62, s90, 7
    s_add_u32 s61, s61, s62
    s_add_u32 s80, s12, s61
    s_addc_u32 s81, s13, 0
    s_sub_u32 s82, 0x400000, s61
    s_mov_b32 s83, 0x20000
    s_lshl_b32 s61, s2, 2
    s_add_u32 s61, s61, s40
    s_lshl_b32 s61, s61, 12
    v_min_u32 v4, 2, v0
    v_lshlrev_b32 v4, 7, v4
    v_add_u32 v93, s61, v4
    s_lshr_b32 s61, s2, 3
    s_mul_i32 s61, s61, 9984
    s_lshl_b32 s62, s40, 20
    s_add_u32 s61, s61, s62
    v_lshl_add_u32 v4, v0, 7, s61
    s_mul_i32 s61, s2, 2848
    s_add_u32 s61, s61, s62
    s_add_u32 s61, s61, 319488
    v_and_b32 v5, 1, v0
    v_lshl_add_u32 v5, v5, 7, s61
    v_cmp_gt_u32 vcc, 6, v0
    v_mov_b32 v6, 220
    v_mov_b32 v91, 768
    v_cndmask_b32 v93, v5, v4, vcc
    v_cndmask_b32 v91, v6, v91, vcc
    v_lshrrev_b32 v4, 1, v7
    v_xor_b32 v4, v4, v3
    v_lshlrev_b32 v4, 4, v4
    v_lshl_add_u32 v4, v7, 7, v4
    v_xor_b32 v5, 64, v4
    v_add_u32 v29, s52, v4
    v_add_u32 v30, s52, v5
    s_lshl_b32 s61, s42, 11
    s_add_u32 s61, s61, 32768
    v_add_u32 v31, s61, v4
    v_add_u32 v32, s61, v5
    v_lshrrev_b32 v4, 2, v0
    v_lshlrev_b32 v4, 10, v4
    v_lshrrev_b32 v5, 3, v0
    v_lshl_add_u32 v4, v5, 6, v4
    v_bfe_u32 v5, v0, 2, 1
    v_lshl_add_u32 v4, v5, 3, v4
    v_and_b32 v5, 3, v0
    v_lshl_add_u32 v4, v5, 4, v4
    s_lshl_b32 s61, s41, 7
    s_add_u32 s62, s61, 36864
    v_add_u32 v33, s62, v4
    s_sub_u32 s62, 36992, s61
    v_add_u32 v34, s62, v4
    v_add_u32 v36, 107520, v29
    v_add_u32 v37, 107520, v30
    v_add_u32 v38, 107520, v31
    v_add_u32 v39, 107520, v32
    v_add_u32 v40, 107520, v33
    v_add_u32 v41, 107520, v34
    s_lshl_b32 s61, s42, 12
    s_add_u32 s61, s61, 107520
    v_lshlrev_b32 v5, 4, v0
    v_add_u32 v95, s61, v5
    s_lshl_b32 s61, s41, 11
    v_add_u32 v94, s61, v95
    s_mov_b32 s70, 0x3e0293ee
    s_lshr_b32 s71, s2, 4
    s_mul_i32 s61, s2, 5
    s_add_u32 s71, s71, s61
    s_and_b32 s71, s71, 0
    s_lshl_b32 s71, s71, 14
    s_lshl_b32 s78, s40, 12
    s_lshl_b32 s79, s40, 8
    v_lshrrev_b32 v4, 2, v0
    v_mul_u32_u24 v4, 1056, v4
    v_and_b32 v5, 3, v0
    v_lshl_add_u32 v4, v5, 3, v4
    s_lshl_b32 s61, s41, 9
    s_add_u32 s62, s61, 16896
    v_add_u32 v12, s62, v4
    s_sub_u32 s62, 17408, s61
    v_add_u32 v13, s62, v4
    v_mul_u32_u24 v4, 1056, v7
    v_lshl_add_u32 v4, v3, 4, v4
    v_add_u32 v10, s61, v4
    s_sub_u32 s62, 512, s61
    v_add_u32 v11, s62, v4
    v_mov_b32 v14, 0
    v_mov_b32 v15, 0
    v_mov_b32 v89, 0
    s_cmp_eq_u32 s40, 0
    s_cbranch_scc1 L_stub0
    s_cmp_eq_u32 s40, 1
    s_cbranch_scc1 L_stub1
    s_cmp_eq_u32 s40, 2
    s_cbranch_scc1 L_stub2
    s_branch L_stub3
L_warm_ret:
    s_lshl_b32 s50, s45, 19
    s_add_u32 m0, s54, 107520
    s_nop 0
    buffer_load_dwordx4 v25, s[24:27], s50 offen offset:0 lds
    buffer_load_dwordx4 v26, s[24:27], s50 offen offset:1032 lds
    buffer_load_dwordx4 v27, s[24:27], s50 offen offset:2112 lds
    buffer_load_dwordx4 v28, s[24:27], s50 offen offset:3144 lds
    s_lshl_b32 s48, s45, 7
    s_add_u32 m0, s52, 107520
    s_nop 0
    buffer_load_dwordx4 v20, s[20:23], s48 offen offset:0 lds
    buffer_load_dwordx4 v21, s[20:23], s48 offen offset:1024 lds
    buffer_load_dwordx4 v22, s[20:23], s48 offen offset:2048 lds
    buffer_load_dwordx4 v23, s[20:23], s48 offen offset:3072 lds
    s_add_u32 s49, s48, 32768
    s_add_u32 m0, s52, 111616
    s_nop 0
    buffer_load_dwordx4 v20, s[20:23], s49 offen offset:0 lds
    buffer_load_dwordx4 v21, s[20:23], s49 offen offset:1024 lds
    buffer_load_dwordx4 v22, s[20:23], s49 offen offset:2048 lds
    buffer_load_dwordx4 v23, s[20:23], s49 offen offset:3072 lds
    s_add_u32 s45, s45, 1
    s_and_b32 s45, s45, 3
    s_or_b32 s45, s45, 0
    s_add_u32 m0, s53, 107520
    s_nop 0
    buffer_load_dwordx4 v24, s[20:23], s48 offen lds
    s_waitcnt vmcnt(13)
    s_barrier
    ds_read_b64_tr_b16 a[0:1], v33 offset:53760
    ds_read_b64_tr_b16 a[2:3], v33 offset:54016
    ds_read_b128 a[64:67], v29 offset:53760
    ds_read_b64_tr_b16 a[4:5], v33 offset:54272
    ds_read_b64_tr_b16 a[6:7], v33 offset:54528
    ds_read_b128 a[68:71], v30 offset:53760
    ds_read_b128 a[72:75], v29 offset:55808
    ds_read_b128 a[76:79], v30 offset:55808
    ds_read_b128 a[80:83], v29 offset:57856
    ds_read_b128 a[84:87], v30 offset:57856
    ds_read_b128 a[88:91], v29 offset:59904
    ds_read_b128 a[92:95], v30 offset:59904
    ds_read_b128 a[96:99], v31 offset:53760
    ds_read_b128 a[100:103], v32 offset:53760
    ds_read_b64_tr_b16 a[8:9], v33 offset:53768
    ds_read_b64_tr_b16 a[10:11], v33 offset:54024
    ds_read_b64_tr_b16 a[12:13], v33 offset:54280
    ds_read_b64_tr_b16 a[14:15], v33 offset:54536
    ds_read_b64_tr_b16 a[16:17], v33 offset:53824
    ds_read_b64_tr_b16 a[18:19], v33 offset:54080
    ds_read_b64_tr_b16 a[20:21], v33 offset:54336
    ds_read_b64_tr_b16 a[22:23], v33 offset:54592
    ds_read_b64_tr_b16 a[24:25], v33 offset:53832
    ds_read_b64_tr_b16 a[26:27], v33 offset:54088
    ds_read_b64_tr_b16 a[28:29], v33 offset:54344
    ds_read_b64_tr_b16 a[30:31], v33 offset:54600
    ds_read_b64_tr_b16 a[32:33], v34 offset:53760
    ds_read_b64_tr_b16 a[34:35], v34 offset:54016
    ds_read_b64_tr_b16 a[36:37], v34 offset:54272
    ds_read_b64_tr_b16 a[38:39], v34 offset:54528
    ds_read_b64_tr_b16 a[40:41], v34 offset:53768
    ds_read_b64_tr_b16 a[42:43], v34 offset:54024
    ds_read_b64_tr_b16 a[44:45], v34 offset:54280
    ds_read_b64_tr_b16 a[46:47], v34 offset:54536
    ds_read_b64_tr_b16 a[48:49], v34 offset:53824
    ds_read_b64_tr_b16 a[50:51], v34 offset:54080
    ds_read_b64_tr_b16 a[52:53], v34 offset:54336
    ds_read_b64_tr_b16 a[54:55], v34 offset:54592
    ds_read_b64_tr_b16 a[56:57], v34 offset:53832
    ds_read_b64_tr_b16 a[58:59], v34 offset:54088
    ds_read_b64_tr_b16 a[60:61], v34 offset:54344
    ds_read_b64_tr_b16 a[62:63], v34 offset:54600
    s_waitcnt lgkmcnt(15)
    s_branch L_pg0
    .p2align 12
L_stub0:
    s_branch L_stub4
L_pg0:
L_code0:
    v_mfma_f32_16x16x32_bf16 v[96:99], a[0:3], a[64:67], 0
    s_lshl_b32 s50, s45, 19
    v_mfma_f32_16x16x32_bf16 v[96:99], a[4:7], a[68:71], v[96:99]
    s_add_u32 m0, s54, 0
    v_mfma_f32_16x16x32_bf16 v[128:131], a[4:7], a[76:79], 0
    buffer_load_dwordx4 v25, s[24:27], s50 offen offset:0 lds
    v_mfma_f32_16x16x32_bf16 v[128:131], a[0:3], a[72:75], v[128:131]
    v_mfma_f32_16x16x32_bf16 v[160:163], a[0:3], a[80:83], 0
    v_mfma_f32_16x16x32_bf16 v[160:163], a[4:7], a[84:87], v[160:163]
    buffer_load_dwordx4 v26, s[24:27], s50 offen offset:1032 lds
    v_mfma_f32_16x16x32_bf16 v[192:195], a[4:7], a[92:95], 0
    v_mfma_f32_16x16x32_bf16 v[192:195], a[0:3], a[88:91], v[192:195]
    v_mfma_f32_16x16x32_bf16 v[224:227], a[0:3], a[96:99], 0
    buffer_load_dwordx4 v27, s[24:27], s50 offen offset:2112 lds
    v_mfma_f32_16x16x32_bf16 v[224:227], a[4:7], a[100:103], v[224:227]
    v_mfma_f32_16x16x32_bf16 v[100:103], a[12:15], a[68:71], 0
    v_mfma_f32_16x16x32_bf16 v[100:103], a[8:11], a[64:67], v[100:103]
    buffer_load_dwordx4 v28, s[24:27], s50 offen offset:3144 lds
    v_mfma_f32_16x16x32_bf16 v[132:135], a[8:11], a[72:75], 0
    s_lshl_b32 s48, s45, 7
    v_mfma_f32_16x16x32_bf16 v[132:135], a[12:15], a[76:79], v[132:135]
    s_add_u32 m0, s52, 0
    v_mfma_f32_16x16x32_bf16 v[164:167], a[12:15], a[84:87], 0
    buffer_load_dwordx4 v20, s[20:23], s48 offen offset:0 lds
    v_mfma_f32_16x16x32_bf16 v[164:167], a[8:11], a[80:83], v[164:167]
    v_mfma_f32_16x16x32_bf16 v[196:199], a[8:11], a[88:91], 0
    v_mfma_f32_16x16x32_bf16 v[196:199], a[12:15], a[92:95], v[196:199]
    buffer_load_dwordx4 v21, s[20:23], s48 offen offset:1024 lds
    v_mfma_f32_16x16x32_bf16 v[228:231], a[12:15], a[100:103], 0
    v_mfma_f32_16x16x32_bf16 v[228:231], a[8:11], a[96:99], v[228:231]
    v_mfma_f32_16x16x32_bf16 v[104:107], a[16:19], a[64:67], 0
    buffer_load_dwordx4 v22, s[20:23], s48 offen offset:2048 lds
    v_mfma_f32_16x16x32_bf16 v[104:107], a[20:23], a[68:71], v[104:107]
    v_mfma_f32_16x16x32_bf16 v[136:139], a[20:23], a[76:79], 0
    v_mfma_f32_16x16x32_bf16 v[136:139], a[16:19], a[72:75], v[136:139]
    buffer_load_dwordx4 v23, s[20:23], s48 offen offset:3072 lds
    v_mfma_f32_16x16x32_bf16 v[168:171], a[16:19], a[80:83], 0
    s_add_u32 s49, s48, 32768
    v_mfma_f32_16x16x32_bf16 v[168:171], a[20:23], a[84:87], v[168:171]
    s_add_u32 m0, s52, 4096
    v_mfma_f32_16x16x32_bf16 v[200:203], a[20:23], a[92:95], 0
    buffer_load_dwordx4 v20, s[20:23], s49 offen offset:0 lds
    v_mfma_f32_16x16x32_bf16 v[200:203], a[16:19], a[88:91], v[200:203]
    v_mfma_f32_16x16x32_bf16 v[232:235], a[16:19], a[96:99], 0
    v_mfma_f32_16x16x32_bf16 v[232:235], a[20:23], a[100:103], v[232:235]
    buffer_load_dwordx4 v21, s[20:23], s49 offen offset:1024 lds
    v_mfma_f32_16x16x32_bf16 v[108:111], a[28:31], a[68:71], 0
    v_mfma_f32_16x16x32_bf16 v[108:111], a[24:27], a[64:67], v[108:111]
    v_mfma_f32_16x16x32_bf16 v[140:143], a[24:27], a[72:75], 0
    buffer_load_dwordx4 v22, s[20:23], s49 offen offset:2048 lds
    v_mfma_f32_16x16x32_bf16 v[140:143], a[28:31], a[76:79], v[140:143]
    v_mfma_f32_16x16x32_bf16 v[172:175], a[28:31], a[84:87], 0
    v_mfma_f32_16x16x32_bf16 v[172:175], a[24:27], a[80:83], v[172:175]
    buffer_load_dwordx4 v23, s[20:23], s49 offen offset:3072 lds
    s_waitcnt vmcnt(12) lgkmcnt(0)
    s_barrier
    v_mfma_f32_16x16x32_bf16 v[204:207], a[24:27], a[88:91], 0
    s_add_u32 s45, s45, 1
    ds_read_b64_tr_b16 a[144:145], v40 offset:0
    ds_read_b64_tr_b16 a[146:147], v40 offset:256
    v_mfma_f32_16x16x32_bf16 v[204:207], a[28:31], a[92:95], v[204:207]
    s_and_b32 s45, s45, 3
    ds_read_b128 a[208:211], v36 offset:0
    v_mfma_f32_16x16x32_bf16 v[236:239], a[28:31], a[100:103], 0
    s_or_b32 s45, s45, 0
    ds_read_b64_tr_b16 a[148:149], v40 offset:512
    v_mfma_f32_16x16x32_bf16 v[236:239], a[24:27], a[96:99], v[236:239]
    s_add_u32 m0, s53, 0
    ds_read_b64_tr_b16 a[150:151], v40 offset:768
    ds_read_b128 a[212:215], v37 offset:0
    v_mfma_f32_16x16x32_bf16 v[112:115], a[32:35], a[64:67], 0
    buffer_load_dwordx4 v24, s[20:23], s48 offen lds
    v_mfma_f32_16x16x32_bf16 v[112:115], a[36:39], a[68:71], v[112:115]
    s_lshl_b32 s50, s45, 19
    ds_read_b128 a[216:219], v36 offset:2048
    ds_read_b128 a[220:223], v37 offset:2048
    v_mfma_f32_16x16x32_bf16 v[144:147], a[36:39], a[76:79], 0
    s_add_u32 m0, s54, 53760
    ds_read_b128 a[224:227], v36 offset:4096
    ds_read_b128 a[228:231], v37 offset:4096
    v_mfma_f32_16x16x32_bf16 v[144:147], a[32:35], a[72:75], v[144:147]
    buffer_load_dwordx4 v25, s[24:27], s50 offen offset:0 lds
    v_mfma_f32_16x16x32_bf16 v[176:179], a[32:35], a[80:83], 0
    ds_read_b128 a[232:235], v36 offset:6144
    ds_read_b128 a[236:239], v37 offset:6144
    v_mfma_f32_16x16x32_bf16 v[176:179], a[36:39], a[84:87], v[176:179]
    ds_read_b128 a[240:243], v38 offset:0
    ds_read_b128 a[244:247], v39 offset:0
    v_mfma_f32_16x16x32_bf16 v[208:211], a[36:39], a[92:95], 0
    ds_read_b64_tr_b16 a[152:153], v40 offset:8
    v_mfma_f32_16x16x32_bf16 v[208:211], a[32:35], a[88:91], v[208:211]
    buffer_load_dwordx4 v26, s[24:27], s50 offen offset:1032 lds
    v_mfma_f32_16x16x32_bf16 v[116:119], a[40:43], a[64:67], 0
    ds_read_b64_tr_b16 a[154:155], v40 offset:264
    ds_read_b64_tr_b16 a[156:157], v40 offset:520
    v_mfma_f32_16x16x32_bf16 v[116:119], a[44:47], a[68:71], v[116:119]
    ds_read_b64_tr_b16 a[158:159], v40 offset:776
    ds_read_b64_tr_b16 a[160:161], v40 offset:64
    v_mfma_f32_16x16x32_bf16 v[148:151], a[44:47], a[76:79], 0
    ds_read_b64_tr_b16 a[162:163], v40 offset:320
    v_mfma_f32_16x16x32_bf16 v[148:151], a[40:43], a[72:75], v[148:151]
    buffer_load_dwordx4 v27, s[24:27], s50 offen offset:2112 lds
    v_mfma_f32_16x16x32_bf16 v[180:183], a[40:43], a[80:83], 0
    ds_read_b64_tr_b16 a[164:165], v40 offset:576
    ds_read_b64_tr_b16 a[166:167], v40 offset:832
    v_mfma_f32_16x16x32_bf16 v[180:183], a[44:47], a[84:87], v[180:183]
    ds_read_b64_tr_b16 a[168:169], v40 offset:72
    ds_read_b64_tr_b16 a[170:171], v40 offset:328
    v_mfma_f32_16x16x32_bf16 v[212:215], a[44:47], a[92:95], 0
    ds_read_b64_tr_b16 a[172:173], v40 offset:584
    v_mfma_f32_16x16x32_bf16 v[212:215], a[40:43], a[88:91], v[212:215]
    buffer_load_dwordx4 v28, s[24:27], s50 offen offset:3144 lds
    v_mfma_f32_16x16x32_bf16 v[120:123], a[48:51], a[64:67], 0
    ds_read_b64_tr_b16 a[174:175], v40 offset:840
    ds_read_b64_tr_b16 a[176:177], v41 offset:0
    v_mfma_f32_16x16x32_bf16 v[120:123], a[52:55], a[68:71], v[120:123]
    s_lshl_b32 s48, s45, 7
    ds_read_b64_tr_b16 a[178:179], v41 offset:256
    ds_read_b64_tr_b16 a[180:181], v41 offset:512
    v_mfma_f32_16x16x32_bf16 v[152:155], a[52:55], a[76:79], 0
    s_add_u32 m0, s52, 53760
    ds_read_b64_tr_b16 a[182:183], v41 offset:768
    ds_read_b64_tr_b16 a[184:185], v41 offset:8
    v_mfma_f32_16x16x32_bf16 v[152:155], a[48:51], a[72:75], v[152:155]
    buffer_load_dwordx4 v20, s[20:23], s48 offen offset:0 lds
    v_mfma_f32_16x16x32_bf16 v[184:187], a[48:51], a[80:83], 0
    ds_read_b64_tr_b16 a[186:187], v41 offset:264
    ds_read_b64_tr_b16 a[188:189], v41 offset:520
    v_mfma_f32_16x16x32_bf16 v[184:187], a[52:55], a[84:87], v[184:187]
    ds_read_b64_tr_b16 a[190:191], v41 offset:776
    ds_read_b64_tr_b16 a[192:193], v41 offset:64
    v_mfma_f32_16x16x32_bf16 v[216:219], a[52:55], a[92:95], 0
    ds_read_b64_tr_b16 a[194:195], v41 offset:320
    v_mfma_f32_16x16x32_bf16 v[216:219], a[48:51], a[88:91], v[216:219]
    buffer_load_dwordx4 v21, s[20:23], s48 offen offset:1024 lds
    v_mfma_f32_16x16x32_bf16 v[124:127], a[56:59], a[64:67], 0
    ds_read_b64_tr_b16 a[196:197], v41 offset:576
    ds_read_b64_tr_b16 a[198:199], v41 offset:832
    v_mfma_f32_16x16x32_bf16 v[124:127], a[60:63], a[68:71], v[124:127]
    ds_read_b64_tr_b16 a[200:201], v41 offset:72
    ds_read_b64_tr_b16 a[202:203], v41 offset:328
    v_mfma_f32_16x16x32_bf16 v[156:159], a[60:63], a[76:79], 0
    ds_read_b64_tr_b16 a[204:205], v41 offset:584
    v_mfma_f32_16x16x32_bf16 v[156:159], a[56:59], a[72:75], v[156:159]
    buffer_load_dwordx4 v22, s[20:23], s48 offen offset:2048 lds
    v_mfma_f32_16x16x32_bf16 v[188:191], a[56:59], a[80:83], 0
    ds_read_b64_tr_b16 a[206:207], v41 offset:840
    v_mfma_f32_16x16x32_bf16 v[188:191], a[60:63], a[84:87], v[188:191]
    v_mfma_f32_16x16x32_bf16 v[220:223], a[60:63], a[92:95], 0
    v_mfma_f32_16x16x32_bf16 v[220:223], a[56:59], a[88:91], v[220:223]
    s_waitcnt lgkmcnt(2)
    buffer_load_dwordx4 v23, s[20:23], s48 offen offset:3072 lds
    s_waitcnt vmcnt(8) lgkmcnt(0)
    s_barrier
    v_mfma_f32_16x16x32_bf16 v[96:99], a[144:147], a[208:211], v[96:99]
    ds_read_b64_tr_b16 a[0:1], v33 offset:0
    v_mfma_f32_16x16x32_bf16 v[96:99], a[148:151], a[212:215], v[96:99]
    s_add_u32 s49, s48, 32768
    ds_read_b64_tr_b16 a[2:3], v33 offset:256
    v_mfma_f32_16x16x32_bf16 v[128:131], a[148:151], a[220:223], v[128:131]
    s_add_u32 m0, s52, 57856
    v_mfma_f32_16x16x32_bf16 v[128:131], a[144:147], a[216:219], v[128:131]
    buffer_load_dwordx4 v20, s[20:23], s49 offen offset:0 lds
    v_mfma_f32_16x16x32_bf16 v[160:163], a[144:147], a[224:227], v[160:163]
    ds_read_b128 a[64:67], v29 offset:0
    ds_read_b64_tr_b16 a[4:5], v33 offset:512
    v_mfma_f32_16x16x32_bf16 v[160:163], a[148:151], a[228:231], v[160:163]
    v_mfma_f32_16x16x32_bf16 v[192:195], a[148:151], a[236:239], v[192:195]
    ds_read_b64_tr_b16 a[6:7], v33 offset:768
    v_mfma_f32_16x16x32_bf16 v[192:195], a[144:147], a[232:235], v[192:195]
    buffer_load_dwordx4 v21, s[20:23], s49 offen offset:1024 lds
    v_mfma_f32_16x16x32_bf16 v[224:227], a[144:147], a[240:243], v[224:227]
    ds_read_b128 a[68:71], v30 offset:0
    v_mfma_f32_16x16x32_bf16 v[224:227], a[148:151], a[244:247], v[224:227]
    ds_read_b128 a[72:75], v29 offset:2048
    v_mfma_f32_16x16x32_bf16 v[100:103], a[156:159], a[212:215], v[100:103]
    ds_read_b128 a[76:79], v30 offset:2048
    v_mfma_f32_16x16x32_bf16 v[100:103], a[152:155], a[208:211], v[100:103]
    buffer_load_dwordx4 v22, s[20:23], s49 offen offset:2048 lds
    v_mfma_f32_16x16x32_bf16 v[132:135], a[152:155], a[216:219], v[132:135]
    ds_read_b128 a[80:83], v29 offset:4096
    v_mfma_f32_16x16x32_bf16 v[132:135], a[156:159], a[220:223], v[132:135]
    ds_read_b128 a[84:87], v30 offset:4096
    v_mfma_f32_16x16x32_bf16 v[164:167], a[156:159], a[228:231], v[164:167]
    v_mfma_f32_16x16x32_bf16 v[164:167], a[152:155], a[224:227], v[164:167]
    buffer_load_dwordx4 v23, s[20:23], s49 offen offset:3072 lds
    v_mfma_f32_16x16x32_bf16 v[196:199], a[152:155], a[232:235], v[196:199]
    s_add_u32 s45, s45, 1
    ds_read_b128 a[88:91], v29 offset:6144
    ds_read_b128 a[92:95], v30 offset:6144
    v_mfma_f32_16x16x32_bf16 v[196:199], a[156:159], a[236:239], v[196:199]
    s_and_b32 s45, s45, 3
    v_mfma_f32_16x16x32_bf16 v[228:231], a[156:159], a[244:247], v[228:231]
    s_or_b32 s45, s45, 4
    ds_read_b128 a[96:99], v31 offset:0
    v_mfma_f32_16x16x32_bf16 v[228:231], a[152:155], a[240:243], v[228:231]
    s_add_u32 m0, s53, 53760
    ds_read_b128 a[100:103], v32 offset:0
    v_mfma_f32_16x16x32_bf16 v[104:107], a[160:163], a[208:211], v[104:107]
    buffer_load_dwordx4 v24, s[20:23], s48 offen lds
    v_mfma_f32_16x16x32_bf16 v[104:107], a[164:167], a[212:215], v[104:107]
    ds_read_b64_tr_b16 a[8:9], v33 offset:8
    v_mfma_f32_16x16x32_bf16 v[136:139], a[164:167], a[220:223], v[136:139]
    s_lshl_b32 s50, s45, 19
    ds_read_b64_tr_b16 a[10:11], v33 offset:264
    v_mfma_f32_16x16x32_bf16 v[136:139], a[160:163], a[216:219], v[136:139]
    s_add_u32 m0, s54, 107520
    v_mfma_f32_16x16x32_bf16 v[168:171], a[160:163], a[224:227], v[168:171]
    buffer_load_dwordx4 v25, s[24:27], s50 offen offset:0 lds
    v_mfma_f32_16x16x32_bf16 v[168:171], a[164:167], a[228:231], v[168:171]
    ds_read_b64_tr_b16 a[12:13], v33 offset:520
    ds_read_b64_tr_b16 a[14:15], v33 offset:776
    v_mfma_f32_16x16x32_bf16 v[200:203], a[164:167], a[236:239], v[200:203]
    v_mfma_f32_16x16x32_bf16 v[200:203], a[160:163], a[232:235], v[200:203]
    ds_read_b64_tr_b16 a[16:17], v33 offset:64
    v_mfma_f32_16x16x32_bf16 v[232:235], a[160:163], a[240:243], v[232:235]
    ds_read_b64_tr_b16 a[18:19], v33 offset:320
    v_mfma_f32_16x16x32_bf16 v[232:235], a[164:167], a[244:247], v[232:235]
    buffer_load_dwordx4 v26, s[24:27], s50 offen offset:1032 lds
    v_mfma_f32_16x16x32_bf16 v[108:111], a[172:175], a[212:215], v[108:111]
    ds_read_b64_tr_b16 a[20:21], v33 offset:576
    v_mfma_f32_16x16x32_bf16 v[108:111], a[168:171], a[208:211], v[108:111]
    v_mfma_f32_16x16x32_bf16 v[140:143], a[168:171], a[216:219], v[140:143]
    ds_read_b64_tr_b16 a[22:23], v33 offset:832
    v_mfma_f32_16x16x32_bf16 v[140:143], a[172:175], a[220:223], v[140:143]
    ds_read_b64_tr_b16 a[24:25], v33 offset:72
    v_mfma_f32_16x16x32_bf16 v[172:175], a[172:175], a[228:231], v[172:175]
    buffer_load_dwordx4 v27, s[24:27], s50 offen offset:2112 lds
    v_mfma_f32_16x16x32_bf16 v[172:175], a[168:171], a[224:227], v[172:175]
    ds_read_b64_tr_b16 a[26:27], v33 offset:328
    v_mfma_f32_16x16x32_bf16 v[204:207], a[168:171], a[232:235], v[204:207]
    ds_read_b64_tr_b16 a[28:29], v33 offset:584
    v_mfma_f32_16x16x32_bf16 v[204:207], a[172:175], a[236:239], v[204:207]
    v_mfma_f32_16x16x32_bf16 v[236:239], a[172:175], a[244:247], v[236:239]
    ds_read_b64_tr_b16 a[30:31], v33 offset:840
    v_mfma_f32_16x16x32_bf16 v[236:239], a[168:171], a[240:243], v[236:239]
    buffer_load_dwordx4 v28, s[24:27], s50 offen offset:3144 lds
    v_mfma_f32_16x16x32_bf16 v[112:115], a[176:179], a[208:211], v[112:115]
    ds_read_b64_tr_b16 a[32:33], v34 offset:0
    v_mfma_f32_16x16x32_bf16 v[112:115], a[180:183], a[212:215], v[112:115]
    ds_read_b64_tr_b16 a[34:35], v34 offset:256
    v_mfma_f32_16x16x32_bf16 v[144:147], a[180:183], a[220:223], v[144:147]
    s_lshl_b32 s48, s45, 7
    ds_read_b64_tr_b16 a[36:37], v34 offset:512
    v_mfma_f32_16x16x32_bf16 v[144:147], a[176:179], a[216:219], v[144:147]
    s_add_u32 m0, s52, 107520
    v_mfma_f32_16x16x32_bf16 v[176:179], a[176:179], a[224:227], v[176:179]
    buffer_load_dwordx4 v20, s[20:23], s48 offen offset:0 lds
    v_mfma_f32_16x16x32_bf16 v[176:179], a[180:183], a[228:231], v[176:179]
    ds_read_b64_tr_b16 a[38:39], v34 offset:768
    ds_read_b64_tr_b16 a[40:41], v34 offset:8
    v_mfma_f32_16x16x32_bf16 v[208:211], a[180:183], a[236:239], v[208:211]
    v_mfma_f32_16x16x32_bf16 v[208:211], a[176:179], a[232:235], v[208:211]
    ds_read_b64_tr_b16 a[42:43], v34 offset:264
    v_mfma_f32_16x16x32_bf16 v[116:119], a[184:187], a[208:211], v[116:119]
    ds_read_b64_tr_b16 a[44:45], v34 offset:520
    v_mfma_f32_16x16x32_bf16 v[116:119], a[188:191], a[212:215], v[116:119]
    buffer_load_dwordx4 v21, s[20:23], s48 offen offset:1024 lds
    v_mfma_f32_16x16x32_bf16 v[148:151], a[188:191], a[220:223], v[148:151]
    ds_read_b64_tr_b16 a[46:47], v34 offset:776
    v_mfma_f32_16x16x32_bf16 v[148:151], a[184:187], a[216:219], v[148:151]
    ds_read_b64_tr_b16 a[48:49], v34 offset:64
    v_mfma_f32_16x16x32_bf16 v[180:183], a[184:187], a[224:227], v[180:183]
    v_mfma_f32_16x16x32_bf16 v[180:183], a[188:191], a[228:231], v[180:183]
    ds_read_b64_tr_b16 a[50:51], v34 offset:320
    v_mfma_f32_16x16x32_bf16 v[212:215], a[188:191], a[236:239], v[212:215]
    buffer_load_dwordx4 v22, s[20:23], s48 offen offset:2048 lds
    v_mfma_f32_16x16x32_bf16 v[212:215], a[184:187], a[232:235], v[212:215]
    ds_read_b64_tr_b16 a[52:53], v34 offset:576
    v_mfma_f32_16x16x32_bf16 v[120:123], a[192:195], a[208:211], v[120:123]
    ds_read_b64_tr_b16 a[54:55], v34 offset:832
    v_mfma_f32_16x16x32_bf16 v[120:123], a[196:199], a[212:215], v[120:123]
    ds_read_b64_tr_b16 a[56:57], v34 offset:72
    v_mfma_f32_16x16x32_bf16 v[152:155], a[196:199], a[220:223], v[152:155]
    v_mfma_f32_16x16x32_bf16 v[152:155], a[192:195], a[216:219], v[152:155]
    buffer_load_dwordx4 v23, s[20:23], s48 offen offset:3072 lds
    v_mfma_f32_16x16x32_bf16 v[184:187], a[192:195], a[224:227], v[184:187]
    ds_read_b64_tr_b16 a[58:59], v34 offset:328
    ds_read_b64_tr_b16 a[60:61], v34 offset:584
    v_mfma_f32_16x16x32_bf16 v[184:187], a[196:199], a[228:231], v[184:187]
    v_mfma_f32_16x16x32_bf16 v[216:219], a[196:199], a[236:239], v[216:219]
    s_add_u32 s49, s48, 32768
    ds_read_b64_tr_b16 a[62:63], v34 offset:840
    v_mfma_f32_16x16x32_bf16 v[216:219], a[192:195], a[232:235], v[216:219]
    s_add_u32 m0, s52, 111616
    v_mfma_f32_16x16x32_bf16 v[124:127], a[200:203], a[208:211], v[124:127]
    buffer_load_dwordx4 v20, s[20:23], s49 offen offset:0 lds
    v_mfma_f32_16x16x32_bf16 v[124:127], a[204:207], a[212:215], v[124:127]
    v_mfma_f32_16x16x32_bf16 v[156:159], a[204:207], a[220:223], v[156:159]
    v_mfma_f32_16x16x32_bf16 v[156:159], a[200:203], a[216:219], v[156:159]
    v_mfma_f32_16x16x32_bf16 v[188:191], a[200:203], a[224:227], v[188:191]
    v_mfma_f32_16x16x32_bf16 v[188:191], a[204:207], a[228:231], v[188:191]
    buffer_load_dwordx4 v21, s[20:23], s49 offen offset:1024 lds
    v_mfma_f32_16x16x32_bf16 v[220:223], a[204:207], a[236:239], v[220:223]
    v_mfma_f32_16x16x32_bf16 v[220:223], a[200:203], a[232:235], v[220:223]
    s_waitcnt vmcnt(10) lgkmcnt(0)
    v_mfma_f32_16x16x32_bf16 v[96:99], a[0:3], a[64:67], v[96:99]
    s_barrier
    ds_read_b64_tr_b16 a[144:145], v33 offset:53760
    v_mfma_f32_16x16x32_bf16 v[96:99], a[4:7], a[68:71], v[96:99]
    ds_read_b64_tr_b16 a[146:147], v33 offset:54016
    v_mfma_f32_16x16x32_bf16 v[128:131], a[4:7], a[76:79], v[128:131]
    buffer_load_dwordx4 v22, s[20:23], s49 offen offset:2048 lds
    v_mfma_f32_16x16x32_bf16 v[128:131], a[0:3], a[72:75], v[128:131]
    ds_read_b128 a[208:211], v29 offset:53760
    v_mfma_f32_16x16x32_bf16 v[160:163], a[0:3], a[80:83], v[160:163]
    ds_read_b64_tr_b16 a[148:149], v33 offset:54272
    v_mfma_f32_16x16x32_bf16 v[160:163], a[4:7], a[84:87], v[160:163]
    v_mfma_f32_16x16x32_bf16 v[192:195], a[4:7], a[92:95], v[192:195]
    ds_read_b64_tr_b16 a[150:151], v33 offset:54528
    v_bfe_u32 v3, v0, 2, 2
    v_mfma_f32_16x16x32_bf16 v[192:195], a[0:3], a[88:91], v[192:195]
    buffer_load_dwordx4 v23, s[20:23], s49 offen offset:3072 lds
    v_mfma_f32_16x16x32_bf16 v[224:227], a[0:3], a[96:99], v[224:227]
    s_add_u32 s45, s45, 1
    ds_read_b128 a[212:215], v30 offset:53760
    v_mul_u32_u24 v3, 1056, v3
    v_mfma_f32_16x16x32_bf16 v[224:227], a[4:7], a[100:103], v[224:227]
    s_and_b32 s45, s45, 3
    ds_read_b128 a[216:219], v29 offset:55808
    v_lshrrev_b32 v4, 4, v0
    v_mfma_f32_16x16x32_bf16 v[100:103], a[12:15], a[68:71], v[100:103]
    s_or_b32 s45, s45, 4
    ds_read_b128 a[220:223], v30 offset:55808
    v_lshl_add_u32 v3, v4, 7, v3
    v_mfma_f32_16x16x32_bf16 v[100:103], a[8:11], a[64:67], v[100:103]
    s_add_u32 m0, s53, 107520
    v_and_b32 v4, 3, v0
    v_lshl_add_u32 v3, v4, 3, v3
    v_mfma_f32_16x16x32_bf16 v[132:135], a[8:11], a[72:75], v[132:135]
    buffer_load_dwordx4 v24, s[20:23], s48 offen lds
    v_mfma_f32_16x16x32_bf16 v[132:135], a[12:15], a[76:79], v[132:135]
    ds_read_b128 a[224:227], v29 offset:57856
    ds_read_b128 a[228:231], v30 offset:57856
    v_mfma_f32_16x16x32_bf16 v[164:167], a[12:15], a[84:87], v[164:167]
    v_add_u32 v1, s60, v3
    v_add_u32 v5, 67584, v1
    v_mfma_f32_16x16x32_bf16 v[164:167], a[8:11], a[80:83], v[164:167]
    s_lshl_b32 s50, s45, 19
    ds_read_b128 a[232:235], v29 offset:59904
    v_lshlrev_b32 v2, 4, v0
    v_mfma_f32_16x16x32_bf16 v[196:199], a[8:11], a[88:91], v[196:199]
    s_add_u32 m0, s54, 0
    ds_read_b128 a[236:239], v30 offset:59904
    v_lshl_add_u32 v3, v0, 4, s78
    v_mfma_f32_16x16x32_bf16 v[196:199], a[12:15], a[92:95], v[196:199]
    buffer_load_dwordx4 v25, s[24:27], s50 offen offset:0 lds
    v_mfma_f32_16x16x32_bf16 v[228:231], a[12:15], a[100:103], v[228:231]
    ds_read_b128 a[240:243], v31 offset:53760
    v_xor_b32 v4, 4096, v3
    v_mfma_f32_16x16x32_bf16 v[228:231], a[8:11], a[96:99], v[228:231]
    ds_read_b128 a[244:247], v32 offset:53760
    v_add_u32 v3, 84480, v3
    v_mfma_f32_16x16x32_bf16 v[104:107], a[16:19], a[64:67], v[104:107]
    v_add_u32 v4, 84480, v4
    v_lshl_add_u32 v6, v0, 2, s79
    v_mfma_f32_16x16x32_bf16 v[104:107], a[20:23], a[68:71], v[104:107]
    ds_read_b64_tr_b16 a[152:153], v33 offset:53768
    v_add_u32 v6, 152064, v6
    v_mfma_f32_16x16x32_bf16 v[136:139], a[20:23], a[76:79], v[136:139]
    buffer_load_dwordx4 v26, s[24:27], s50 offen offset:1032 lds
    v_mfma_f32_16x16x32_bf16 v[136:139], a[16:19], a[72:75], v[136:139]
    ds_read_b64_tr_b16 a[154:155], v33 offset:54024
    v_xor_b32 v7, 256, v6
    v_mfma_f32_16x16x32_bf16 v[168:171], a[16:19], a[80:83], v[168:171]
    ds_read_b64_tr_b16 a[156:157], v33 offset:54280
    v_mfma_f32_16x16x32_bf16 v[168:171], a[20:23], a[84:87], v[168:171]
    ds_read_b64_tr_b16 a[158:159], v33 offset:54536
    v_mfma_f32_16x16x32_bf16 v[200:203], a[20:23], a[92:95], v[200:203]
    v_mfma_f32_16x16x32_bf16 v[200:203], a[16:19], a[88:91], v[200:203]
    buffer_load_dwordx4 v27, s[24:27], s50 offen offset:2112 lds
    v_mfma_f32_16x16x32_bf16 v[232:235], a[16:19], a[96:99], v[232:235]
    ds_read_b64_tr_b16 a[160:161], v33 offset:53824
    ds_read_b64_tr_b16 a[162:163], v33 offset:54080
    v_mfma_f32_16x16x32_bf16 v[232:235], a[20:23], a[100:103], v[232:235]
    v_mfma_f32_16x16x32_bf16 v[108:111], a[28:31], a[68:71], v[108:111]
    ds_read_b64_tr_b16 a[164:165], v33 offset:54336
    v_mfma_f32_16x16x32_bf16 v[108:111], a[24:27], a[64:67], v[108:111]
    v_mfma_f32_16x16x32_bf16 v[140:143], a[24:27], a[72:75], v[140:143]
    buffer_load_dwordx4 v28, s[24:27], s50 offen offset:3144 lds
    v_mfma_f32_16x16x32_bf16 v[140:143], a[28:31], a[76:79], v[140:143]
    ds_read_b64_tr_b16 a[166:167], v33 offset:54592
    ds_read_b64_tr_b16 a[168:169], v33 offset:53832
    v_mfma_f32_16x16x32_bf16 v[172:175], a[28:31], a[84:87], v[172:175]
    v_mfma_f32_16x16x32_bf16 v[172:175], a[24:27], a[80:83], v[172:175]
    s_lshl_b32 s48, s45, 7
    ds_read_b64_tr_b16 a[170:171], v33 offset:54088
    v_mfma_f32_16x16x32_bf16 v[204:207], a[24:27], a[88:91], v[204:207]
    s_add_u32 m0, s52, 0
    ds_read_b64_tr_b16 a[172:173], v33 offset:54344
    v_mfma_f32_16x16x32_bf16 v[204:207], a[28:31], a[92:95], v[204:207]
    buffer_load_dwordx4 v20, s[20:23], s48 offen offset:0 lds
    v_mfma_f32_16x16x32_bf16 v[236:239], a[28:31], a[100:103], v[236:239]
    ds_read_b64_tr_b16 a[174:175], v33 offset:54600
    v_mfma_f32_16x16x32_bf16 v[236:239], a[24:27], a[96:99], v[236:239]
    ds_read_b64_tr_b16 a[176:177], v34 offset:53760
    v_mfma_f32_16x16x32_bf16 v[112:115], a[32:35], a[64:67], v[112:115]
    v_mfma_f32_16x16x32_bf16 v[112:115], a[36:39], a[68:71], v[112:115]
    ds_read_b64_tr_b16 a[178:179], v34 offset:54016
    v_mfma_f32_16x16x32_bf16 v[144:147], a[36:39], a[76:79], v[144:147]
    buffer_load_dwordx4 v21, s[20:23], s48 offen offset:1024 lds
    v_mfma_f32_16x16x32_bf16 v[144:147], a[32:35], a[72:75], v[144:147]
    ds_read_b64_tr_b16 a[180:181], v34 offset:54272
    v_mfma_f32_16x16x32_bf16 v[176:179], a[32:35], a[80:83], v[176:179]
    ds_read_b64_tr_b16 a[182:183], v34 offset:54528
    v_mfma_f32_16x16x32_bf16 v[176:179], a[36:39], a[84:87], v[176:179]
    ds_read_b64_tr_b16 a[184:185], v34 offset:53768
    v_mfma_f32_16x16x32_bf16 v[208:211], a[36:39], a[92:95], v[208:211]
    v_mfma_f32_16x16x32_bf16 v[208:211], a[32:35], a[88:91], v[208:211]
    buffer_load_dwordx4 v22, s[20:23], s48 offen offset:2048 lds
    v_mfma_f32_16x16x32_bf16 v[116:119], a[40:43], a[64:67], v[116:119]
    ds_read_b64_tr_b16 a[186:187], v34 offset:54024
    ds_read_b64_tr_b16 a[188:189], v34 offset:54280
    v_mfma_f32_16x16x32_bf16 v[116:119], a[44:47], a[68:71], v[116:119]
    v_mfma_f32_16x16x32_bf16 v[148:151], a[44:47], a[76:79], v[148:151]
    ds_read_b64_tr_b16 a[190:191], v34 offset:54536
    v_mfma_f32_16x16x32_bf16 v[148:151], a[40:43], a[72:75], v[148:151]
    ds_read_b64_tr_b16 a[192:193], v34 offset:53824
    v_mfma_f32_16x16x32_bf16 v[180:183], a[40:43], a[80:83], v[180:183]
    buffer_load_dwordx4 v23, s[20:23], s48 offen offset:3072 lds
    v_mfma_f32_16x16x32_bf16 v[180:183], a[44:47], a[84:87], v[180:183]
    ds_read_b64_tr_b16 a[194:195], v34 offset:54080
    v_mfma_f32_16x16x32_bf16 v[212:215], a[44:47], a[92:95], v[212:215]
    ds_read_b64_tr_b16 a[196:197], v34 offset:54336
    v_mfma_f32_16x16x32_bf16 v[212:215], a[40:43], a[88:91], v[212:215]
    s_add_u32 s49, s48, 32768
    v_mfma_f32_16x16x32_bf16 v[120:123], a[48:51], a[64:67], v[120:123]
    s_add_u32 m0, s52, 4096
    ds_read_b64_tr_b16 a[198:199], v34 offset:54592
    v_mfma_f32_16x16x32_bf16 v[120:123], a[52:55], a[68:71], v[120:123]
    buffer_load_dwordx4 v20, s[20:23], s49 offen offset:0 lds
    v_mfma_f32_16x16x32_bf16 v[152:155], a[52:55], a[76:79], v[152:155]
    ds_read_b64_tr_b16 a[200:201], v34 offset:53832
    v_mfma_f32_16x16x32_bf16 v[152:155], a[48:51], a[72:75], v[152:155]
    ds_read_b64_tr_b16 a[202:203], v34 offset:54088
    v_mfma_f32_16x16x32_bf16 v[184:187], a[48:51], a[80:83], v[184:187]
    ds_read_b64_tr_b16 a[204:205], v34 offset:54344
    v_mfma_f32_16x16x32_bf16 v[184:187], a[52:55], a[84:87], v[184:187]
    v_mfma_f32_16x16x32_bf16 v[216:219], a[52:55], a[92:95], v[216:219]
    buffer_load_dwordx4 v21, s[20:23], s49 offen offset:1024 lds
    v_mfma_f32_16x16x32_bf16 v[216:219], a[48:51], a[88:91], v[216:219]
    ds_read_b64_tr_b16 a[206:207], v34 offset:54600
    v_mfma_f32_16x16x32_bf16 v[124:127], a[56:59], a[64:67], v[124:127]
    v_mfma_f32_16x16x32_bf16 v[124:127], a[60:63], a[68:71], v[124:127]
    v_mfma_f32_16x16x32_bf16 v[156:159], a[60:63], a[76:79], v[156:159]
    v_mfma_f32_16x16x32_bf16 v[156:159], a[56:59], a[72:75], v[156:159]
    buffer_load_dwordx4 v22, s[20:23], s49 offen offset:2048 lds
    v_mfma_f32_16x16x32_bf16 v[188:191], a[56:59], a[80:83], v[188:191]
    v_mfma_f32_16x16x32_bf16 v[188:191], a[60:63], a[84:87], v[188:191]
    v_mfma_f32_16x16x32_bf16 v[220:223], a[60:63], a[92:95], v[220:223]
    v_mfma_f32_16x16x32_bf16 v[220:223], a[56:59], a[88:91], v[220:223]
    s_waitcnt vmcnt(11) lgkmcnt(0)
    v_mfma_f32_16x16x32_bf16 v[96:99], a[144:147], a[208:211], v[96:99]
    s_barrier
    buffer_load_dwordx4 v23, s[20:23], s49 offen offset:3072 lds
    v_mfma_f32_16x16x32_bf16 v[96:99], a[148:151], a[212:215], v[96:99]
    s_add_u32 s45, s45, 1
    ds_read_b64_tr_b16 a[0:1], v40 offset:0
    ds_read_b64_tr_b16 a[2:3], v40 offset:256
    v_mfma_f32_16x16x32_bf16 v[128:131], a[148:151], a[220:223], v[128:131]
    s_and_b32 s45, s45, 3
    v_mfma_f32_16x16x32_bf16 v[128:131], a[144:147], a[216:219], v[128:131]
    s_or_b32 s45, s45, 4
    ds_read_b128 a[64:67], v36 offset:0
    v_mfma_f32_16x16x32_bf16 v[160:163], a[144:147], a[224:227], v[160:163]
    s_add_u32 m0, s53, 0
    ds_read_b64_tr_b16 a[4:5], v40 offset:512
    v_mfma_f32_16x16x32_bf16 v[160:163], a[148:151], a[228:231], v[160:163]
    buffer_load_dwordx4 v24, s[20:23], s48 offen lds
    v_mfma_f32_16x16x32_bf16 v[192:195], a[148:151], a[236:239], v[192:195]
    ds_read_b64_tr_b16 a[6:7], v40 offset:768
    v_mfma_f32_16x16x32_bf16 v[192:195], a[144:147], a[232:235], v[192:195]
    ds_read_b128 a[68:71], v37 offset:0
    v_mfma_f32_16x16x32_bf16 v[224:227], a[144:147], a[240:243], v[224:227]
    s_lshl_b32 s50, s45, 19
    v_mfma_f32_16x16x32_bf16 v[224:227], a[148:151], a[244:247], v[224:227]
    s_add_u32 m0, s54, 53760
    ds_read_b128 a[72:75], v36 offset:2048
    v_mfma_f32_16x16x32_bf16 v[100:103], a[156:159], a[212:215], v[100:103]
    buffer_load_dwordx4 v25, s[24:27], s50 offen offset:0 lds
    v_mfma_f32_16x16x32_bf16 v[100:103], a[152:155], a[208:211], v[100:103]
    ds_read_b128 a[76:79], v37 offset:2048
    v_mfma_f32_16x16x32_bf16 v[132:135], a[152:155], a[216:219], v[132:135]
    ds_read_b128 a[80:83], v36 offset:4096
    v_mfma_f32_16x16x32_bf16 v[132:135], a[156:159], a[220:223], v[132:135]
    ds_read_b128 a[84:87], v37 offset:4096
    v_mfma_f32_16x16x32_bf16 v[164:167], a[156:159], a[228:231], v[164:167]
    v_mfma_f32_16x16x32_bf16 v[164:167], a[152:155], a[224:227], v[164:167]
    buffer_load_dwordx4 v26, s[24:27], s50 offen offset:1032 lds
    v_mfma_f32_16x16x32_bf16 v[196:199], a[152:155], a[232:235], v[196:199]
    ds_read_b128 a[88:91], v36 offset:6144
    ds_read_b128 a[92:95], v37 offset:6144
    v_mfma_f32_16x16x32_bf16 v[196:199], a[156:159], a[236:239], v[196:199]
    v_mfma_f32_16x16x32_bf16 v[228:231], a[156:159], a[244:247], v[228:231]
    ds_read_b128 a[96:99], v38 offset:0
    v_mfma_f32_16x16x32_bf16 v[228:231], a[152:155], a[240:243], v[228:231]
    ds_read_b128 a[100:103], v39 offset:0
    v_mfma_f32_16x16x32_bf16 v[104:107], a[160:163], a[208:211], v[104:107]
    buffer_load_dwordx4 v27, s[24:27], s50 offen offset:2112 lds
    v_mfma_f32_16x16x32_bf16 v[104:107], a[164:167], a[212:215], v[104:107]
    ds_read_b64_tr_b16 a[8:9], v40 offset:8
    v_mfma_f32_16x16x32_bf16 v[136:139], a[164:167], a[220:223], v[136:139]
    ds_read_b64_tr_b16 a[10:11], v40 offset:264
    v_mfma_f32_16x16x32_bf16 v[136:139], a[160:163], a[216:219], v[136:139]
    v_mfma_f32_16x16x32_bf16 v[168:171], a[160:163], a[224:227], v[168:171]
    ds_read_b64_tr_b16 a[12:13], v40 offset:520
    v_mfma_f32_16x16x32_bf16 v[168:171], a[164:167], a[228:231], v[168:171]
    buffer_load_dwordx4 v28, s[24:27], s50 offen offset:3144 lds
    v_mfma_f32_16x16x32_bf16 v[200:203], a[164:167], a[236:239], v[200:203]
    ds_read_b64_tr_b16 a[14:15], v40 offset:776
    v_mfma_f32_16x16x32_bf16 v[200:203], a[160:163], a[232:235], v[200:203]
    ds_read_b64_tr_b16 a[16:17], v40 offset:64
    v_mfma_f32_16x16x32_bf16 v[232:235], a[160:163], a[240:243], v[232:235]
    s_lshl_b32 s48, s45, 7
    ds_read_b64_tr_b16 a[18:19], v40 offset:320
    v_mfma_f32_16x16x32_bf16 v[232:235], a[164:167], a[244:247], v[232:235]
    s_add_u32 m0, s52, 53760
    v_mfma_f32_16x16x32_bf16 v[108:111], a[172:175], a[212:215], v[108:111]
    buffer_load_dwordx4 v20, s[20:23], s48 offen offset:0 lds
    v_mfma_f32_16x16x32_bf16 v[108:111], a[168:171], a[208:211], v[108:111]
    ds_read_b64_tr_b16 a[20:21], v40 offset:576
    v_mfma_f32_16x16x32_bf16 v[140:143], a[168:171], a[216:219], v[140:143]
    ds_read_b64_tr_b16 a[22:23], v40 offset:832
    v_mfma_f32_16x16x32_bf16 v[140:143], a[172:175], a[220:223], v[140:143]
    ds_read_b64_tr_b16 a[24:25], v40 offset:72
    v_mfma_f32_16x16x32_bf16 v[172:175], a[172:175], a[228:231], v[172:175]
    v_mfma_f32_16x16x32_bf16 v[172:175], a[168:171], a[224:227], v[172:175]
    buffer_load_dwordx4 v21, s[20:23], s48 offen offset:1024 lds
    v_mfma_f32_16x16x32_bf16 v[204:207], a[168:171], a[232:235], v[204:207]
    ds_read_b64_tr_b16 a[26:27], v40 offset:328
    ds_read_b64_tr_b16 a[28:29], v40 offset:584
    s_branch L_pg1
    .p2align 12
L_stub1:
    s_branch L_stub5
L_pg1:
    v_mfma_f32_16x16x32_bf16 v[204:207], a[172:175], a[236:239], v[204:207]
    v_mfma_f32_16x16x32_bf16 v[236:239], a[172:175], a[244:247], v[236:239]
    ds_read_b64_tr_b16 a[30:31], v40 offset:840
    v_mfma_f32_16x16x32_bf16 v[236:239], a[168:171], a[240:243], v[236:239]
    ds_read_b64_tr_b16 a[32:33], v41 offset:0
    v_mfma_f32_16x16x32_bf16 v[112:115], a[176:179], a[208:211], v[112:115]
    buffer_load_dwordx4 v22, s[20:23], s48 offen offset:2048 lds
    v_mfma_f32_16x16x32_bf16 v[112:115], a[180:183], a[212:215], v[112:115]
    ds_read_b64_tr_b16 a[34:35], v41 offset:256
    v_mfma_f32_16x16x32_bf16 v[144:147], a[180:183], a[220:223], v[144:147]
    ds_read_b64_tr_b16 a[36:37], v41 offset:512
    v_mfma_f32_16x16x32_bf16 v[144:147], a[176:179], a[216:219], v[144:147]
    v_mfma_f32_16x16x32_bf16 v[176:179], a[176:179], a[224:227], v[176:179]
    ds_read_b64_tr_b16 a[38:39], v41 offset:768
    v_mfma_f32_16x16x32_bf16 v[176:179], a[180:183], a[228:231], v[176:179]
    buffer_load_dwordx4 v23, s[20:23], s48 offen offset:3072 lds
    v_mfma_f32_16x16x32_bf16 v[208:211], a[180:183], a[236:239], v[208:211]
    ds_read_b64_tr_b16 a[40:41], v41 offset:8
    v_mfma_f32_16x16x32_bf16 v[208:211], a[176:179], a[232:235], v[208:211]
    ds_read_b64_tr_b16 a[42:43], v41 offset:264
    v_mfma_f32_16x16x32_bf16 v[116:119], a[184:187], a[208:211], v[116:119]
    s_add_u32 s49, s48, 32768
    ds_read_b64_tr_b16 a[44:45], v41 offset:520
    v_mfma_f32_16x16x32_bf16 v[116:119], a[188:191], a[212:215], v[116:119]
    s_add_u32 m0, s52, 57856
    v_mfma_f32_16x16x32_bf16 v[148:151], a[188:191], a[220:223], v[148:151]
    buffer_load_dwordx4 v20, s[20:23], s49 offen offset:0 lds
    v_mfma_f32_16x16x32_bf16 v[148:151], a[184:187], a[216:219], v[148:151]
    ds_read_b64_tr_b16 a[46:47], v41 offset:776
    ds_read_b64_tr_b16 a[48:49], v41 offset:64
    v_mfma_f32_16x16x32_bf16 v[180:183], a[184:187], a[224:227], v[180:183]
    v_mfma_f32_16x16x32_bf16 v[180:183], a[188:191], a[228:231], v[180:183]
    ds_read_b64_tr_b16 a[50:51], v41 offset:320
    v_mfma_f32_16x16x32_bf16 v[212:215], a[188:191], a[236:239], v[212:215]
    ds_read_b64_tr_b16 a[52:53], v41 offset:576
    v_mfma_f32_16x16x32_bf16 v[212:215], a[184:187], a[232:235], v[212:215]
    buffer_load_dwordx4 v21, s[20:23], s49 offen offset:1024 lds
    v_mfma_f32_16x16x32_bf16 v[120:123], a[192:195], a[208:211], v[120:123]
    ds_read_b64_tr_b16 a[54:55], v41 offset:832
    v_mfma_f32_16x16x32_bf16 v[120:123], a[196:199], a[212:215], v[120:123]
    ds_read_b64_tr_b16 a[56:57], v41 offset:72
    v_mfma_f32_16x16x32_bf16 v[152:155], a[196:199], a[220:223], v[152:155]
    v_mfma_f32_16x16x32_bf16 v[152:155], a[192:195], a[216:219], v[152:155]
    ds_read_b64_tr_b16 a[58:59], v41 offset:328
    v_mfma_f32_16x16x32_bf16 v[184:187], a[192:195], a[224:227], v[184:187]
    buffer_load_dwordx4 v22, s[20:23], s49 offen offset:2048 lds
    v_mfma_f32_16x16x32_bf16 v[184:187], a[196:199], a[228:231], v[184:187]
    ds_read_b64_tr_b16 a[60:61], v41 offset:584
    v_mfma_f32_16x16x32_bf16 v[216:219], a[196:199], a[236:239], v[216:219]
    ds_read_b64_tr_b16 a[62:63], v41 offset:840
    v_mfma_f32_16x16x32_bf16 v[216:219], a[192:195], a[232:235], v[216:219]
    v_mfma_f32_16x16x32_bf16 v[124:127], a[200:203], a[208:211], v[124:127]
    v_mfma_f32_16x16x32_bf16 v[124:127], a[204:207], a[212:215], v[124:127]
    buffer_load_dwordx4 v23, s[20:23], s49 offen offset:3072 lds
    v_mfma_f32_16x16x32_bf16 v[156:159], a[204:207], a[220:223], v[156:159]
    s_add_u32 s45, s45, 1
    v_mfma_f32_16x16x32_bf16 v[156:159], a[200:203], a[216:219], v[156:159]
    s_and_b32 s45, s45, 3
    v_mfma_f32_16x16x32_bf16 v[188:191], a[200:203], a[224:227], v[188:191]
    s_or_b32 s45, s45, 4
    v_mfma_f32_16x16x32_bf16 v[188:191], a[204:207], a[228:231], v[188:191]
    s_add_u32 m0, s53, 53760
    v_mfma_f32_16x16x32_bf16 v[220:223], a[204:207], a[236:239], v[220:223]
    buffer_load_dwordx4 v24, s[20:23], s48 offen lds
    v_mfma_f32_16x16x32_bf16 v[220:223], a[200:203], a[232:235], v[220:223]
    s_waitcnt vmcnt(13) lgkmcnt(0)
    v_mfma_f32_16x16x32_bf16 v[96:99], a[0:3], a[64:67], v[96:99]
    s_barrier
    ds_read_b64_tr_b16 a[144:145], v33 offset:0
    v_mfma_f32_16x16x32_bf16 v[96:99], a[4:7], a[68:71], v[96:99]
    s_lshl_b32 s50, s45, 19
    ds_read_b64_tr_b16 a[146:147], v33 offset:256
    v_mfma_f32_16x16x32_bf16 v[128:131], a[4:7], a[76:79], v[128:131]
    s_add_u32 m0, s54, 107520
    v_mfma_f32_16x16x32_bf16 v[128:131], a[0:3], a[72:75], v[128:131]
    buffer_load_dwordx4 v25, s[24:27], s50 offen offset:0 lds
    v_mfma_f32_16x16x32_bf16 v[160:163], a[0:3], a[80:83], v[160:163]
    ds_read_b128 a[208:211], v29 offset:0
    ds_read_b64_tr_b16 a[148:149], v33 offset:512
    v_mfma_f32_16x16x32_bf16 v[160:163], a[4:7], a[84:87], v[160:163]
    v_mfma_f32_16x16x32_bf16 v[192:195], a[4:7], a[92:95], v[192:195]
    ds_read_b64_tr_b16 a[150:151], v33 offset:768
    v_mfma_f32_16x16x32_bf16 v[192:195], a[0:3], a[88:91], v[192:195]
    ds_read_b128 a[212:215], v30 offset:0
    v_mfma_f32_16x16x32_bf16 v[224:227], a[0:3], a[96:99], v[224:227]
    buffer_load_dwordx4 v26, s[24:27], s50 offen offset:1032 lds
    v_mfma_f32_16x16x32_bf16 v[224:227], a[4:7], a[100:103], v[224:227]
    ds_read_b128 a[216:219], v29 offset:2048
    v_mfma_f32_16x16x32_bf16 v[100:103], a[12:15], a[68:71], v[100:103]
    ds_read_b128 a[220:223], v30 offset:2048
    v_mfma_f32_16x16x32_bf16 v[100:103], a[8:11], a[64:67], v[100:103]
    v_mfma_f32_16x16x32_bf16 v[132:135], a[8:11], a[72:75], v[132:135]
    ds_read_b128 a[224:227], v29 offset:4096
    v_mfma_f32_16x16x32_bf16 v[132:135], a[12:15], a[76:79], v[132:135]
    buffer_load_dwordx4 v27, s[24:27], s50 offen offset:2112 lds
    v_mfma_f32_16x16x32_bf16 v[164:167], a[12:15], a[84:87], v[164:167]
    ds_read_b128 a[228:231], v30 offset:4096
    v_mfma_f32_16x16x32_bf16 v[164:167], a[8:11], a[80:83], v[164:167]
    ds_read_b128 a[232:235], v29 offset:6144
    v_mfma_f32_16x16x32_bf16 v[196:199], a[8:11], a[88:91], v[196:199]
    ds_read_b128 a[236:239], v30 offset:6144
    v_mfma_f32_16x16x32_bf16 v[196:199], a[12:15], a[92:95], v[196:199]
    v_mfma_f32_16x16x32_bf16 v[228:231], a[12:15], a[100:103], v[228:231]
    buffer_load_dwordx4 v28, s[24:27], s50 offen offset:3144 lds
    v_mfma_f32_16x16x32_bf16 v[228:231], a[8:11], a[96:99], v[228:231]
    ds_read_b128 a[240:243], v31 offset:0
    ds_read_b128 a[244:247], v32 offset:0
    v_mfma_f32_16x16x32_bf16 v[104:107], a[16:19], a[64:67], v[104:107]
    v_mfma_f32_16x16x32_bf16 v[104:107], a[20:23], a[68:71], v[104:107]
    s_lshl_b32 s48, s45, 7
    ds_read_b64_tr_b16 a[152:153], v33 offset:8
    v_mfma_f32_16x16x32_bf16 v[136:139], a[20:23], a[76:79], v[136:139]
    s_add_u32 m0, s52, 107520
    ds_read_b64_tr_b16 a[154:155], v33 offset:264
    v_mfma_f32_16x16x32_bf16 v[136:139], a[16:19], a[72:75], v[136:139]
    buffer_load_dwordx4 v20, s[20:23], s48 offen offset:0 lds
    v_mfma_f32_16x16x32_bf16 v[168:171], a[16:19], a[80:83], v[168:171]
    ds_read_b64_tr_b16 a[156:157], v33 offset:520
    v_mfma_f32_16x16x32_bf16 v[168:171], a[20:23], a[84:87], v[168:171]
    ds_read_b64_tr_b16 a[158:159], v33 offset:776
    v_mfma_f32_16x16x32_bf16 v[200:203], a[20:23], a[92:95], v[200:203]
    v_mfma_f32_16x16x32_bf16 v[200:203], a[16:19], a[88:91], v[200:203]
    ds_read_b64_tr_b16 a[160:161], v33 offset:64
    v_mfma_f32_16x16x32_bf16 v[232:235], a[16:19], a[96:99], v[232:235]
    buffer_load_dwordx4 v21, s[20:23], s48 offen offset:1024 lds
    v_mfma_f32_16x16x32_bf16 v[232:235], a[20:23], a[100:103], v[232:235]
    ds_read_b64_tr_b16 a[162:163], v33 offset:320
    v_mfma_f32_16x16x32_bf16 v[108:111], a[28:31], a[68:71], v[108:111]
    ds_read_b64_tr_b16 a[164:165], v33 offset:576
    v_mfma_f32_16x16x32_bf16 v[108:111], a[24:27], a[64:67], v[108:111]
    v_mfma_f32_16x16x32_bf16 v[140:143], a[24:27], a[72:75], v[140:143]
    ds_read_b64_tr_b16 a[166:167], v33 offset:832
    v_mfma_f32_16x16x32_bf16 v[140:143], a[28:31], a[76:79], v[140:143]
    buffer_load_dwordx4 v22, s[20:23], s48 offen offset:2048 lds
    v_mfma_f32_16x16x32_bf16 v[172:175], a[28:31], a[84:87], v[172:175]
    ds_read_b64_tr_b16 a[168:169], v33 offset:72
    v_mfma_f32_16x16x32_bf16 v[172:175], a[24:27], a[80:83], v[172:175]
    ds_read_b64_tr_b16 a[170:171], v33 offset:328
    v_mfma_f32_16x16x32_bf16 v[204:207], a[24:27], a[88:91], v[204:207]
    ds_read_b64_tr_b16 a[172:173], v33 offset:584
    v_mfma_f32_16x16x32_bf16 v[204:207], a[28:31], a[92:95], v[204:207]
    v_mfma_f32_16x16x32_bf16 v[236:239], a[28:31], a[100:103], v[236:239]
    buffer_load_dwordx4 v23, s[20:23], s48 offen offset:3072 lds
    v_mfma_f32_16x16x32_bf16 v[236:239], a[24:27], a[96:99], v[236:239]
    ds_read_b64_tr_b16 a[174:175], v33 offset:840
    ds_read_b64_tr_b16 a[176:177], v34 offset:0
    v_mfma_f32_16x16x32_bf16 v[112:115], a[32:35], a[64:67], v[112:115]
    v_mfma_f32_16x16x32_bf16 v[112:115], a[36:39], a[68:71], v[112:115]
    s_add_u32 s49, s48, 32768
    ds_read_b64_tr_b16 a[178:179], v34 offset:256
    v_mfma_f32_16x16x32_bf16 v[144:147], a[36:39], a[76:79], v[144:147]
    s_add_u32 m0, s52, 111616
    ds_read_b64_tr_b16 a[180:181], v34 offset:512
    v_mfma_f32_16x16x32_bf16 v[144:147], a[32:35], a[72:75], v[144:147]
    buffer_load_dwordx4 v20, s[20:23], s49 offen offset:0 lds
    v_mfma_f32_16x16x32_bf16 v[176:179], a[32:35], a[80:83], v[176:179]
    ds_read_b64_tr_b16 a[182:183], v34 offset:768
    v_mfma_f32_16x16x32_bf16 v[176:179], a[36:39], a[84:87], v[176:179]
    ds_read_b64_tr_b16 a[184:185], v34 offset:8
    v_mfma_f32_16x16x32_bf16 v[208:211], a[36:39], a[92:95], v[208:211]
    v_mfma_f32_16x16x32_bf16 v[208:211], a[32:35], a[88:91], v[208:211]
    ds_read_b64_tr_b16 a[186:187], v34 offset:264
    v_mfma_f32_16x16x32_bf16 v[116:119], a[40:43], a[64:67], v[116:119]
    buffer_load_dwordx4 v21, s[20:23], s49 offen offset:1024 lds
    v_mfma_f32_16x16x32_bf16 v[116:119], a[44:47], a[68:71], v[116:119]
    ds_read_b64_tr_b16 a[188:189], v34 offset:520
    v_mfma_f32_16x16x32_bf16 v[148:151], a[44:47], a[76:79], v[148:151]
    ds_read_b64_tr_b16 a[190:191], v34 offset:776
    v_mfma_f32_16x16x32_bf16 v[148:151], a[40:43], a[72:75], v[148:151]
    ds_read_b64_tr_b16 a[192:193], v34 offset:64
    v_mfma_f32_16x16x32_bf16 v[180:183], a[40:43], a[80:83], v[180:183]
    v_mfma_f32_16x16x32_bf16 v[180:183], a[44:47], a[84:87], v[180:183]
    buffer_load_dwordx4 v22, s[20:23], s49 offen offset:2048 lds
    v_mfma_f32_16x16x32_bf16 v[212:215], a[44:47], a[92:95], v[212:215]
    ds_read_b64_tr_b16 a[194:195], v34 offset:320
    ds_read_b64_tr_b16 a[196:197], v34 offset:576
    v_mfma_f32_16x16x32_bf16 v[212:215], a[40:43], a[88:91], v[212:215]
    v_mfma_f32_16x16x32_bf16 v[120:123], a[48:51], a[64:67], v[120:123]
    ds_read_b64_tr_b16 a[198:199], v34 offset:832
    v_mfma_f32_16x16x32_bf16 v[120:123], a[52:55], a[68:71], v[120:123]
    ds_read_b64_tr_b16 a[200:201], v34 offset:72
    v_mfma_f32_16x16x32_bf16 v[152:155], a[52:55], a[76:79], v[152:155]
    buffer_load_dwordx4 v23, s[20:23], s49 offen offset:3072 lds
    v_mfma_f32_16x16x32_bf16 v[152:155], a[48:51], a[72:75], v[152:155]
    s_add_u32 s45, s45, 1
    ds_read_b64_tr_b16 a[202:203], v34 offset:328
    v_mfma_f32_16x16x32_bf16 v[184:187], a[48:51], a[80:83], v[184:187]
    s_and_b32 s45, s45, 3
    ds_read_b64_tr_b16 a[204:205], v34 offset:584
    v_mfma_f32_16x16x32_bf16 v[184:187], a[52:55], a[84:87], v[184:187]
    s_or_b32 s45, s45, 8
    v_mfma_f32_16x16x32_bf16 v[216:219], a[52:55], a[92:95], v[216:219]
    s_add_u32 m0, s53, 107520
    ds_read_b64_tr_b16 a[206:207], v34 offset:840
    v_mfma_f32_16x16x32_bf16 v[216:219], a[48:51], a[88:91], v[216:219]
    buffer_load_dwordx4 v24, s[20:23], s48 offen lds
    v_mfma_f32_16x16x32_bf16 v[124:127], a[56:59], a[64:67], v[124:127]
    v_mfma_f32_16x16x32_bf16 v[124:127], a[60:63], a[68:71], v[124:127]
    v_mfma_f32_16x16x32_bf16 v[156:159], a[60:63], a[76:79], v[156:159]
    v_mfma_f32_16x16x32_bf16 v[156:159], a[56:59], a[72:75], v[156:159]
    v_mfma_f32_16x16x32_bf16 v[188:191], a[56:59], a[80:83], v[188:191]
    v_mfma_f32_16x16x32_bf16 v[188:191], a[60:63], a[84:87], v[188:191]
    v_mfma_f32_16x16x32_bf16 v[220:223], a[60:63], a[92:95], v[220:223]
    v_mfma_f32_16x16x32_bf16 v[220:223], a[56:59], a[88:91], v[220:223]
    s_waitcnt vmcnt(13) lgkmcnt(0)
    v_mfma_f32_16x16x32_bf16 v[96:99], a[144:147], a[208:211], v[96:99]
    s_barrier
    s_add_u32 s48, s71, 0
    ds_read_b64_tr_b16 a[0:1], v33 offset:53760
    v_mfma_f32_16x16x32_bf16 v[96:99], a[148:151], a[212:215], v[96:99]
    s_and_b32 s48, s48, 0x3ffff
    ds_read_b64_tr_b16 a[2:3], v33 offset:54016
    v_mfma_f32_16x16x32_bf16 v[128:131], a[148:151], a[220:223], v[128:131]
    s_add_u32 m0, s60, 0
    v_mfma_f32_16x16x32_bf16 v[128:131], a[144:147], a[216:219], v[128:131]
    buffer_load_dwordx4 v88, s[28:31], s48 offen offset:0 nt lds
    v_mfma_f32_16x16x32_bf16 v[160:163], a[144:147], a[224:227], v[160:163]
    ds_read_b128 a[64:67], v29 offset:53760
    ds_read_b64_tr_b16 a[4:5], v33 offset:54272
    v_mfma_f32_16x16x32_bf16 v[160:163], a[148:151], a[228:231], v[160:163]
    v_mfma_f32_16x16x32_bf16 v[192:195], a[148:151], a[236:239], v[192:195]
    ds_read_b64_tr_b16 a[6:7], v33 offset:54528
    v_mfma_f32_16x16x32_bf16 v[192:195], a[144:147], a[232:235], v[192:195]
    s_add_u32 m0, s60, 32
    ds_read_b128 a[68:71], v30 offset:53760
    v_mfma_f32_16x16x32_bf16 v[224:227], a[144:147], a[240:243], v[224:227]
    buffer_load_dwordx4 v88, s[28:31], s48 offen offset:1024 nt lds
    v_mfma_f32_16x16x32_bf16 v[224:227], a[148:151], a[244:247], v[224:227]
    ds_read_b128 a[72:75], v29 offset:55808
    v_mfma_f32_16x16x32_bf16 v[100:103], a[156:159], a[212:215], v[100:103]
    ds_read_b128 a[76:79], v30 offset:55808
    v_mfma_f32_16x16x32_bf16 v[100:103], a[152:155], a[208:211], v[100:103]
    v_mfma_f32_16x16x32_bf16 v[132:135], a[152:155], a[216:219], v[132:135]
    s_add_u32 m0, s60, 64
    ds_read_b128 a[80:83], v29 offset:57856
    v_mfma_f32_16x16x32_bf16 v[132:135], a[156:159], a[220:223], v[132:135]
    buffer_load_dwordx4 v88, s[28:31], s48 offen offset:2048 nt lds
    v_mfma_f32_16x16x32_bf16 v[164:167], a[156:159], a[228:231], v[164:167]
    ds_read_b128 a[84:87], v30 offset:57856
    v_mfma_f32_16x16x32_bf16 v[164:167], a[152:155], a[224:227], v[164:167]
    ds_read_b128 a[88:91], v29 offset:59904
    v_mfma_f32_16x16x32_bf16 v[196:199], a[152:155], a[232:235], v[196:199]
    ds_read_b128 a[92:95], v30 offset:59904
    v_mfma_f32_16x16x32_bf16 v[196:199], a[156:159], a[236:239], v[196:199]
    s_add_u32 m0, s60, 96
    v_mfma_f32_16x16x32_bf16 v[228:231], a[156:159], a[244:247], v[228:231]
    buffer_load_dwordx4 v88, s[28:31], s48 offen offset:3072 nt lds
    v_mfma_f32_16x16x32_bf16 v[228:231], a[152:155], a[240:243], v[228:231]
    ds_read_b128 a[96:99], v31 offset:53760
    ds_read_b128 a[100:103], v32 offset:53760
    v_mfma_f32_16x16x32_bf16 v[104:107], a[160:163], a[208:211], v[104:107]
    s_add_u32 s48, s71, 0
    v_mfma_f32_16x16x32_bf16 v[104:107], a[164:167], a[212:215], v[104:107]
    s_and_b32 s48, s48, 0x3ffff
    ds_read_b64_tr_b16 a[8:9], v33 offset:53768
    v_mfma_f32_16x16x32_bf16 v[136:139], a[164:167], a[220:223], v[136:139]
    s_add_u32 m0, s60, 16896
    ds_read_b64_tr_b16 a[10:11], v33 offset:54024
    v_mfma_f32_16x16x32_bf16 v[136:139], a[160:163], a[216:219], v[136:139]
    buffer_load_dwordx4 v88, s[32:35], s48 offen offset:0 nt lds
    v_mfma_f32_16x16x32_bf16 v[168:171], a[160:163], a[224:227], v[168:171]
    ds_read_b64_tr_b16 a[12:13], v33 offset:54280
    v_mfma_f32_16x16x32_bf16 v[168:171], a[164:167], a[228:231], v[168:171]
    ds_read_b64_tr_b16 a[14:15], v33 offset:54536
    v_mfma_f32_16x16x32_bf16 v[200:203], a[164:167], a[236:239], v[200:203]
    v_mfma_f32_16x16x32_bf16 v[200:203], a[160:163], a[232:235], v[200:203]
    s_add_u32 m0, s60, 16928
    ds_read_b64_tr_b16 a[16:17], v33 offset:53824
    v_mfma_f32_16x16x32_bf16 v[232:235], a[160:163], a[240:243], v[232:235]
    buffer_load_dwordx4 v88, s[32:35], s48 offen offset:1024 nt lds
    v_mfma_f32_16x16x32_bf16 v[232:235], a[164:167], a[244:247], v[232:235]
    ds_read_b64_tr_b16 a[18:19], v33 offset:54080
    v_mfma_f32_16x16x32_bf16 v[108:111], a[172:175], a[212:215], v[108:111]
    ds_read_b64_tr_b16 a[20:21], v33 offset:54336
    v_mfma_f32_16x16x32_bf16 v[108:111], a[168:171], a[208:211], v[108:111]
    v_mfma_f32_16x16x32_bf16 v[140:143], a[168:171], a[216:219], v[140:143]
    s_add_u32 m0, s60, 16960
    ds_read_b64_tr_b16 a[22:23], v33 offset:54592
    v_mfma_f32_16x16x32_bf16 v[140:143], a[172:175], a[220:223], v[140:143]
    buffer_load_dwordx4 v88, s[32:35], s48 offen offset:2048 nt lds
    v_mfma_f32_16x16x32_bf16 v[172:175], a[172:175], a[228:231], v[172:175]
    ds_read_b64_tr_b16 a[24:25], v33 offset:53832
    v_mfma_f32_16x16x32_bf16 v[172:175], a[168:171], a[224:227], v[172:175]
    ds_read_b64_tr_b16 a[26:27], v33 offset:54088
    v_mfma_f32_16x16x32_bf16 v[204:207], a[168:171], a[232:235], v[204:207]
    ds_read_b64_tr_b16 a[28:29], v33 offset:54344
    v_mfma_f32_16x16x32_bf16 v[204:207], a[172:175], a[236:239], v[204:207]
    s_add_u32 m0, s60, 16992
    v_mfma_f32_16x16x32_bf16 v[236:239], a[172:175], a[244:247], v[236:239]
    buffer_load_dwordx4 v88, s[32:35], s48 offen offset:3072 nt lds
    v_mfma_f32_16x16x32_bf16 v[236:239], a[168:171], a[240:243], v[236:239]
    ds_read_b64_tr_b16 a[30:31], v33 offset:54600
    ds_read_b64_tr_b16 a[32:33], v34 offset:53760
    v_mfma_f32_16x16x32_bf16 v[112:115], a[176:179], a[208:211], v[112:115]
    s_add_u32 s48, s71, 16384
    v_mfma_f32_16x16x32_bf16 v[112:115], a[180:183], a[212:215], v[112:115]
    s_and_b32 s48, s48, 0x3ffff
    ds_read_b64_tr_b16 a[34:35], v34 offset:54016
    v_mfma_f32_16x16x32_bf16 v[144:147], a[180:183], a[220:223], v[144:147]
    s_add_u32 m0, s60, 33792
    ds_read_b64_tr_b16 a[36:37], v34 offset:54272
    v_mfma_f32_16x16x32_bf16 v[144:147], a[176:179], a[216:219], v[144:147]
    buffer_load_dwordx4 v88, s[28:31], s48 offen offset:0 nt lds
    v_mfma_f32_16x16x32_bf16 v[176:179], a[176:179], a[224:227], v[176:179]
    ds_read_b64_tr_b16 a[38:39], v34 offset:54528
    v_mfma_f32_16x16x32_bf16 v[176:179], a[180:183], a[228:231], v[176:179]
    ds_read_b64_tr_b16 a[40:41], v34 offset:53768
    v_mfma_f32_16x16x32_bf16 v[208:211], a[180:183], a[236:239], v[208:211]
    v_mfma_f32_16x16x32_bf16 v[208:211], a[176:179], a[232:235], v[208:211]
    ds_read_b64_tr_b16 a[42:43], v34 offset:54024
    v_mfma_f32_16x16x32_bf16 v[116:119], a[184:187], a[208:211], v[116:119]
    ds_read_b64_tr_b16 a[44:45], v34 offset:54280
    v_mfma_f32_16x16x32_bf16 v[116:119], a[188:191], a[212:215], v[116:119]
    v_mfma_f32_16x16x32_bf16 v[148:151], a[188:191], a[220:223], v[148:151]
    ds_read_b64_tr_b16 a[46:47], v34 offset:54536
    v_mfma_f32_16x16x32_bf16 v[148:151], a[184:187], a[216:219], v[148:151]
    ds_read_b64_tr_b16 a[48:49], v34 offset:53824
    v_mfma_f32_16x16x32_bf16 v[180:183], a[184:187], a[224:227], v[180:183]
    v_mfma_f32_16x16x32_bf16 v[180:183], a[188:191], a[228:231], v[180:183]
    ds_read_b64_tr_b16 a[50:51], v34 offset:54080
    v_mfma_f32_16x16x32_bf16 v[212:215], a[188:191], a[236:239], v[212:215]
    ds_read_b64_tr_b16 a[52:53], v34 offset:54336
    v_mfma_f32_16x16x32_bf16 v[212:215], a[184:187], a[232:235], v[212:215]
    v_mfma_f32_16x16x32_bf16 v[120:123], a[192:195], a[208:211], v[120:123]
    ds_read_b64_tr_b16 a[54:55], v34 offset:54592
    v_mfma_f32_16x16x32_bf16 v[120:123], a[196:199], a[212:215], v[120:123]
    ds_read_b64_tr_b16 a[56:57], v34 offset:53832
    v_mfma_f32_16x16x32_bf16 v[152:155], a[196:199], a[220:223], v[152:155]
    v_mfma_f32_16x16x32_bf16 v[152:155], a[192:195], a[216:219], v[152:155]
    ds_read_b64_tr_b16 a[58:59], v34 offset:54088
    v_mfma_f32_16x16x32_bf16 v[184:187], a[192:195], a[224:227], v[184:187]
    ds_read_b64_tr_b16 a[60:61], v34 offset:54344
    v_mfma_f32_16x16x32_bf16 v[184:187], a[196:199], a[228:231], v[184:187]
    v_mfma_f32_16x16x32_bf16 v[216:219], a[196:199], a[236:239], v[216:219]
    s_add_u32 m0, s60, 33824
    ds_read_b64_tr_b16 a[62:63], v34 offset:54600
    v_mfma_f32_16x16x32_bf16 v[216:219], a[192:195], a[232:235], v[216:219]
    buffer_load_dwordx4 v88, s[28:31], s48 offen offset:1024 nt lds
    v_mfma_f32_16x16x32_bf16 v[124:127], a[200:203], a[208:211], v[124:127]
    v_mfma_f32_16x16x32_bf16 v[124:127], a[204:207], a[212:215], v[124:127]
    v_mfma_f32_16x16x32_bf16 v[156:159], a[204:207], a[220:223], v[156:159]
    v_mfma_f32_16x16x32_bf16 v[156:159], a[200:203], a[216:219], v[156:159]
    v_mfma_f32_16x16x32_bf16 v[188:191], a[200:203], a[224:227], v[188:191]
    v_mfma_f32_16x16x32_bf16 v[188:191], a[204:207], a[228:231], v[188:191]
    v_mfma_f32_16x16x32_bf16 v[220:223], a[204:207], a[236:239], v[220:223]
    v_mfma_f32_16x16x32_bf16 v[220:223], a[200:203], a[232:235], v[220:223]
    s_waitcnt vmcnt(10) lgkmcnt(0)
    v_mfma_f32_16x16x32_bf16 v[96:99], a[0:3], a[64:67], v[96:99]
    s_barrier
    ds_read_b64_tr_b16 a[144:145], v40 offset:0
    v_mfma_f32_16x16x32_bf16 v[96:99], a[4:7], a[68:71], v[96:99]
    ds_read_b64_tr_b16 a[146:147], v40 offset:256
    v_mfma_f32_16x16x32_bf16 v[128:131], a[4:7], a[76:79], v[128:131]
    v_mfma_f32_16x16x32_bf16 v[128:131], a[0:3], a[72:75], v[128:131]
    ds_read_b128 a[208:211], v36 offset:0
    v_mfma_f32_16x16x32_bf16 v[160:163], a[0:3], a[80:83], v[160:163]
    ds_read_b64_tr_b16 a[148:149], v40 offset:512
    v_mfma_f32_16x16x32_bf16 v[160:163], a[4:7], a[84:87], v[160:163]
    v_mfma_f32_16x16x32_bf16 v[192:195], a[4:7], a[92:95], v[192:195]
    ds_read_b64_tr_b16 a[150:151], v40 offset:768
    v_mfma_f32_16x16x32_bf16 v[192:195], a[0:3], a[88:91], v[192:195]
    ds_read_b128 a[212:215], v37 offset:0
    v_mfma_f32_16x16x32_bf16 v[224:227], a[0:3], a[96:99], v[224:227]
    v_mfma_f32_16x16x32_bf16 v[224:227], a[4:7], a[100:103], v[224:227]
    ds_read_b128 a[216:219], v36 offset:2048
    v_mfma_f32_16x16x32_bf16 v[100:103], a[12:15], a[68:71], v[100:103]
    s_add_u32 m0, s60, 33856
    ds_read_b128 a[220:223], v37 offset:2048
    v_mfma_f32_16x16x32_bf16 v[100:103], a[8:11], a[64:67], v[100:103]
    buffer_load_dwordx4 v88, s[28:31], s48 offen offset:2048 nt lds
    v_mfma_f32_16x16x32_bf16 v[132:135], a[8:11], a[72:75], v[132:135]
    ds_read_b128 a[224:227], v36 offset:4096
    v_mfma_f32_16x16x32_bf16 v[132:135], a[12:15], a[76:79], v[132:135]
    ds_read_b128 a[228:231], v37 offset:4096
    v_mfma_f32_16x16x32_bf16 v[164:167], a[12:15], a[84:87], v[164:167]
    v_mfma_f32_16x16x32_bf16 v[164:167], a[8:11], a[80:83], v[164:167]
    ds_read_b128 a[232:235], v36 offset:6144
    v_mfma_f32_16x16x32_bf16 v[196:199], a[8:11], a[88:91], v[196:199]
    ds_read_b128 a[236:239], v37 offset:6144
    v_mfma_f32_16x16x32_bf16 v[196:199], a[12:15], a[92:95], v[196:199]
    v_mfma_f32_16x16x32_bf16 v[228:231], a[12:15], a[100:103], v[228:231]
    ds_read_b128 a[240:243], v38 offset:0
    v_mfma_f32_16x16x32_bf16 v[228:231], a[8:11], a[96:99], v[228:231]
    ds_read_b128 a[244:247], v39 offset:0
    v_mfma_f32_16x16x32_bf16 v[104:107], a[16:19], a[64:67], v[104:107]
    v_mfma_f32_16x16x32_bf16 v[104:107], a[20:23], a[68:71], v[104:107]
    ds_read_b64_tr_b16 a[152:153], v40 offset:8
    v_mfma_f32_16x16x32_bf16 v[136:139], a[20:23], a[76:79], v[136:139]
    ds_read_b64_tr_b16 a[154:155], v40 offset:264
    v_mfma_f32_16x16x32_bf16 v[136:139], a[16:19], a[72:75], v[136:139]
    v_mfma_f32_16x16x32_bf16 v[168:171], a[16:19], a[80:83], v[168:171]
    ds_read_b64_tr_b16 a[156:157], v40 offset:520
    v_mfma_f32_16x16x32_bf16 v[168:171], a[20:23], a[84:87], v[168:171]
    ds_read_b64_tr_b16 a[158:159], v40 offset:776
    v_mfma_f32_16x16x32_bf16 v[200:203], a[20:23], a[92:95], v[200:203]
    v_mfma_f32_16x16x32_bf16 v[200:203], a[16:19], a[88:91], v[200:203]
    ds_read_b64_tr_b16 a[160:161], v40 offset:64
    v_mfma_f32_16x16x32_bf16 v[232:235], a[16:19], a[96:99], v[232:235]
    ds_read_b64_tr_b16 a[162:163], v40 offset:320
    v_mfma_f32_16x16x32_bf16 v[232:235], a[20:23], a[100:103], v[232:235]
    v_mfma_f32_16x16x32_bf16 v[108:111], a[28:31], a[68:71], v[108:111]
    s_add_u32 m0, s60, 33888
    ds_read_b64_tr_b16 a[164:165], v40 offset:576
    v_mfma_f32_16x16x32_bf16 v[108:111], a[24:27], a[64:67], v[108:111]
    buffer_load_dwordx4 v88, s[28:31], s48 offen offset:3072 nt lds
    v_mfma_f32_16x16x32_bf16 v[140:143], a[24:27], a[72:75], v[140:143]
    ds_read_b64_tr_b16 a[166:167], v40 offset:832
    v_mfma_f32_16x16x32_bf16 v[140:143], a[28:31], a[76:79], v[140:143]
    ds_read_b64_tr_b16 a[168:169], v40 offset:72
    v_mfma_f32_16x16x32_bf16 v[172:175], a[28:31], a[84:87], v[172:175]
    v_mfma_f32_16x16x32_bf16 v[172:175], a[24:27], a[80:83], v[172:175]
    ds_read_b64_tr_b16 a[170:171], v40 offset:328
    v_mfma_f32_16x16x32_bf16 v[204:207], a[24:27], a[88:91], v[204:207]
    ds_read_b64_tr_b16 a[172:173], v40 offset:584
    v_mfma_f32_16x16x32_bf16 v[204:207], a[28:31], a[92:95], v[204:207]
    v_mfma_f32_16x16x32_bf16 v[236:239], a[28:31], a[100:103], v[236:239]
    ds_read_b64_tr_b16 a[174:175], v40 offset:840
    v_mfma_f32_16x16x32_bf16 v[236:239], a[24:27], a[96:99], v[236:239]
    ds_read_b64_tr_b16 a[176:177], v41 offset:0
    v_mfma_f32_16x16x32_bf16 v[112:115], a[32:35], a[64:67], v[112:115]
    v_mfma_f32_16x16x32_bf16 v[112:115], a[36:39], a[68:71], v[112:115]
    ds_read_b64_tr_b16 a[178:179], v41 offset:256
    v_mfma_f32_16x16x32_bf16 v[144:147], a[36:39], a[76:79], v[144:147]
    ds_read_b64_tr_b16 a[180:181], v41 offset:512
    v_mfma_f32_16x16x32_bf16 v[144:147], a[32:35], a[72:75], v[144:147]
    v_mfma_f32_16x16x32_bf16 v[176:179], a[32:35], a[80:83], v[176:179]
    ds_read_b64_tr_b16 a[182:183], v41 offset:768
    v_mfma_f32_16x16x32_bf16 v[176:179], a[36:39], a[84:87], v[176:179]
    ds_read_b64_tr_b16 a[184:185], v41 offset:8
    v_mfma_f32_16x16x32_bf16 v[208:211], a[36:39], a[92:95], v[208:211]
    v_mfma_f32_16x16x32_bf16 v[208:211], a[32:35], a[88:91], v[208:211]
    ds_read_b64_tr_b16 a[186:187], v41 offset:264
    v_mfma_f32_16x16x32_bf16 v[116:119], a[40:43], a[64:67], v[116:119]
    s_add_u32 s48, s71, 16384
    ds_read_b64_tr_b16 a[188:189], v41 offset:520
    v_mfma_f32_16x16x32_bf16 v[116:119], a[44:47], a[68:71], v[116:119]
    s_and_b32 s48, s48, 0x3ffff
    v_mfma_f32_16x16x32_bf16 v[148:151], a[44:47], a[76:79], v[148:151]
    s_add_u32 m0, s60, 50688
    ds_read_b64_tr_b16 a[190:191], v41 offset:776
    v_mfma_f32_16x16x32_bf16 v[148:151], a[40:43], a[72:75], v[148:151]
    buffer_load_dwordx4 v88, s[32:35], s48 offen offset:0 nt lds
    v_mfma_f32_16x16x32_bf16 v[180:183], a[40:43], a[80:83], v[180:183]
    ds_read_b64_tr_b16 a[192:193], v41 offset:64
    v_mfma_f32_16x16x32_bf16 v[180:183], a[44:47], a[84:87], v[180:183]
    ds_read_b64_tr_b16 a[194:195], v41 offset:320
    v_mfma_f32_16x16x32_bf16 v[212:215], a[44:47], a[92:95], v[212:215]
    ds_read_b64_tr_b16 a[196:197], v41 offset:576
    v_mfma_f32_16x16x32_bf16 v[212:215], a[40:43], a[88:91], v[212:215]
    v_mfma_f32_16x16x32_bf16 v[120:123], a[48:51], a[64:67], v[120:123]
    ds_read_b64_tr_b16 a[198:199], v41 offset:832
    v_mfma_f32_16x16x32_bf16 v[120:123], a[52:55], a[68:71], v[120:123]
    ds_read_b64_tr_b16 a[200:201], v41 offset:72
    v_mfma_f32_16x16x32_bf16 v[152:155], a[52:55], a[76:79], v[152:155]
    v_mfma_f32_16x16x32_bf16 v[152:155], a[48:51], a[72:75], v[152:155]
    ds_read_b64_tr_b16 a[202:203], v41 offset:328
    v_mfma_f32_16x16x32_bf16 v[184:187], a[48:51], a[80:83], v[184:187]
    ds_read_b64_tr_b16 a[204:205], v41 offset:584
    v_mfma_f32_16x16x32_bf16 v[184:187], a[52:55], a[84:87], v[184:187]
    v_mfma_f32_16x16x32_bf16 v[216:219], a[52:55], a[92:95], v[216:219]
    ds_read_b64_tr_b16 a[206:207], v41 offset:840
    v_mfma_f32_16x16x32_bf16 v[216:219], a[48:51], a[88:91], v[216:219]
    v_mfma_f32_16x16x32_bf16 v[124:127], a[56:59], a[64:67], v[124:127]
    v_mfma_f32_16x16x32_bf16 v[124:127], a[60:63], a[68:71], v[124:127]
    v_mfma_f32_16x16x32_bf16 v[156:159], a[60:63], a[76:79], v[156:159]
    v_mfma_f32_16x16x32_bf16 v[156:159], a[56:59], a[72:75], v[156:159]
    v_mfma_f32_16x16x32_bf16 v[188:191], a[56:59], a[80:83], v[188:191]
    v_mfma_f32_16x16x32_bf16 v[188:191], a[60:63], a[84:87], v[188:191]
    v_mfma_f32_16x16x32_bf16 v[220:223], a[60:63], a[92:95], v[220:223]
    s_add_u32 m0, s60, 50720
    v_mfma_f32_16x16x32_bf16 v[220:223], a[56:59], a[88:91], v[220:223]
    s_waitcnt lgkmcnt(0)
    buffer_load_dwordx4 v88, s[32:35], s48 offen offset:1024 nt lds
    s_waitcnt lgkmcnt(0)
    s_barrier
    s_cmp_eq_u32 s41, 0
    s_cbranch_scc1 L_q7even
    v_mfma_f32_16x16x32_bf16 v[224:227], a[144:147], a[240:243], v[224:227]
    v_mfma_f32_16x16x32_bf16 v[224:227], a[148:151], a[244:247], v[224:227]
    v_mfma_f32_16x16x32_bf16 v[228:231], a[156:159], a[244:247], v[228:231]
    v_mfma_f32_16x16x32_bf16 v[228:231], a[152:155], a[240:243], v[228:231]
    v_mfma_f32_16x16x32_bf16 v[232:235], a[160:163], a[240:243], v[232:235]
    v_mfma_f32_16x16x32_bf16 v[232:235], a[164:167], a[244:247], v[232:235]
    v_mfma_f32_16x16x32_bf16 v[236:239], a[172:175], a[244:247], v[236:239]
    v_mfma_f32_16x16x32_bf16 v[236:239], a[168:171], a[240:243], v[236:239]
    v_mfma_f32_16x16x32_bf16 v[96:99], a[144:147], a[208:211], v[96:99]
    v_mfma_f32_16x16x32_bf16 v[96:99], a[148:151], a[212:215], v[96:99]
    v_mul_f32 v224, s70, v224
    v_mul_f32 v225, s70, v225
    v_mfma_f32_16x16x32_bf16 v[100:103], a[156:159], a[212:215], v[100:103]
    v_mul_f32 v226, s70, v226
    v_mul_f32 v227, s70, v227
    v_mfma_f32_16x16x32_bf16 v[100:103], a[152:155], a[208:211], v[100:103]
    v_cvt_pk_bf16_f32 v52, v224, v225
    v_cvt_pk_bf16_f32 v53, v226, v227
    v_mfma_f32_16x16x32_bf16 v[104:107], a[160:163], a[208:211], v[104:107]
    v_mul_f32 v228, s70, v228
    v_mul_f32 v229, s70, v229
    v_mfma_f32_16x16x32_bf16 v[104:107], a[164:167], a[212:215], v[104:107]
    v_mul_f32 v230, s70, v230
    v_mul_f32 v231, s70, v231
    v_mfma_f32_16x16x32_bf16 v[108:111], a[172:175], a[212:215], v[108:111]
    v_cvt_pk_bf16_f32 v54, v228, v229
    v_cvt_pk_bf16_f32 v55, v230, v231
    v_mfma_f32_16x16x32_bf16 v[108:111], a[168:171], a[208:211], v[108:111]
    v_mul_f32 v232, s70, v232
    v_mul_f32 v233, s70, v233
    v_mfma_f32_16x16x32_bf16 v[112:115], a[176:179], a[208:211], v[112:115]
    v_mul_f32 v234, s70, v234
    v_mul_f32 v235, s70, v235
    v_mfma_f32_16x16x32_bf16 v[112:115], a[180:183], a[212:215], v[112:115]
    v_cvt_pk_bf16_f32 v56, v232, v233
    v_cvt_pk_bf16_f32 v57, v234, v235
    v_mfma_f32_16x16x32_bf16 v[116:119], a[188:191], a[212:215], v[116:119]
    s_add_u32 m0, s60, 50752
    v_mul_f32 v236, s70, v236
    v_mul_f32 v237, s70, v237
    v_mfma_f32_16x16x32_bf16 v[116:119], a[184:187], a[208:211], v[116:119]
    buffer_load_dwordx4 v88, s[32:35], s48 offen offset:2048 nt lds
    v_mfma_f32_16x16x32_bf16 v[120:123], a[192:195], a[208:211], v[120:123]
    v_mul_f32 v238, s70, v238
    v_mul_f32 v239, s70, v239
    v_mfma_f32_16x16x32_bf16 v[120:123], a[196:199], a[212:215], v[120:123]
    v_cvt_pk_bf16_f32 v58, v236, v237
    v_cvt_pk_bf16_f32 v59, v238, v239
    v_mfma_f32_16x16x32_bf16 v[124:127], a[204:207], a[212:215], v[124:127]
    ds_write_b128 v94, v[52:55] offset:0
    s_nop 0
    v_mfma_f32_16x16x32_bf16 v[124:127], a[200:203], a[208:211], v[124:127]
    ds_write_b128 v94, v[56:59] offset:1024
    s_nop 0
    v_mfma_f32_16x16x32_bf16 v[128:131], a[144:147], a[216:219], v[128:131]
    s_branch L_pg2
    .p2align 12
L_stub2:
    s_branch L_stub6
L_pg2:
    v_mul_f32 v96, s70, v96
    v_mul_f32 v97, s70, v97
    v_mfma_f32_16x16x32_bf16 v[128:131], a[148:151], a[220:223], v[128:131]
    v_mul_f32 v98, s70, v98
    v_mul_f32 v99, s70, v99
    v_mfma_f32_16x16x32_bf16 v[132:135], a[156:159], a[220:223], v[132:135]
    v_cvt_pk_bf16_f32 v96, v96, v97
    v_cvt_pk_bf16_f32 v97, v98, v99
    v_mfma_f32_16x16x32_bf16 v[132:135], a[152:155], a[216:219], v[132:135]
    v_accvgpr_write_b32 a8, v96
    v_accvgpr_write_b32 a9, v97
    v_mfma_f32_16x16x32_bf16 v[136:139], a[160:163], a[216:219], v[136:139]
    v_mul_f32 v100, s70, v100
    v_mul_f32 v101, s70, v101
    v_mfma_f32_16x16x32_bf16 v[136:139], a[164:167], a[220:223], v[136:139]
    v_mul_f32 v102, s70, v102
    v_mul_f32 v103, s70, v103
    v_mfma_f32_16x16x32_bf16 v[140:143], a[172:175], a[220:223], v[140:143]
    v_cvt_pk_bf16_f32 v100, v100, v101
    v_cvt_pk_bf16_f32 v101, v102, v103
    v_mfma_f32_16x16x32_bf16 v[140:143], a[168:171], a[216:219], v[140:143]
    v_accvgpr_write_b32 a10, v100
    v_accvgpr_write_b32 a11, v101
    v_mfma_f32_16x16x32_bf16 v[144:147], a[176:179], a[216:219], v[144:147]
    v_mul_f32 v104, s70, v104
    v_mul_f32 v105, s70, v105
    v_mfma_f32_16x16x32_bf16 v[144:147], a[180:183], a[220:223], v[144:147]
    v_mul_f32 v106, s70, v106
    v_mul_f32 v107, s70, v107
    v_mfma_f32_16x16x32_bf16 v[148:151], a[188:191], a[220:223], v[148:151]
    v_cvt_pk_bf16_f32 v104, v104, v105
    v_cvt_pk_bf16_f32 v105, v106, v107
    v_mfma_f32_16x16x32_bf16 v[148:151], a[184:187], a[216:219], v[148:151]
    v_accvgpr_write_b32 a12, v104
    v_accvgpr_write_b32 a13, v105
    v_mfma_f32_16x16x32_bf16 v[152:155], a[192:195], a[216:219], v[152:155]
    v_mul_f32 v108, s70, v108
    v_mul_f32 v109, s70, v109
    v_mfma_f32_16x16x32_bf16 v[152:155], a[196:199], a[220:223], v[152:155]
    v_mul_f32 v110, s70, v110
    v_mul_f32 v111, s70, v111
    v_mfma_f32_16x16x32_bf16 v[156:159], a[204:207], a[220:223], v[156:159]
    s_add_u32 m0, s60, 50784
    v_cvt_pk_bf16_f32 v108, v108, v109
    v_cvt_pk_bf16_f32 v109, v110, v111
    v_mfma_f32_16x16x32_bf16 v[156:159], a[200:203], a[216:219], v[156:159]
    buffer_load_dwordx4 v88, s[32:35], s48 offen offset:3072 nt lds
    v_mfma_f32_16x16x32_bf16 v[160:163], a[144:147], a[224:227], v[160:163]
    v_accvgpr_write_b32 a14, v108
    v_accvgpr_write_b32 a15, v109
    v_mfma_f32_16x16x32_bf16 v[160:163], a[148:151], a[228:231], v[160:163]
    v_mul_f32 v112, s70, v112
    v_mul_f32 v113, s70, v113
    v_mfma_f32_16x16x32_bf16 v[164:167], a[156:159], a[228:231], v[164:167]
    v_mul_f32 v114, s70, v114
    v_mul_f32 v115, s70, v115
    v_mfma_f32_16x16x32_bf16 v[164:167], a[152:155], a[224:227], v[164:167]
    v_cvt_pk_bf16_f32 v112, v112, v113
    v_cvt_pk_bf16_f32 v113, v114, v115
    v_mfma_f32_16x16x32_bf16 v[168:171], a[160:163], a[224:227], v[168:171]
    v_accvgpr_write_b32 a0, v112
    v_accvgpr_write_b32 a1, v113
    v_mfma_f32_16x16x32_bf16 v[168:171], a[164:167], a[228:231], v[168:171]
    v_mul_f32 v116, s70, v116
    v_mul_f32 v117, s70, v117
    v_mfma_f32_16x16x32_bf16 v[172:175], a[172:175], a[228:231], v[172:175]
    v_mul_f32 v118, s70, v118
    v_mul_f32 v119, s70, v119
    v_mfma_f32_16x16x32_bf16 v[172:175], a[168:171], a[224:227], v[172:175]
    v_cvt_pk_bf16_f32 v116, v116, v117
    v_cvt_pk_bf16_f32 v117, v118, v119
    v_mfma_f32_16x16x32_bf16 v[176:179], a[176:179], a[224:227], v[176:179]
    v_accvgpr_write_b32 a2, v116
    v_accvgpr_write_b32 a3, v117
    v_mfma_f32_16x16x32_bf16 v[176:179], a[180:183], a[228:231], v[176:179]
    v_mul_f32 v120, s70, v120
    v_mul_f32 v121, s70, v121
    v_mfma_f32_16x16x32_bf16 v[180:183], a[188:191], a[228:231], v[180:183]
    v_mul_f32 v122, s70, v122
    v_mul_f32 v123, s70, v123
    v_mfma_f32_16x16x32_bf16 v[180:183], a[184:187], a[224:227], v[180:183]
    v_cvt_pk_bf16_f32 v120, v120, v121
    v_cvt_pk_bf16_f32 v121, v122, v123
    v_mfma_f32_16x16x32_bf16 v[184:187], a[192:195], a[224:227], v[184:187]
    v_accvgpr_write_b32 a4, v120
    v_accvgpr_write_b32 a5, v121
    v_mfma_f32_16x16x32_bf16 v[184:187], a[196:199], a[228:231], v[184:187]
    v_mul_f32 v124, s70, v124
    v_mul_f32 v125, s70, v125
    v_mfma_f32_16x16x32_bf16 v[188:191], a[204:207], a[228:231], v[188:191]
    v_mul_f32 v126, s70, v126
    v_mul_f32 v127, s70, v127
    v_mfma_f32_16x16x32_bf16 v[188:191], a[200:203], a[224:227], v[188:191]
    s_waitcnt vmcnt(8) lgkmcnt(0)
    v_cvt_pk_bf16_f32 v124, v124, v125
    v_cvt_pk_bf16_f32 v125, v126, v127
    v_mfma_f32_16x16x32_bf16 v[192:195], a[144:147], a[232:235], v[192:195]
    s_barrier
    ds_read_b128 a[80:83], v10 offset:0
    ds_read_b128 a[84:87], v10 offset:64
    v_mfma_f32_16x16x32_bf16 v[192:195], a[148:151], a[236:239], v[192:195]
    ds_read_b128 a[88:91], v10 offset:128
    ds_read_b128 a[92:95], v10 offset:192
    v_mfma_f32_16x16x32_bf16 v[196:199], a[156:159], a[236:239], v[196:199]
    ds_read_b128 a[96:99], v10 offset:256
    ds_read_b128 a[100:103], v10 offset:320
    v_mfma_f32_16x16x32_bf16 v[196:199], a[152:155], a[232:235], v[196:199]
    ds_read_b128 a[104:107], v10 offset:384
    ds_read_b128 a[108:111], v10 offset:448
    v_mfma_f32_16x16x32_bf16 v[200:203], a[160:163], a[232:235], v[200:203]
    ds_read_b128 a[64:67], v95 offset:0
    ds_read_b128 a[68:71], v95 offset:1024
    v_mfma_f32_16x16x32_bf16 v[200:203], a[164:167], a[236:239], v[200:203]
    ds_read_b128 a[72:75], v95 offset:2048
    ds_read_b128 a[76:79], v95 offset:3072
    v_mfma_f32_16x16x32_bf16 v[204:207], a[172:175], a[236:239], v[204:207]
    v_accvgpr_write_b32 a6, v124
    v_accvgpr_write_b32 a7, v125
    v_mfma_f32_16x16x32_bf16 v[204:207], a[168:171], a[232:235], v[204:207]
    v_mul_f32 v128, s70, v128
    v_mul_f32 v129, s70, v129
    v_mfma_f32_16x16x32_bf16 v[208:211], a[176:179], a[232:235], v[208:211]
    v_mul_f32 v130, s70, v130
    v_mul_f32 v131, s70, v131
    v_mfma_f32_16x16x32_bf16 v[208:211], a[180:183], a[236:239], v[208:211]
    v_cvt_pk_bf16_f32 v128, v128, v129
    v_cvt_pk_bf16_f32 v129, v130, v131
    v_mfma_f32_16x16x32_bf16 v[212:215], a[188:191], a[236:239], v[212:215]
    v_accvgpr_write_b32 a24, v128
    v_accvgpr_write_b32 a25, v129
    v_mfma_f32_16x16x32_bf16 v[212:215], a[184:187], a[232:235], v[212:215]
    v_mul_f32 v132, s70, v132
    v_mul_f32 v133, s70, v133
    v_mfma_f32_16x16x32_bf16 v[216:219], a[192:195], a[232:235], v[216:219]
    v_mul_f32 v134, s70, v134
    v_mul_f32 v135, s70, v135
    v_mfma_f32_16x16x32_bf16 v[216:219], a[196:199], a[236:239], v[216:219]
    v_cvt_pk_bf16_f32 v132, v132, v133
    v_cvt_pk_bf16_f32 v133, v134, v135
    v_mfma_f32_16x16x32_bf16 v[220:223], a[204:207], a[236:239], v[220:223]
    v_accvgpr_write_b32 a26, v132
    v_accvgpr_write_b32 a27, v133
    v_mfma_f32_16x16x32_bf16 v[220:223], a[200:203], a[232:235], v[220:223]
    s_waitcnt lgkmcnt(0)
    v_mul_f32 v136, s70, v136
    v_mul_f32 v137, s70, v137
    v_mfma_f32_16x16x32_bf16 v[64:67], a[80:83], a[0:3], 0
    ds_read_b128 a[144:147], v11 offset:0
    ds_read_b128 a[148:151], v11 offset:64
    v_mfma_f32_16x16x32_bf16 v[64:67], a[84:87], a[4:7], v[64:67]
    ds_read_b128 a[152:155], v11 offset:128
    ds_read_b128 a[156:159], v11 offset:192
    v_mfma_f32_16x16x32_bf16 v[64:67], a[88:91], a[8:11], v[64:67]
    ds_read_b128 a[160:163], v11 offset:256
    ds_read_b128 a[164:167], v11 offset:320
    v_mfma_f32_16x16x32_bf16 v[64:67], a[92:95], a[12:15], v[64:67]
    ds_read_b128 a[168:171], v11 offset:384
    ds_read_b128 a[172:175], v11 offset:448
    v_mfma_f32_16x16x32_bf16 v[68:71], a[108:111], a[12:15], 0
    v_mul_f32 v138, s70, v138
    v_mul_f32 v139, s70, v139
    v_mfma_f32_16x16x32_bf16 v[68:71], a[104:107], a[8:11], v[68:71]
    v_cvt_pk_bf16_f32 v136, v136, v137
    v_cvt_pk_bf16_f32 v137, v138, v139
    v_mfma_f32_16x16x32_bf16 v[68:71], a[100:103], a[4:7], v[68:71]
    v_accvgpr_write_b32 a28, v136
    v_accvgpr_write_b32 a29, v137
    v_mfma_f32_16x16x32_bf16 v[68:71], a[96:99], a[0:3], v[68:71]
    v_mul_f32 v140, s70, v140
    v_mul_f32 v141, s70, v141
    v_mul_f32 v142, s70, v142
    v_mul_f32 v143, s70, v143
    v_cvt_pk_bf16_f32 v140, v140, v141
    v_cvt_pk_bf16_f32 v141, v142, v143
    v_accvgpr_write_b32 a30, v140
    v_accvgpr_write_b32 a31, v141
    v_mul_f32 v144, s70, v144
    v_mul_f32 v145, s70, v145
    v_mul_f32 v146, s70, v146
    v_mul_f32 v147, s70, v147
    v_cvt_pk_bf16_f32 v144, v144, v145
    v_cvt_pk_bf16_f32 v145, v146, v147
    v_accvgpr_write_b32 a16, v144
    v_accvgpr_write_b32 a17, v145
    v_mul_f32 v148, s70, v148
    v_mul_f32 v149, s70, v149
    v_mul_f32 v150, s70, v150
    v_mul_f32 v151, s70, v151
    v_cvt_pk_bf16_f32 v148, v148, v149
    v_cvt_pk_bf16_f32 v149, v150, v151
    v_accvgpr_write_b32 a18, v148
    v_accvgpr_write_b32 a19, v149
    v_mul_f32 v152, s70, v152
    v_mul_f32 v153, s70, v153
    v_mul_f32 v154, s70, v154
    v_mul_f32 v155, s70, v155
    v_cvt_pk_bf16_f32 v152, v152, v153
    v_cvt_pk_bf16_f32 v153, v154, v155
    v_accvgpr_write_b32 a20, v152
    v_accvgpr_write_b32 a21, v153
    v_mul_f32 v156, s70, v156
    v_mul_f32 v157, s70, v157
    v_mul_f32 v158, s70, v158
    v_mul_f32 v159, s70, v159
    v_cvt_pk_bf16_f32 v156, v156, v157
    v_cvt_pk_bf16_f32 v157, v158, v159
    v_accvgpr_write_b32 a22, v156
    v_accvgpr_write_b32 a23, v157
    v_mul_f32 v160, s70, v160
    v_mul_f32 v161, s70, v161
    v_mul_f32 v162, s70, v162
    v_mul_f32 v163, s70, v163
    v_cvt_pk_bf16_f32 v28, v160, v161
    v_cvt_pk_bf16_f32 v29, v162, v163
    v_mul_f32 v164, s70, v164
    v_mul_f32 v165, s70, v165
    v_mul_f32 v166, s70, v166
    v_mul_f32 v167, s70, v167
    v_cvt_pk_bf16_f32 v30, v164, v165
    v_cvt_pk_bf16_f32 v31, v166, v167
    v_mul_f32 v168, s70, v168
    v_mul_f32 v169, s70, v169
    v_mul_f32 v170, s70, v170
    v_mul_f32 v171, s70, v171
    v_cvt_pk_bf16_f32 v32, v168, v169
    v_cvt_pk_bf16_f32 v33, v170, v171
    v_mul_f32 v172, s70, v172
    v_mul_f32 v173, s70, v173
    v_mul_f32 v174, s70, v174
    v_mul_f32 v175, s70, v175
    v_cvt_pk_bf16_f32 v34, v172, v173
    v_cvt_pk_bf16_f32 v35, v174, v175
    v_mul_f32 v176, s70, v176
    v_mul_f32 v177, s70, v177
    v_mul_f32 v178, s70, v178
    v_mul_f32 v179, s70, v179
    v_cvt_pk_bf16_f32 v20, v176, v177
    v_cvt_pk_bf16_f32 v21, v178, v179
    v_mul_f32 v180, s70, v180
    v_mul_f32 v181, s70, v181
    v_mul_f32 v182, s70, v182
    v_mul_f32 v183, s70, v183
    v_cvt_pk_bf16_f32 v22, v180, v181
    v_cvt_pk_bf16_f32 v23, v182, v183
    v_mul_f32 v184, s70, v184
    v_mul_f32 v185, s70, v185
    v_mul_f32 v186, s70, v186
    v_mul_f32 v187, s70, v187
    v_cvt_pk_bf16_f32 v24, v184, v185
    v_cvt_pk_bf16_f32 v25, v186, v187
    v_mul_f32 v188, s70, v188
    v_mul_f32 v189, s70, v189
    v_mul_f32 v190, s70, v190
    v_mul_f32 v191, s70, v191
    v_cvt_pk_bf16_f32 v26, v188, v189
    v_cvt_pk_bf16_f32 v27, v190, v191
    v_mul_f32 v192, s70, v192
    v_mul_f32 v193, s70, v193
    v_mul_f32 v194, s70, v194
    v_mul_f32 v195, s70, v195
    v_cvt_pk_bf16_f32 v44, v192, v193
    v_cvt_pk_bf16_f32 v45, v194, v195
    v_mul_f32 v196, s70, v196
    v_mul_f32 v197, s70, v197
    v_mul_f32 v198, s70, v198
    v_mul_f32 v199, s70, v199
    v_cvt_pk_bf16_f32 v46, v196, v197
    v_cvt_pk_bf16_f32 v47, v198, v199
    v_mul_f32 v200, s70, v200
    v_mul_f32 v201, s70, v201
    v_mul_f32 v202, s70, v202
    v_mul_f32 v203, s70, v203
    v_cvt_pk_bf16_f32 v48, v200, v201
    v_cvt_pk_bf16_f32 v49, v202, v203
    v_mul_f32 v204, s70, v204
    v_mul_f32 v205, s70, v205
    v_mul_f32 v206, s70, v206
    v_mul_f32 v207, s70, v207
    v_cvt_pk_bf16_f32 v50, v204, v205
    v_cvt_pk_bf16_f32 v51, v206, v207
    v_mul_f32 v208, s70, v208
    v_mul_f32 v209, s70, v209
    v_mul_f32 v210, s70, v210
    v_mul_f32 v211, s70, v211
    v_cvt_pk_bf16_f32 v36, v208, v209
    v_cvt_pk_bf16_f32 v37, v210, v211
    v_mul_f32 v212, s70, v212
    v_mul_f32 v213, s70, v213
    v_mul_f32 v214, s70, v214
    v_mul_f32 v215, s70, v215
    v_cvt_pk_bf16_f32 v38, v212, v213
    v_cvt_pk_bf16_f32 v39, v214, v215
    v_mul_f32 v216, s70, v216
    v_mul_f32 v217, s70, v217
    v_mul_f32 v218, s70, v218
    v_mul_f32 v219, s70, v219
    v_cvt_pk_bf16_f32 v40, v216, v217
    v_cvt_pk_bf16_f32 v41, v218, v219
    v_mul_f32 v220, s70, v220
    v_mul_f32 v221, s70, v221
    v_mul_f32 v222, s70, v222
    v_mul_f32 v223, s70, v223
    v_cvt_pk_bf16_f32 v42, v220, v221
    v_cvt_pk_bf16_f32 v43, v222, v223
    s_branch L_q7done
    .p2align 6
L_stub3:
    s_branch L_stub7
L_pg3:
L_q7even:
    v_mfma_f32_16x16x32_bf16 v[224:227], a[144:147], a[240:243], v[224:227]
    v_mfma_f32_16x16x32_bf16 v[224:227], a[148:151], a[244:247], v[224:227]
    v_mfma_f32_16x16x32_bf16 v[228:231], a[156:159], a[244:247], v[228:231]
    v_mfma_f32_16x16x32_bf16 v[228:231], a[152:155], a[240:243], v[228:231]
    v_mfma_f32_16x16x32_bf16 v[232:235], a[160:163], a[240:243], v[232:235]
    v_mfma_f32_16x16x32_bf16 v[232:235], a[164:167], a[244:247], v[232:235]
    v_mfma_f32_16x16x32_bf16 v[236:239], a[172:175], a[244:247], v[236:239]
    v_mfma_f32_16x16x32_bf16 v[236:239], a[168:171], a[240:243], v[236:239]
    v_mfma_f32_16x16x32_bf16 v[96:99], a[144:147], a[208:211], v[96:99]
    v_mfma_f32_16x16x32_bf16 v[96:99], a[148:151], a[212:215], v[96:99]
    v_mul_f32 v224, s70, v224
    v_mul_f32 v225, s70, v225
    v_mfma_f32_16x16x32_bf16 v[100:103], a[156:159], a[212:215], v[100:103]
    v_mul_f32 v226, s70, v226
    v_mul_f32 v227, s70, v227
    v_mfma_f32_16x16x32_bf16 v[100:103], a[152:155], a[208:211], v[100:103]
    v_cvt_pk_bf16_f32 v52, v224, v225
    v_cvt_pk_bf16_f32 v53, v226, v227
    v_mfma_f32_16x16x32_bf16 v[104:107], a[160:163], a[208:211], v[104:107]
    v_mul_f32 v228, s70, v228
    v_mul_f32 v229, s70, v229
    v_mfma_f32_16x16x32_bf16 v[104:107], a[164:167], a[212:215], v[104:107]
    v_mul_f32 v230, s70, v230
    v_mul_f32 v231, s70, v231
    v_mfma_f32_16x16x32_bf16 v[108:111], a[172:175], a[212:215], v[108:111]
    v_cvt_pk_bf16_f32 v54, v228, v229
    v_cvt_pk_bf16_f32 v55, v230, v231
    v_mfma_f32_16x16x32_bf16 v[108:111], a[168:171], a[208:211], v[108:111]
    v_mul_f32 v232, s70, v232
    v_mul_f32 v233, s70, v233
    v_mfma_f32_16x16x32_bf16 v[112:115], a[176:179], a[208:211], v[112:115]
    v_mul_f32 v234, s70, v234
    v_mul_f32 v235, s70, v235
    v_mfma_f32_16x16x32_bf16 v[112:115], a[180:183], a[212:215], v[112:115]
    v_cvt_pk_bf16_f32 v56, v232, v233
    v_cvt_pk_bf16_f32 v57, v234, v235
    v_mfma_f32_16x16x32_bf16 v[116:119], a[188:191], a[212:215], v[116:119]
    s_add_u32 m0, s60, 50752
    v_mul_f32 v236, s70, v236
    v_mul_f32 v237, s70, v237
    v_mfma_f32_16x16x32_bf16 v[116:119], a[184:187], a[208:211], v[116:119]
    buffer_load_dwordx4 v88, s[32:35], s48 offen offset:2048 nt lds
    v_mfma_f32_16x16x32_bf16 v[120:123], a[192:195], a[208:211], v[120:123]
    v_mul_f32 v238, s70, v238
    v_mul_f32 v239, s70, v239
    v_mfma_f32_16x16x32_bf16 v[120:123], a[196:199], a[212:215], v[120:123]
    v_cvt_pk_bf16_f32 v58, v236, v237
    v_cvt_pk_bf16_f32 v59, v238, v239
    v_mfma_f32_16x16x32_bf16 v[124:127], a[204:207], a[212:215], v[124:127]
    ds_write_b128 v94, v[52:55] offset:0
    s_nop 0
    v_mfma_f32_16x16x32_bf16 v[124:127], a[200:203], a[208:211], v[124:127]
    ds_write_b128 v94, v[56:59] offset:1024
    s_nop 0
    v_mfma_f32_16x16x32_bf16 v[128:131], a[144:147], a[216:219], v[128:131]
    v_mul_f32 v96, s70, v96
    v_mul_f32 v97, s70, v97
    v_mfma_f32_16x16x32_bf16 v[128:131], a[148:151], a[220:223], v[128:131]
    v_mul_f32 v98, s70, v98
    v_mul_f32 v99, s70, v99
    v_mfma_f32_16x16x32_bf16 v[132:135], a[156:159], a[220:223], v[132:135]
    v_cvt_pk_bf16_f32 v96, v96, v97
    v_cvt_pk_bf16_f32 v97, v98, v99
    v_mfma_f32_16x16x32_bf16 v[132:135], a[152:155], a[216:219], v[132:135]
    v_accvgpr_write_b32 a0, v96
    v_accvgpr_write_b32 a1, v97
    v_mfma_f32_16x16x32_bf16 v[136:139], a[160:163], a[216:219], v[136:139]
    v_mul_f32 v100, s70, v100
    v_mul_f32 v101, s70, v101
    v_mfma_f32_16x16x32_bf16 v[136:139], a[164:167], a[220:223], v[136:139]
    v_mul_f32 v102, s70, v102
    v_mul_f32 v103, s70, v103
    v_mfma_f32_16x16x32_bf16 v[140:143], a[172:175], a[220:223], v[140:143]
    v_cvt_pk_bf16_f32 v100, v100, v101
    v_cvt_pk_bf16_f32 v101, v102, v103
    v_mfma_f32_16x16x32_bf16 v[140:143], a[168:171], a[216:219], v[140:143]
    v_accvgpr_write_b32 a2, v100
    v_accvgpr_write_b32 a3, v101
    v_mfma_f32_16x16x32_bf16 v[144:147], a[176:179], a[216:219], v[144:147]
    v_mul_f32 v104, s70, v104
    v_mul_f32 v105, s70, v105
    v_mfma_f32_16x16x32_bf16 v[144:147], a[180:183], a[220:223], v[144:147]
    v_mul_f32 v106, s70, v106
    v_mul_f32 v107, s70, v107
    v_mfma_f32_16x16x32_bf16 v[148:151], a[188:191], a[220:223], v[148:151]
    v_cvt_pk_bf16_f32 v104, v104, v105
    v_cvt_pk_bf16_f32 v105, v106, v107
    v_mfma_f32_16x16x32_bf16 v[148:151], a[184:187], a[216:219], v[148:151]
    v_accvgpr_write_b32 a4, v104
    v_accvgpr_write_b32 a5, v105
    v_mfma_f32_16x16x32_bf16 v[152:155], a[192:195], a[216:219], v[152:155]
    v_mul_f32 v108, s70, v108
    v_mul_f32 v109, s70, v109
    v_mfma_f32_16x16x32_bf16 v[152:155], a[196:199], a[220:223], v[152:155]
    v_mul_f32 v110, s70, v110
    v_mul_f32 v111, s70, v111
    v_mfma_f32_16x16x32_bf16 v[156:159], a[204:207], a[220:223], v[156:159]
    s_add_u32 m0, s60, 50784
    v_cvt_pk_bf16_f32 v108, v108, v109
    v_cvt_pk_bf16_f32 v109, v110, v111
    v_mfma_f32_16x16x32_bf16 v[156:159], a[200:203], a[216:219], v[156:159]
    buffer_load_dwordx4 v88, s[32:35], s48 offen offset:3072 nt lds
    v_mfma_f32_16x16x32_bf16 v[160:163], a[144:147], a[224:227], v[160:163]
    v_accvgpr_write_b32 a6, v108
    v_accvgpr_write_b32 a7, v109
    v_mfma_f32_16x16x32_bf16 v[160:163], a[148:151], a[228:231], v[160:163]
    v_mul_f32 v112, s70, v112
    v_mul_f32 v113, s70, v113
    v_mfma_f32_16x16x32_bf16 v[164:167], a[156:159], a[228:231], v[164:167]
    v_mul_f32 v114, s70, v114
    v_mul_f32 v115, s70, v115
    v_mfma_f32_16x16x32_bf16 v[164:167], a[152:155], a[224:227], v[164:167]
    v_cvt_pk_bf16_f32 v112, v112, v113
    v_cvt_pk_bf16_f32 v113, v114, v115
    v_mfma_f32_16x16x32_bf16 v[168:171], a[160:163], a[224:227], v[168:171]
    v_accvgpr_write_b32 a8, v112
    v_accvgpr_write_b32 a9, v113
    v_mfma_f32_16x16x32_bf16 v[168:171], a[164:167], a[228:231], v[168:171]
    v_mul_f32 v116, s70, v116
    v_mul_f32 v117, s70, v117
    v_mfma_f32_16x16x32_bf16 v[172:175], a[172:175], a[228:231], v[172:175]
    v_mul_f32 v118, s70, v118
    v_mul_f32 v119, s70, v119
    v_mfma_f32_16x16x32_bf16 v[172:175], a[168:171], a[224:227], v[172:175]
    v_cvt_pk_bf16_f32 v116, v116, v117
    v_cvt_pk_bf16_f32 v117, v118, v119
    v_mfma_f32_16x16x32_bf16 v[176:179], a[176:179], a[224:227], v[176:179]
    v_accvgpr_write_b32 a10, v116
    v_accvgpr_write_b32 a11, v117
    v_mfma_f32_16x16x32_bf16 v[176:179], a[180:183], a[228:231], v[176:179]
    v_mul_f32 v120, s70, v120
    v_mul_f32 v121, s70, v121
    v_mfma_f32_16x16x32_bf16 v[180:183], a[188:191], a[228:231], v[180:183]
    v_mul_f32 v122, s70, v122
    v_mul_f32 v123, s70, v123
    v_mfma_f32_16x16x32_bf16 v[180:183], a[184:187], a[224:227], v[180:183]
    v_cvt_pk_bf16_f32 v120, v120, v121
    v_cvt_pk_bf16_f32 v121, v122, v123
    v_mfma_f32_16x16x32_bf16 v[184:187], a[192:195], a[224:227], v[184:187]
    v_accvgpr_write_b32 a12, v120
    v_accvgpr_write_b32 a13, v121
    v_mfma_f32_16x16x32_bf16 v[184:187], a[196:199], a[228:231], v[184:187]
    v_mul_f32 v124, s70, v124
    v_mul_f32 v125, s70, v125
    v_mfma_f32_16x16x32_bf16 v[188:191], a[204:207], a[228:231], v[188:191]
    v_mul_f32 v126, s70, v126
    v_mul_f32 v127, s70, v127
    v_mfma_f32_16x16x32_bf16 v[188:191], a[200:203], a[224:227], v[188:191]
    s_waitcnt vmcnt(8) lgkmcnt(0)
    v_cvt_pk_bf16_f32 v124, v124, v125
    v_cvt_pk_bf16_f32 v125, v126, v127
    v_mfma_f32_16x16x32_bf16 v[192:195], a[144:147], a[232:235], v[192:195]
    s_barrier
    ds_read_b128 a[80:83], v10 offset:0
    ds_read_b128 a[84:87], v10 offset:64
    v_mfma_f32_16x16x32_bf16 v[192:195], a[148:151], a[236:239], v[192:195]
    ds_read_b128 a[88:91], v10 offset:128
    ds_read_b128 a[92:95], v10 offset:192
    v_mfma_f32_16x16x32_bf16 v[196:199], a[156:159], a[236:239], v[196:199]
    ds_read_b128 a[96:99], v10 offset:256
    ds_read_b128 a[100:103], v10 offset:320
    v_mfma_f32_16x16x32_bf16 v[196:199], a[152:155], a[232:235], v[196:199]
    ds_read_b128 a[104:107], v10 offset:384
    ds_read_b128 a[108:111], v10 offset:448
    v_mfma_f32_16x16x32_bf16 v[200:203], a[160:163], a[232:235], v[200:203]
    ds_read_b128 a[64:67], v95 offset:0
    ds_read_b128 a[68:71], v95 offset:1024
    v_mfma_f32_16x16x32_bf16 v[200:203], a[164:167], a[236:239], v[200:203]
    ds_read_b128 a[72:75], v95 offset:2048
    ds_read_b128 a[76:79], v95 offset:3072
    v_mfma_f32_16x16x32_bf16 v[204:207], a[172:175], a[236:239], v[204:207]
    v_accvgpr_write_b32 a14, v124
    v_accvgpr_write_b32 a15, v125
    v_mfma_f32_16x16x32_bf16 v[204:207], a[168:171], a[232:235], v[204:207]
    v_mul_f32 v128, s70, v128
    v_mul_f32 v129, s70, v129
    v_mfma_f32_16x16x32_bf16 v[208:211], a[176:179], a[232:235], v[208:211]
    v_mul_f32 v130, s70, v130
    v_mul_f32 v131, s70, v131
    v_mfma_f32_16x16x32_bf16 v[208:211], a[180:183], a[236:239], v[208:211]
    v_cvt_pk_bf16_f32 v128, v128, v129
    v_cvt_pk_bf16_f32 v129, v130, v131
    v_mfma_f32_16x16x32_bf16 v[212:215], a[188:191], a[236:239], v[212:215]
    v_accvgpr_write_b32 a16, v128
    v_accvgpr_write_b32 a17, v129
    v_mfma_f32_16x16x32_bf16 v[212:215], a[184:187], a[232:235], v[212:215]
    v_mul_f32 v132, s70, v132
    v_mul_f32 v133, s70, v133
    v_mfma_f32_16x16x32_bf16 v[216:219], a[192:195], a[232:235], v[216:219]
    v_mul_f32 v134, s70, v134
    v_mul_f32 v135, s70, v135
    v_mfma_f32_16x16x32_bf16 v[216:219], a[196:199], a[236:239], v[216:219]
    v_cvt_pk_bf16_f32 v132, v132, v133
    v_cvt_pk_bf16_f32 v133, v134, v135
    v_mfma_f32_16x16x32_bf16 v[220:223], a[204:207], a[236:239], v[220:223]
    v_accvgpr_write_b32 a18, v132
    v_accvgpr_write_b32 a19, v133
    v_mfma_f32_16x16x32_bf16 v[220:223], a[200:203], a[232:235], v[220:223]
    s_waitcnt lgkmcnt(0)
    v_mul_f32 v136, s70, v136
    v_mul_f32 v137, s70, v137
    v_mfma_f32_16x16x32_bf16 v[64:67], a[80:83], a[0:3], 0
    ds_read_b128 a[144:147], v11 offset:0
    ds_read_b128 a[148:151], v11 offset:64
    v_mfma_f32_16x16x32_bf16 v[64:67], a[84:87], a[4:7], v[64:67]
    ds_read_b128 a[152:155], v11 offset:128
    ds_read_b128 a[156:159], v11 offset:192
    v_mfma_f32_16x16x32_bf16 v[64:67], a[88:91], a[8:11], v[64:67]
    ds_read_b128 a[160:163], v11 offset:256
    ds_read_b128 a[164:167], v11 offset:320
    v_mfma_f32_16x16x32_bf16 v[64:67], a[92:95], a[12:15], v[64:67]
    ds_read_b128 a[168:171], v11 offset:384
    ds_read_b128 a[172:175], v11 offset:448
    v_mfma_f32_16x16x32_bf16 v[68:71], a[108:111], a[12:15], 0
    v_mul_f32 v138, s70, v138
    v_mul_f32 v139, s70, v139
    v_mfma_f32_16x16x32_bf16 v[68:71], a[104:107], a[8:11], v[68:71]
    v_cvt_pk_bf16_f32 v136, v136, v137
    v_cvt_pk_bf16_f32 v137, v138, v139
    v_mfma_f32_16x16x32_bf16 v[68:71], a[100:103], a[4:7], v[68:71]
    v_accvgpr_write_b32 a20, v136
    v_accvgpr_write_b32 a21, v137
    v_mfma_f32_16x16x32_bf16 v[68:71], a[96:99], a[0:3], v[68:71]
    v_mul_f32 v140, s70, v140
    v_mul_f32 v141, s70, v141
    v_mul_f32 v142, s70, v142
    v_mul_f32 v143, s70, v143
    v_cvt_pk_bf16_f32 v140, v140, v141
    v_cvt_pk_bf16_f32 v141, v142, v143
    v_accvgpr_write_b32 a22, v140
    v_accvgpr_write_b32 a23, v141
    v_mul_f32 v144, s70, v144
    v_mul_f32 v145, s70, v145
    v_mul_f32 v146, s70, v146
    v_mul_f32 v147, s70, v147
    v_cvt_pk_bf16_f32 v144, v144, v145
    v_cvt_pk_bf16_f32 v145, v146, v147
    v_accvgpr_write_b32 a24, v144
    v_accvgpr_write_b32 a25, v145
    v_mul_f32 v148, s70, v148
    v_mul_f32 v149, s70, v149
    v_mul_f32 v150, s70, v150
    v_mul_f32 v151, s70, v151
    v_cvt_pk_bf16_f32 v148, v148, v149
    v_cvt_pk_bf16_f32 v149, v150, v151
    v_accvgpr_write_b32 a26, v148
    v_accvgpr_write_b32 a27, v149
    v_mul_f32 v152, s70, v152
    v_mul_f32 v153, s70, v153
    v_mul_f32 v154, s70, v154
    v_mul_f32 v155, s70, v155
    v_cvt_pk_bf16_f32 v152, v152, v153
    v_cvt_pk_bf16_f32 v153, v154, v155
    v_accvgpr_write_b32 a28, v152
    v_accvgpr_write_b32 a29, v153
    v_mul_f32 v156, s70, v156
    v_mul_f32 v157, s70, v157
    v_mul_f32 v158, s70, v158
    v_mul_f32 v159, s70, v159
    v_cvt_pk_bf16_f32 v156, v156, v157
    v_cvt_pk_bf16_f32 v157, v158, v159
    v_accvgpr_write_b32 a30, v156
    v_accvgpr_write_b32 a31, v157
    v_mul_f32 v160, s70, v160
    v_mul_f32 v161, s70, v161
    v_mul_f32 v162, s70, v162
    v_mul_f32 v163, s70, v163
    v_cvt_pk_bf16_f32 v20, v160, v161
    v_cvt_pk_bf16_f32 v21, v162, v163
    v_mul_f32 v164, s70, v164
    v_mul_f32 v165, s70, v165
    v_mul_f32 v166, s70, v166
    v_mul_f32 v167, s70, v167
    v_cvt_pk_bf16_f32 v22, v164, v165
    v_cvt_pk_bf16_f32 v23, v166, v167
    v_mul_f32 v168, s70, v168
    v_mul_f32 v169, s70, v169
    v_mul_f32 v170, s70, v170
    v_mul_f32 v171, s70, v171
    v_cvt_pk_bf16_f32 v24, v168, v169
    v_cvt_pk_bf16_f32 v25, v170, v171
    v_mul_f32 v172, s70, v172
    v_mul_f32 v173, s70, v173
    v_mul_f32 v174, s70, v174
    v_mul_f32 v175, s70, v175
    v_cvt_pk_bf16_f32 v26, v172, v173
    v_cvt_pk_bf16_f32 v27, v174, v175
    v_mul_f32 v176, s70, v176
    v_mul_f32 v177, s70, v177
    v_mul_f32 v178, s70, v178
    v_mul_f32 v179, s70, v179
    v_cvt_pk_bf16_f32 v28, v176, v177
    v_cvt_pk_bf16_f32 v29, v178, v179
    v_mul_f32 v180, s70, v180
    v_mul_f32 v181, s70, v181
    v_mul_f32 v182, s70, v182
    v_mul_f32 v183, s70, v183
    v_cvt_pk_bf16_f32 v30, v180, v181
    v_cvt_pk_bf16_f32 v31, v182, v183
    v_mul_f32 v184, s70, v184
    v_mul_f32 v185, s70, v185
    v_mul_f32 v186, s70, v186
    v_mul_f32 v187, s70, v187
    v_cvt_pk_bf16_f32 v32, v184, v185
    v_cvt_pk_bf16_f32 v33, v186, v187
    v_mul_f32 v188, s70, v188
    v_mul_f32 v189, s70, v189
    v_mul_f32 v190, s70, v190
    v_mul_f32 v191, s70, v191
    v_cvt_pk_bf16_f32 v34, v188, v189
    v_cvt_pk_bf16_f32 v35, v190, v191
    v_mul_f32 v192, s70, v192
    v_mul_f32 v193, s70, v193
    v_mul_f32 v194, s70, v194
    v_mul_f32 v195, s70, v195
    v_cvt_pk_bf16_f32 v36, v192, v193
    v_cvt_pk_bf16_f32 v37, v194, v195
    v_mul_f32 v196, s70, v196
    v_mul_f32 v197, s70, v197
    v_mul_f32 v198, s70, v198
    v_mul_f32 v199, s70, v199
    v_cvt_pk_bf16_f32 v38, v196, v197
    v_cvt_pk_bf16_f32 v39, v198, v199
    v_mul_f32 v200, s70, v200
    v_mul_f32 v201, s70, v201
    v_mul_f32 v202, s70, v202
    v_mul_f32 v203, s70, v203
    v_cvt_pk_bf16_f32 v40, v200, v201
    v_cvt_pk_bf16_f32 v41, v202, v203
    v_mul_f32 v204, s70, v204
    v_mul_f32 v205, s70, v205
    v_mul_f32 v206, s70, v206
    v_mul_f32 v207, s70, v207
    v_cvt_pk_bf16_f32 v42, v204, v205
    v_cvt_pk_bf16_f32 v43, v206, v207
    v_mul_f32 v208, s70, v208
    v_mul_f32 v209, s70, v209
    v_mul_f32 v210, s70, v210
    v_mul_f32 v211, s70, v211
    s_branch L_pg4
    .p2align 12
L_stub4:
    s_branch L_stub8
L_pg4:
    v_cvt_pk_bf16_f32 v44, v208, v209
    v_cvt_pk_bf16_f32 v45, v210, v211
    v_mul_f32 v212, s70, v212
    v_mul_f32 v213, s70, v213
    v_mul_f32 v214, s70, v214
    v_mul_f32 v215, s70, v215
    v_cvt_pk_bf16_f32 v46, v212, v213
    v_cvt_pk_bf16_f32 v47, v214, v215
    v_mul_f32 v216, s70, v216
    v_mul_f32 v217, s70, v217
    v_mul_f32 v218, s70, v218
    v_mul_f32 v219, s70, v219
    v_cvt_pk_bf16_f32 v48, v216, v217
    v_cvt_pk_bf16_f32 v49, v218, v219
    v_mul_f32 v220, s70, v220
    v_mul_f32 v221, s70, v221
    v_mul_f32 v222, s70, v222
    v_mul_f32 v223, s70, v223
    v_cvt_pk_bf16_f32 v50, v220, v221
    v_cvt_pk_bf16_f32 v51, v222, v223
    s_branch L_pg5
    .p2align 6
L_stub5:
    s_branch L_stub9
L_pg5:
L_q7done:
    s_mov_b32 s59, 0
    s_add_u32 s56, s71, 32768
    s_and_b32 s56, s56, 0x3ffff
    s_add_u32 s55, s71, 49152
    s_and_b32 s55, s55, 0x3ffff
    s_add_u32 s58, s60, 84480
    s_mov_b32 s47, 0
    s_add_u32 s48, s71, 32768
    s_and_b32 s48, s48, 0x3ffff
    s_mov_b32 s92, s16
    s_mov_b32 s93, s17
    s_mov_b32 s94, 256
    s_mov_b32 s95, 0x20000
    s_mov_b32 s72, s12
    s_mov_b32 s73, s13
    s_mov_b32 s74, 0x400000
    s_mov_b32 s75, 0x20000
    v_mov_b32 v92, 0x3f803f80
    v_accvgpr_write_b32 a248, v92
    v_accvgpr_write_b32 a249, v92
    v_accvgpr_write_b32 a250, v92
    v_accvgpr_write_b32 a251, v92
    s_cmp_lg_u32 s101, 0
    s_cbranch_scc1 L_slow
    s_branch L_pg6
    .p2align 12
L_stub6:
    s_branch L_stub10
L_pg6:
    v_mfma_f32_16x16x32_bf16 v[72:75], a[144:147], a[0:3], 0
    s_cmp_eq_u32 s47, 67584
    ds_read_b64_tr_b16 a[124:125], v12 offset:96
    v_exp_f32 v64, v64
    v_mfma_f32_16x16x32_bf16 v[72:75], a[148:151], a[4:7], v[72:75]
    s_cselect_b32 s65, -67584, s77
    ds_read_b64_tr_b16 a[126:127], v12 offset:352
    v_mov_b32 v16, 0
    v_mov_b32 v17, 0
    v_mfma_f32_16x16x32_bf16 v[72:75], a[152:155], a[8:11], v[72:75]
    s_add_u32 s57, s47, s60
    ds_read_b64_tr_b16 a[198:199], v13 offset:416
    v_exp_f32 v65, v65
    v_mfma_f32_16x16x32_bf16 v[72:75], a[156:159], a[12:15], v[72:75]
    s_waitcnt lgkmcnt(3)
    ds_read_b64_tr_b16 a[132:133], v12 offset:160
    v_mov_b32 v18, 0
    v_mov_b32 v19, 0
    v_mfma_f32_16x16x32_bf16 v[76:79], a[172:175], a[12:15], 0
    s_add_u32 m0, s60, 67584
    ds_read_b64_tr_b16 a[134:135], v12 offset:416
    v_exp_f32 v66, v66
    v_mfma_f32_16x16x32_bf16 v[76:79], a[168:171], a[8:11], v[76:79]
    buffer_load_dwordx4 v88, s[28:31], s48 offen offset:0 nt lds
    v_mfma_f32_16x16x32_bf16 v[76:79], a[164:167], a[4:7], v[76:79]
    ds_read_b64_tr_b16 a[136:137], v12 offset:192
    v_exp_f32 v67, v67
    v_mfma_f32_16x16x32_bf16 v[76:79], a[160:163], a[0:3], v[76:79]
    ds_read_b64_tr_b16 a[138:139], v12 offset:448
    v_cvt_pk_bf16_f32 v53, v66, v67
    v_cvt_pk_bf16_f32 v52, v64, v65
    v_mfma_f32_16x16x32_bf16 v[208:211], a[248:251], v[16:19], 0
    ds_read_b64_tr_b16 a[202:203], v13 offset:448
    v_exp_f32 v68, v68
    v_mfma_f32_16x16x32_bf16 v[212:215], a[248:251], v[16:19], 0
    ds_read_b64_tr_b16 a[112:113], v12 offset:0
    ds_read_b64_tr_b16 a[114:115], v12 offset:256
    ds_read_b64_tr_b16 a[204:205], v13 offset:224
    v_mfma_f32_16x16x32_bf16 v[216:219], a[248:251], v[16:19], 0
    ds_read_b64_tr_b16 a[206:207], v13 offset:480
    v_exp_f32 v69, v69
    v_mfma_f32_16x16x32_bf16 v[220:223], a[248:251], v[16:19], 0
    ds_read_b64_tr_b16 a[176:177], v13 offset:0
    ds_read_b64_tr_b16 a[140:141], v12 offset:224
    v_cvt_pk_bf16_f32 v54, v68, v69
    v_mfma_f32_16x16x32_bf16 v[224:227], a[248:251], v[16:19], 0
    s_add_u32 m0, s60, 67616
    ds_read_b64_tr_b16 a[142:143], v12 offset:480
    v_exp_f32 v70, v70
    v_mfma_f32_16x16x32_bf16 v[228:231], a[248:251], v[16:19], 0
    buffer_load_dwordx4 v88, s[28:31], s48 offen offset:1024 nt lds
    v_mfma_f32_16x16x32_bf16 v[232:235], a[248:251], v[16:19], 0
    v_exp_f32 v71, v71
    v_mfma_f32_16x16x32_bf16 v[236:239], a[248:251], v[16:19], 0
    ds_read_b64_tr_b16 a[178:179], v13 offset:256
    v_cvt_pk_bf16_f32 v55, v70, v71
    v_mfma_f32_16x16x32_bf16 v[80:83], a[80:83], a[16:19], 0
    v_exp_f32 v72, v72
    v_add_u32 v11, s65, v11
    v_mfma_f32_16x16x32_bf16 v[80:83], a[84:87], a[20:23], v[80:83]
    ds_read_b64_tr_b16 a[180:181], v13 offset:32
    ds_read_b64_tr_b16 a[182:183], v13 offset:288
    v_mfma_f32_16x16x32_bf16 v[80:83], a[88:91], a[24:27], v[80:83]
    s_mul_i32 s63, s42, 9
    v_exp_f32 v73, v73
    v_mfma_f32_16x16x32_bf16 v[80:83], a[92:95], a[28:31], v[80:83]
    s_lshl_b32 s84, s41, 2
    ds_read_b64_tr_b16 a[116:117], v12 offset:32
    v_cvt_pk_bf16_f32 v56, v72, v73
    v_mfma_f32_16x16x32_bf16 v[84:87], a[108:111], a[28:31], 0
    s_add_u32 s84, s84, s63
    v_exp_f32 v74, v74
    v_mfma_f32_16x16x32_bf16 v[84:87], a[104:107], a[24:27], v[84:87]
    s_lshl_b32 s84, s84, 17
    ds_read_b64_tr_b16 a[118:119], v12 offset:288
    ds_read_b64_tr_b16 a[120:121], v12 offset:64
    v_mfma_f32_16x16x32_bf16 v[84:87], a[100:103], a[20:23], v[84:87]
    s_add_u32 m0, s60, 67648
    v_exp_f32 v75, v75
    v_mfma_f32_16x16x32_bf16 v[84:87], a[96:99], a[16:19], v[84:87]
    buffer_load_dwordx4 v88, s[28:31], s48 offen offset:2048 nt lds
    v_mfma_f32_16x16x32_bf16 v[240:243], a[248:251], v[16:19], 0
    s_add_u32 s85, s84, 131072
    v_exp_f32 v76, v76
    v_mfma_f32_16x16x32_bf16 v[244:247], a[248:251], v[16:19], 0
    s_add_u32 s86, s84, 262144
    ds_read_b64_tr_b16 a[122:123], v12 offset:320
    v_cvt_pk_bf16_f32 v57, v74, v75
    v_mfma_f32_16x16x32_bf16 v[248:251], a[248:251], v[16:19], 0
    s_add_u32 s87, s84, 393216
    v_exp_f32 v77, v77
    v_mfma_f32_16x16x32_bf16 v[252:255], a[248:251], v[16:19], 0
    s_add_u32 s63, s63, 8
    ds_read_b64_tr_b16 a[184:185], v13 offset:64
    v_cvt_pk_bf16_f32 v58, v76, v77
    v_mfma_f32_16x16x32_bf16 a[244:247], a[248:251], v[16:19], 0
    s_lshl_b32 s63, s63, 17
    v_exp_f32 v78, v78
    s_nop 0
    s_lshl_b32 s88, s41, 11
    ds_read_b64_tr_b16 a[186:187], v13 offset:320
    ds_read_b64_tr_b16 a[188:189], v13 offset:96
    s_nop 0
    s_add_u32 s88, s88, s63
    v_exp_f32 v79, v79
    s_nop 0
    s_lshr_b32 s63, s89, 1
    ds_read_b64_tr_b16 a[190:191], v13 offset:352
    v_cvt_pk_bf16_f32 v59, v78, v79
    v_mfma_f32_16x16x32_bf16 v[64:67], a[144:147], a[16:19], 0
    s_add_u32 m0, s60, 67680
    v_exp_f32 v80, v80
    v_mfma_f32_16x16x32_bf16 v[64:67], a[148:151], a[20:23], v[64:67]
    buffer_load_dwordx4 v88, s[28:31], s48 offen offset:3072 nt lds
    v_mfma_f32_16x16x32_bf16 v[64:67], a[152:155], a[24:27], v[64:67]
    s_mul_i32 s63, s63, 9
    v_exp_f32 v81, v81
    v_mfma_f32_16x16x32_bf16 v[64:67], a[156:159], a[28:31], v[64:67]
    s_and_b32 s64, s89, 1
    v_add_f32 v14, v14, v81
    v_cvt_pk_bf16_f32 v60, v80, v81
    v_mfma_f32_16x16x32_bf16 v[68:71], a[172:175], a[28:31], 0
    s_lshl_b32 s76, s64, 2
    v_exp_f32 v82, v82
    v_mfma_f32_16x16x32_bf16 v[68:71], a[168:171], a[24:27], v[68:71]
    s_add_u32 s63, s63, s76
    v_add_f32 v14, v14, v82
    v_add_f32 v14, v14, v80
    v_mfma_f32_16x16x32_bf16 v[68:71], a[164:167], a[20:23], v[68:71]
    s_sub_u32 s76, 8, s76
    v_exp_f32 v83, v83
    v_mfma_f32_16x16x32_bf16 v[68:71], a[160:163], a[16:19], v[68:71]
    s_waitcnt lgkmcnt(0)
    v_add_f32 v14, v14, v83
    v_cvt_pk_bf16_f32 v61, v82, v83
    v_mfma_f32_16x16x32_bf16 v[96:99], a[112:115], v[52:55], 0
    s_mul_i32 s64, s91, 18
    v_exp_f32 v84, v84
    v_mfma_f32_16x16x32_bf16 v[96:99], a[176:179], v[56:59], v[96:99]
    s_add_u32 s63, s63, s64
    ds_read_b64_tr_b16 a[128:129], v12 offset:128
    v_add_f32 v14, v14, v84
    v_mfma_f32_16x16x32_bf16 v[100:103], a[180:183], v[56:59], 0
    s_add_u32 m0, s58, 0
    v_exp_f32 v85, v85
    v_mfma_f32_16x16x32_bf16 v[100:103], a[116:119], v[52:55], v[100:103]
    buffer_load_dwordx4 v88, s[32:35], s56 offen offset:0 nt lds
    v_mfma_f32_16x16x32_bf16 v[104:107], a[120:123], v[52:55], 0
    s_lshl_b32 s64, s63, 17
    v_exp_f32 v86, v86
    v_mfma_f32_16x16x32_bf16 v[104:107], a[184:187], v[56:59], v[104:107]
    s_lshl_b32 s51, s40, 15
    v_add_f32 v14, v14, v86
    v_add_f32 v14, v14, v85
    v_mfma_f32_16x16x32_bf16 v[108:111], a[188:191], v[56:59], 0
    s_add_u32 s64, s64, s51
    v_exp_f32 v87, v87
    v_mfma_f32_16x16x32_bf16 v[108:111], a[124:127], v[52:55], v[108:111]
    s_add_u32 s20, s18, s64
    v_add_f32 v14, v14, v87
    v_cvt_pk_bf16_f32 v63, v86, v87
    v_mfma_f32_16x16x32_bf16 a[240:243], a[248:251], v[52:55], 0
    s_addc_u32 s21, s19, 0
    ds_read_b64_tr_b16 a[130:131], v12 offset:384
    v_cvt_pk_bf16_f32 v62, v84, v85
    v_mfma_f32_16x16x32_bf16 a[240:243], a[248:251], v[56:59], a[240:243]
    s_sub_u32 s22, 18874368, s64
    ds_read_b64_tr_b16 a[192:193], v13 offset:128
    ds_read_b64_tr_b16 a[194:195], v13 offset:384
    v_mfma_f32_16x16x32_bf16 v[72:75], a[80:83], v[20:23], 0
    s_mov_b32 s23, 0x20000
    v_exp_f32 v64, v64
    v_mfma_f32_16x16x32_bf16 v[72:75], a[84:87], v[24:27], v[72:75]
    s_lshl_b32 s64, s63, 14
    ds_read_b64_tr_b16 a[196:197], v13 offset:160
    v_add_f32 v14, v14, v64
    v_mfma_f32_16x16x32_bf16 v[72:75], a[88:91], v[28:31], v[72:75]
    s_add_u32 s24, s14, s64
    v_exp_f32 v65, v65
    v_mfma_f32_16x16x32_bf16 v[72:75], a[92:95], v[32:35], v[72:75]
    s_addc_u32 s25, s15, 0
    v_cvt_pk_bf16_f32 v16, v64, v65
    v_add_f32 v14, v14, v65
    v_mfma_f32_16x16x32_bf16 v[76:79], a[108:111], v[32:35], 0
    s_sub_u32 s26, 2359296, s64
    v_exp_f32 v66, v66
    v_mfma_f32_16x16x32_bf16 v[76:79], a[104:107], v[28:31], v[76:79]
    s_mov_b32 s27, 0x20000
    ds_read_b64_tr_b16 a[200:201], v13 offset:192
    v_add_f32 v14, v14, v66
    v_mfma_f32_16x16x32_bf16 v[76:79], a[100:103], v[24:27], v[76:79]
    s_lshl_b32 s51, s76, 17
    v_exp_f32 v67, v67
    v_mfma_f32_16x16x32_bf16 v[76:79], a[96:99], v[20:23], v[76:79]
    s_waitcnt lgkmcnt(1)
    v_cvt_pk_bf16_f32 v17, v66, v67
    v_add_f32 v14, v14, v67
    v_mfma_f32_16x16x32_bf16 v[112:115], a[128:131], v[52:55], 0
    s_and_b32 s53, s90, 0
    v_exp_f32 v68, v68
    v_mfma_f32_16x16x32_bf16 v[112:115], a[192:195], v[56:59], v[112:115]
    s_lshl_b32 s52, s53, 17
    v_add_f32 v14, v14, v68
    v_add_u32 v10, s65, v10
    v_mfma_f32_16x16x32_bf16 v[116:119], a[196:199], v[56:59], 0
    s_add_u32 m0, s58, 32
    v_exp_f32 v69, v69
    v_mfma_f32_16x16x32_bf16 v[116:119], a[132:135], v[52:55], v[116:119]
    buffer_load_dwordx4 v88, s[32:35], s56 offen offset:1024 nt lds
    v_mfma_f32_16x16x32_bf16 v[120:123], a[136:139], v[52:55], 0
    s_waitcnt lgkmcnt(0)
    v_exp_f32 v70, v70
    v_mfma_f32_16x16x32_bf16 v[120:123], a[200:203], v[56:59], v[120:123]
    s_lshl_b32 s53, s53, 12
    v_cvt_pk_bf16_f32 v18, v68, v69
    v_add_f32 v14, v14, v70
    v_mfma_f32_16x16x32_bf16 v[124:127], a[204:207], v[56:59], 0
    s_or_b32 s51, s51, s53
    v_exp_f32 v71, v71
    v_mfma_f32_16x16x32_bf16 v[124:127], a[140:143], v[52:55], v[124:127]
    s_lshl_b32 s54, s43, 2
    v_cvt_pk_bf16_f32 v19, v70, v71
    v_add_f32 v14, v14, v71
    v_mfma_f32_16x16x32_bf16 v[80:83], a[144:147], v[20:23], 0
    s_lshr_b32 s64, s44, 3
    v_exp_f32 v72, v72
    v_add_u32 v12, s65, v12
    v_mfma_f32_16x16x32_bf16 v[80:83], a[148:151], v[24:27], v[80:83]
    s_add_u32 s54, s54, s64
    v_add_f32 v14, v14, v69
    v_add_f32 v15, v15, v72
    v_add_u32 v13, s65, v13
    v_mfma_f32_16x16x32_bf16 v[80:83], a[152:155], v[28:31], v[80:83]
    s_lshl_b32 s54, s54, 3
    v_exp_f32 v73, v73
    v_mfma_f32_16x16x32_bf16 v[80:83], a[156:159], v[32:35], v[80:83]
    s_lshl_b32 s50, s91, 2
    v_add_f32 v15, v15, v73
    v_cvt_pk_bf16_f32 v52, v72, v73
    v_mfma_f32_16x16x32_bf16 v[84:87], a[172:175], v[32:35], 0
    s_add_u32 m0, s58, 64
    v_exp_f32 v74, v74
    v_mfma_f32_16x16x32_bf16 v[84:87], a[168:171], v[28:31], v[84:87]
    buffer_load_dwordx4 v88, s[32:35], s56 offen offset:2048 nt lds
    v_mfma_f32_16x16x32_bf16 v[84:87], a[164:167], v[24:27], v[84:87]
    s_add_u32 s50, s50, s40
    v_exp_f32 v75, v75
    v_mfma_f32_16x16x32_bf16 v[84:87], a[160:163], v[20:23], v[84:87]
    s_lshl_b32 s50, s50, 3
    v_add_f32 v15, v15, v75
    v_cvt_pk_bf16_f32 v53, v74, v75
    v_mfma_f32_16x16x32_bf16 v[128:131], a[112:115], v[60:63], 0
    v_exp_f32 v76, v76
    v_mfma_f32_16x16x32_bf16 v[128:131], a[176:179], v[16:19], v[128:131]
    v_add_f32 v15, v15, v76
    v_add_f32 v15, v15, v74
    v_mfma_f32_16x16x32_bf16 v[132:135], a[180:183], v[16:19], 0
    v_exp_f32 v77, v77
    v_mfma_f32_16x16x32_bf16 v[132:135], a[116:119], v[60:63], v[132:135]
    buffer_load_dword v92, v93, s[72:75], 0 offen
    v_mfma_f32_16x16x32_bf16 v[136:139], a[120:123], v[60:63], 0
    v_exp_f32 v78, v78
    v_mfma_f32_16x16x32_bf16 v[136:139], a[184:187], v[16:19], v[136:139]
    v_add_f32 v15, v15, v78
    v_add_f32 v15, v15, v77
    v_mfma_f32_16x16x32_bf16 v[140:143], a[188:191], v[16:19], 0
    v_exp_f32 v79, v79
    v_mfma_f32_16x16x32_bf16 v[140:143], a[124:127], v[60:63], v[140:143]
    v_add_f32 v15, v15, v79
    v_cvt_pk_bf16_f32 v55, v78, v79
    v_mfma_f32_16x16x32_bf16 v[64:67], a[80:83], v[36:39], 0
    v_exp_f32 v80, v80
    v_mfma_f32_16x16x32_bf16 v[64:67], a[84:87], v[40:43], v[64:67]
    v_cvt_pk_bf16_f32 v54, v76, v77
    v_add_f32 v15, v15, v80
    v_mfma_f32_16x16x32_bf16 v[64:67], a[88:91], v[44:47], v[64:67]
    v_exp_f32 v81, v81
    v_mfma_f32_16x16x32_bf16 v[64:67], a[92:95], v[48:51], v[64:67]
    v_cvt_pk_bf16_f32 v56, v80, v81
    v_add_f32 v15, v15, v81
    v_mfma_f32_16x16x32_bf16 v[68:71], a[108:111], v[48:51], 0
    s_add_u32 m0, s58, 96
    v_exp_f32 v82, v82
    v_mfma_f32_16x16x32_bf16 v[68:71], a[104:107], v[44:47], v[68:71]
    buffer_load_dwordx4 v88, s[32:35], s56 offen offset:3072 nt lds
    v_mfma_f32_16x16x32_bf16 v[68:71], a[100:103], v[40:43], v[68:71]
    v_exp_f32 v83, v83
    v_mfma_f32_16x16x32_bf16 v[68:71], a[96:99], v[36:39], v[68:71]
    v_cvt_pk_bf16_f32 v57, v82, v83
    v_add_f32 v15, v15, v83
    v_mfma_f32_16x16x32_bf16 v[144:147], a[128:131], v[60:63], 0
    v_exp_f32 v84, v84
    v_mfma_f32_16x16x32_bf16 v[144:147], a[192:195], v[16:19], v[144:147]
    v_add_f32 v15, v15, v84
    v_add_f32 v15, v15, v82
    v_mfma_f32_16x16x32_bf16 v[148:151], a[196:199], v[16:19], 0
    v_exp_f32 v85, v85
    v_mfma_f32_16x16x32_bf16 v[148:151], a[132:135], v[60:63], v[148:151]
    v_cvt_pk_bf16_f32 v58, v84, v85
    v_add_f32 v15, v15, v85
    v_mfma_f32_16x16x32_bf16 v[152:155], a[136:139], v[60:63], 0
    v_exp_f32 v86, v86
    v_mfma_f32_16x16x32_bf16 v[152:155], a[200:203], v[16:19], v[152:155]
    v_add_f32 v15, v15, v86
    v_add_u32 v93, v91, v93
    v_mfma_f32_16x16x32_bf16 v[156:159], a[204:207], v[16:19], 0
    v_exp_f32 v87, v87
    v_mfma_f32_16x16x32_bf16 v[156:159], a[140:143], v[60:63], v[156:159]
    s_waitcnt vmcnt(9)
    v_cvt_pk_bf16_f32 v59, v86, v87
    v_add_f32 v15, v15, v87
    v_mfma_f32_16x16x32_bf16 v[72:75], a[144:147], v[36:39], 0
    s_barrier
    v_exp_f32 v64, v64
    v_mfma_f32_16x16x32_bf16 v[72:75], a[148:151], v[40:43], v[72:75]
    ds_read_b128 a[144:147], v11 offset:0
    v_add_f32 v89, v89, v64
    v_mfma_f32_16x16x32_bf16 v[72:75], a[152:155], v[44:47], v[72:75]
    ds_read_b128 a[152:155], v11 offset:128
    v_exp_f32 v65, v65
    v_mfma_f32_16x16x32_bf16 v[72:75], a[156:159], v[48:51], v[72:75]
    ds_read_b128 a[156:159], v11 offset:192
    v_add_f32 v89, v89, v65
    v_cvt_pk_bf16_f32 v60, v64, v65
    v_mfma_f32_16x16x32_bf16 v[76:79], a[172:175], v[48:51], 0
    s_add_u32 m0, s57, 0
    ds_read_b128 a[172:175], v11 offset:448
    v_exp_f32 v66, v66
    v_mfma_f32_16x16x32_bf16 v[76:79], a[168:171], v[44:47], v[76:79]
    buffer_load_dwordx4 v88, s[28:31], s55 offen offset:0 nt lds
    v_mfma_f32_16x16x32_bf16 v[76:79], a[164:167], v[40:43], v[76:79]
    s_add_u32 s56, s56, 16384
    ds_read_b128 a[164:167], v11 offset:320
    v_exp_f32 v67, v67
    v_mfma_f32_16x16x32_bf16 v[76:79], a[160:163], v[36:39], v[76:79]
    s_and_b32 s56, s56, 0x3ffff
    v_add_f32 v89, v89, v67
    v_cvt_pk_bf16_f32 v61, v66, v67
    v_mfma_f32_16x16x32_bf16 v[160:163], a[112:115], v[52:55], 0
    s_add_u32 s58, s57, 16896
    v_exp_f32 v68, v68
    v_mfma_f32_16x16x32_bf16 v[160:163], a[176:179], v[56:59], v[160:163]
    s_add_u32 s47, s47, s65
    v_add_f32 v89, v89, v68
    v_add_f32 v89, v89, v66
    v_mfma_f32_16x16x32_bf16 v[164:167], a[180:183], v[56:59], 0
    v_exp_f32 v69, v69
    v_mfma_f32_16x16x32_bf16 v[164:167], a[116:119], v[52:55], v[164:167]
    v_add_f32 v89, v89, v69
    v_cvt_pk_bf16_f32 v62, v68, v69
    v_mfma_f32_16x16x32_bf16 v[168:171], a[120:123], v[52:55], 0
    v_exp_f32 v70, v70
    v_mfma_f32_16x16x32_bf16 v[168:171], a[184:187], v[56:59], v[168:171]
    ds_read_b128 a[148:151], v11 offset:64
    v_add_f32 v89, v89, v70
    v_mfma_f32_16x16x32_bf16 v[172:175], a[188:191], v[56:59], 0
    v_exp_f32 v71, v71
    v_mfma_f32_16x16x32_bf16 v[172:175], a[124:127], v[52:55], v[172:175]
    v_add_f32 v89, v89, v71
    v_cvt_pk_bf16_f32 v63, v70, v71
    v_mfma_f32_16x16x32_bf16 v[80:83], a[80:83], a[64:67], 0
    v_exp_f32 v72, v72
    v_mfma_f32_16x16x32_bf16 v[80:83], a[84:87], a[68:71], v[80:83]
    ds_read_b128 a[80:83], v10 offset:0
    ds_read_b128 a[84:87], v10 offset:64
    v_mfma_f32_16x16x32_bf16 v[80:83], a[88:91], a[72:75], v[80:83]
    v_exp_f32 v73, v73
    v_mfma_f32_16x16x32_bf16 v[80:83], a[92:95], a[76:79], v[80:83]
    ds_read_b128 a[88:91], v10 offset:128
    ds_read_b128 a[92:95], v10 offset:192
    v_mfma_f32_16x16x32_bf16 v[84:87], a[108:111], a[76:79], 0
    v_exp_f32 v74, v74
    v_mfma_f32_16x16x32_bf16 v[84:87], a[104:107], a[72:75], v[84:87]
    ds_read_b128 a[108:111], v10 offset:448
    ds_read_b128 a[104:107], v10 offset:384
    v_mfma_f32_16x16x32_bf16 v[84:87], a[100:103], a[68:71], v[84:87]
    v_exp_f32 v75, v75
    v_mfma_f32_16x16x32_bf16 v[84:87], a[96:99], a[64:67], v[84:87]
    ds_read_b128 a[100:103], v10 offset:320
    ds_read_b128 a[96:99], v10 offset:256
    v_mfma_f32_16x16x32_bf16 v[176:179], a[128:131], v[52:55], 0
    s_add_u32 m0, s57, 32
    v_exp_f32 v76, v76
    v_mfma_f32_16x16x32_bf16 v[176:179], a[192:195], v[56:59], v[176:179]
    buffer_load_dwordx4 v88, s[28:31], s55 offen offset:1024 nt lds
    v_mfma_f32_16x16x32_bf16 v[180:183], a[196:199], v[56:59], 0
    v_exp_f32 v77, v77
    v_mfma_f32_16x16x32_bf16 v[180:183], a[132:135], v[52:55], v[180:183]
    v_cvt_pk_bf16_f32 v18, v76, v77
    v_cvt_pk_bf16_f32 v17, v74, v75
    v_mfma_f32_16x16x32_bf16 v[184:187], a[136:139], v[52:55], 0
    v_exp_f32 v78, v78
    v_mfma_f32_16x16x32_bf16 v[184:187], a[200:203], v[56:59], v[184:187]
    v_add_f32 v89, v89, v78
    v_cvt_pk_bf16_f32 v16, v72, v73
    v_mfma_f32_16x16x32_bf16 v[188:191], a[204:207], v[56:59], 0
    v_exp_f32 v79, v79
    v_mfma_f32_16x16x32_bf16 v[188:191], a[140:143], v[52:55], v[188:191]
    s_waitcnt lgkmcnt(0)
    v_cvt_pk_bf16_f32 v19, v78, v79
    v_add_f32 v89, v89, v79
    v_mfma_f32_16x16x32_bf16 v[64:67], a[80:83], a[0:3], 0
    v_exp_f32 v80, v80
    v_mfma_f32_16x16x32_bf16 v[64:67], a[84:87], a[4:7], v[64:67]
    v_add_f32 v89, v89, v77
    v_add_f32 v89, v89, v76
    v_mfma_f32_16x16x32_bf16 v[64:67], a[88:91], a[8:11], v[64:67]
    s_add_u32 m0, s57, 64
    v_exp_f32 v81, v81
    v_mfma_f32_16x16x32_bf16 v[64:67], a[92:95], a[12:15], v[64:67]
    buffer_load_dwordx4 v88, s[28:31], s55 offen offset:2048 nt lds
    v_mfma_f32_16x16x32_bf16 v[68:71], a[108:111], a[12:15], 0
    v_exp_f32 v82, v82
    v_mfma_f32_16x16x32_bf16 v[68:71], a[104:107], a[8:11], v[68:71]
    v_cvt_pk_bf16_f32 v56, v80, v81
    v_add_f32 v89, v89, v75
    v_mfma_f32_16x16x32_bf16 v[68:71], a[100:103], a[4:7], v[68:71]
    v_exp_f32 v83, v83
    v_mfma_f32_16x16x32_bf16 v[68:71], a[96:99], a[0:3], v[68:71]
    v_cvt_pk_bf16_f32 v57, v82, v83
    v_add_f32 v89, v89, v74
    v_mfma_f32_16x16x32_bf16 v[192:195], a[112:115], v[60:63], 0
    v_exp_f32 v84, v84
    v_mfma_f32_16x16x32_bf16 v[192:195], a[176:179], v[16:19], v[192:195]
    v_add_f32 v89, v89, v73
    v_add_f32 v89, v89, v72
    v_mfma_f32_16x16x32_bf16 v[196:199], a[180:183], v[16:19], 0
    s_add_u32 m0, s57, 96
    v_exp_f32 v85, v85
    v_mfma_f32_16x16x32_bf16 v[196:199], a[116:119], v[60:63], v[196:199]
    buffer_load_dwordx4 v88, s[28:31], s55 offen offset:3072 nt lds
    v_mfma_f32_16x16x32_bf16 v[200:203], a[120:123], v[60:63], 0
    s_add_u32 s55, s55, 16384
    v_exp_f32 v86, v86
    v_mfma_f32_16x16x32_bf16 v[200:203], a[184:187], v[16:19], v[200:203]
    s_and_b32 s55, s55, 0x3ffff
    ds_read_b128 a[168:171], v11 offset:384
    v_cvt_pk_bf16_f32 v58, v84, v85
    v_mfma_f32_16x16x32_bf16 v[204:207], a[188:191], v[16:19], 0
    s_add_u32 s59, s59, 1
    v_exp_f32 v87, v87
    v_mfma_f32_16x16x32_bf16 v[204:207], a[124:127], v[60:63], v[204:207]
    s_cmp_lt_u32 s59, 13
    ds_read_b128 a[160:163], v11 offset:256
    v_cvt_pk_bf16_f32 v59, v86, v87
    s_branch L_pg7
    .p2align 12
L_stub7:
    s_branch L_stub11
L_pg7:
    .p2align 3
L_tile:
    v_mfma_f32_16x16x32_bf16 v[72:75], a[144:147], a[0:3], 0
    s_cmp_eq_u32 s47, 67584
    v_exp_f32 v64, v64
    v_mfma_f32_16x16x32_bf16 v[72:75], a[148:151], a[4:7], v[72:75]
    s_cselect_b32 s65, -67584, s77
    ds_read_b64_tr_b16 a[176:177], v13 offset:0
    ds_read_b64_tr_b16 a[178:179], v13 offset:256
    v_mfma_f32_16x16x32_bf16 v[72:75], a[152:155], a[8:11], v[72:75]
    s_add_u32 s57, s47, s60
    v_exp_f32 v65, v65
    v_mfma_f32_16x16x32_bf16 v[72:75], a[156:159], a[12:15], v[72:75]
    ds_read_b64_tr_b16 a[180:181], v13 offset:32
    v_cvt_pk_bf16_f32 v52, v64, v65
    v_mfma_f32_16x16x32_bf16 v[76:79], a[172:175], a[12:15], 0
    s_waitcnt lgkmcnt(4)
    v_exp_f32 v66, v66
    v_mfma_f32_16x16x32_bf16 v[76:79], a[168:171], a[8:11], v[76:79]
    ds_read_b64_tr_b16 a[182:183], v13 offset:288
    ds_read_b64_tr_b16 a[184:185], v13 offset:64
    v_mfma_f32_16x16x32_bf16 v[76:79], a[164:167], a[4:7], v[76:79]
    s_waitcnt lgkmcnt(5)
    v_exp_f32 v67, v67
    v_mfma_f32_16x16x32_bf16 v[76:79], a[160:163], a[0:3], v[76:79]
    ds_read_b64_tr_b16 a[186:187], v13 offset:320
    v_cvt_pk_bf16_f32 v53, v66, v67
    v_mfma_f32_16x16x32_bf16 v[224:227], a[112:115], v[56:59], v[224:227]
    v_exp_f32 v68, v68
    v_mfma_f32_16x16x32_bf16 v[228:231], a[116:119], v[56:59], v[228:231]
    ds_read_b64_tr_b16 a[112:113], v12 offset:0
    ds_read_b64_tr_b16 a[114:115], v12 offset:256
    v_mfma_f32_16x16x32_bf16 v[232:235], a[120:123], v[56:59], v[232:235]
    v_exp_f32 v69, v69
    v_mfma_f32_16x16x32_bf16 v[236:239], a[124:127], v[56:59], v[236:239]
    ds_read_b64_tr_b16 a[116:117], v12 offset:32
    v_cvt_pk_bf16_f32 v54, v68, v69
    v_mfma_f32_16x16x32_bf16 v[240:243], a[128:131], v[56:59], v[240:243]
    v_exp_f32 v70, v70
    v_mfma_f32_16x16x32_bf16 v[244:247], a[132:135], v[56:59], v[244:247]
    ds_read_b64_tr_b16 a[118:119], v12 offset:288
    ds_read_b64_tr_b16 a[120:121], v12 offset:64
    v_mfma_f32_16x16x32_bf16 v[248:251], a[136:139], v[56:59], v[248:251]
    v_exp_f32 v71, v71
    v_mfma_f32_16x16x32_bf16 v[252:255], a[140:143], v[56:59], v[252:255]
    ds_read_b64_tr_b16 a[122:123], v12 offset:320
    v_cvt_pk_bf16_f32 v55, v70, v71
    v_mfma_f32_16x16x32_bf16 a[244:247], a[248:251], v[56:59], a[244:247]
    ds_read_b64_tr_b16 a[124:125], v12 offset:96
    ds_read_b64_tr_b16 a[126:127], v12 offset:352
    v_mfma_f32_16x16x32_bf16 v[80:83], a[80:83], a[16:19], 0
    v_exp_f32 v72, v72
    v_mfma_f32_16x16x32_bf16 v[80:83], a[84:87], a[20:23], v[80:83]
    ds_read_b64_tr_b16 a[188:189], v13 offset:96
    ds_read_b64_tr_b16 a[190:191], v13 offset:352
    v_mfma_f32_16x16x32_bf16 v[80:83], a[88:91], a[24:27], v[80:83]
    v_exp_f32 v73, v73
    v_mfma_f32_16x16x32_bf16 v[80:83], a[92:95], a[28:31], v[80:83]
    v_cvt_pk_bf16_f32 v56, v72, v73
    v_add_u32 v10, s65, v10
    v_mfma_f32_16x16x32_bf16 v[84:87], a[108:111], a[28:31], 0
    s_add_u32 m0, s58, 0
    v_exp_f32 v74, v74
    v_mfma_f32_16x16x32_bf16 v[84:87], a[104:107], a[24:27], v[84:87]
    buffer_load_dwordx4 v88, s[32:35], s56 offen offset:0 nt lds
    v_mfma_f32_16x16x32_bf16 v[84:87], a[100:103], a[20:23], v[84:87]
    v_exp_f32 v75, v75
    v_mfma_f32_16x16x32_bf16 v[84:87], a[96:99], a[16:19], v[84:87]
    v_cvt_pk_bf16_f32 v57, v74, v75
    v_add_u32 v11, s65, v11
    v_mfma_f32_16x16x32_bf16 v[208:211], a[128:131], v[60:63], v[208:211]
    v_exp_f32 v76, v76
    v_mfma_f32_16x16x32_bf16 v[208:211], a[192:195], v[16:19], v[208:211]
    ds_read_b64_tr_b16 a[128:129], v12 offset:128
    ds_read_b64_tr_b16 a[130:131], v12 offset:384
    v_mfma_f32_16x16x32_bf16 v[212:215], a[196:199], v[16:19], v[212:215]
    v_exp_f32 v77, v77
    v_mfma_f32_16x16x32_bf16 v[212:215], a[132:135], v[60:63], v[212:215]
    ds_read_b64_tr_b16 a[192:193], v13 offset:128
    v_cvt_pk_bf16_f32 v58, v76, v77
    v_mfma_f32_16x16x32_bf16 v[216:219], a[136:139], v[60:63], v[216:219]
    v_exp_f32 v78, v78
    v_mfma_f32_16x16x32_bf16 v[216:219], a[200:203], v[16:19], v[216:219]
    ds_read_b64_tr_b16 a[194:195], v13 offset:384
    ds_read_b64_tr_b16 a[196:197], v13 offset:160
    v_mfma_f32_16x16x32_bf16 v[220:223], a[204:207], v[16:19], v[220:223]
    v_exp_f32 v79, v79
    v_mfma_f32_16x16x32_bf16 v[220:223], a[140:143], v[60:63], v[220:223]
    ds_read_b64_tr_b16 a[198:199], v13 offset:416
    v_cvt_pk_bf16_f32 v59, v78, v79
    v_mfma_f32_16x16x32_bf16 v[64:67], a[144:147], a[16:19], 0
    v_exp_f32 v80, v80
    v_mfma_f32_16x16x32_bf16 v[64:67], a[148:151], a[20:23], v[64:67]
    ds_read_b64_tr_b16 a[132:133], v12 offset:160
    ds_read_b64_tr_b16 a[134:135], v12 offset:416
    v_mfma_f32_16x16x32_bf16 v[64:67], a[152:155], a[24:27], v[64:67]
    v_exp_f32 v81, v81
    v_mfma_f32_16x16x32_bf16 v[64:67], a[156:159], a[28:31], v[64:67]
    ds_read_b64_tr_b16 a[136:137], v12 offset:192
    ds_read_b64_tr_b16 a[138:139], v12 offset:448
    v_mfma_f32_16x16x32_bf16 v[68:71], a[172:175], a[28:31], 0
    v_exp_f32 v82, v82
    v_mfma_f32_16x16x32_bf16 v[68:71], a[168:171], a[24:27], v[68:71]
    ds_read_b64_tr_b16 a[200:201], v13 offset:192
    ds_read_b64_tr_b16 a[202:203], v13 offset:448
    v_mfma_f32_16x16x32_bf16 v[68:71], a[164:167], a[20:23], v[68:71]
    v_exp_f32 v83, v83
    v_mfma_f32_16x16x32_bf16 v[68:71], a[160:163], a[16:19], v[68:71]
    s_waitcnt lgkmcnt(4)
    ds_read_b64_tr_b16 a[204:205], v13 offset:224
    ds_read_b64_tr_b16 a[206:207], v13 offset:480
    v_mfma_f32_16x16x32_bf16 v[96:99], a[112:115], v[52:55], v[96:99]
    v_exp_f32 v84, v84
    v_mfma_f32_16x16x32_bf16 v[96:99], a[176:179], v[56:59], v[96:99]
    ds_read_b64_tr_b16 a[140:141], v12 offset:224
    v_add_f32 v14, v14, v84
    v_mfma_f32_16x16x32_bf16 v[100:103], a[180:183], v[56:59], v[100:103]
    v_exp_f32 v85, v85
    v_mfma_f32_16x16x32_bf16 v[100:103], a[116:119], v[52:55], v[100:103]
    v_add_f32 v14, v14, v85
    v_cvt_pk_bf16_f32 v62, v84, v85
    v_mfma_f32_16x16x32_bf16 v[104:107], a[120:123], v[52:55], v[104:107]
    v_exp_f32 v86, v86
    v_mfma_f32_16x16x32_bf16 v[104:107], a[184:187], v[56:59], v[104:107]
    ds_read_b64_tr_b16 a[142:143], v12 offset:480
    v_add_f32 v14, v14, v86
    v_mfma_f32_16x16x32_bf16 v[108:111], a[188:191], v[56:59], v[108:111]
    v_exp_f32 v87, v87
    v_mfma_f32_16x16x32_bf16 v[108:111], a[124:127], v[52:55], v[108:111]
    v_add_f32 v14, v14, v87
    v_cvt_pk_bf16_f32 v63, v86, v87
    v_mfma_f32_16x16x32_bf16 a[240:243], a[248:251], v[52:55], a[240:243]
    v_add_f32 v14, v14, v83
    v_cvt_pk_bf16_f32 v61, v82, v83
    v_mfma_f32_16x16x32_bf16 a[240:243], a[248:251], v[56:59], a[240:243]
    v_add_f32 v14, v14, v82
    v_add_f32 v14, v14, v81
    v_mfma_f32_16x16x32_bf16 v[72:75], a[80:83], v[20:23], 0
    v_exp_f32 v64, v64
    v_mfma_f32_16x16x32_bf16 v[72:75], a[84:87], v[24:27], v[72:75]
    v_cvt_pk_bf16_f32 v60, v80, v81
    v_add_f32 v14, v14, v64
    v_mfma_f32_16x16x32_bf16 v[72:75], a[88:91], v[28:31], v[72:75]
    v_exp_f32 v65, v65
    v_mfma_f32_16x16x32_bf16 v[72:75], a[92:95], v[32:35], v[72:75]
    v_cvt_pk_bf16_f32 v16, v64, v65
    v_add_f32 v14, v14, v65
    v_mfma_f32_16x16x32_bf16 v[76:79], a[108:111], v[32:35], 0
    v_exp_f32 v66, v66
    v_mfma_f32_16x16x32_bf16 v[76:79], a[104:107], v[28:31], v[76:79]
    v_add_f32 v14, v14, v66
    v_add_f32 v14, v14, v80
    v_mfma_f32_16x16x32_bf16 v[76:79], a[100:103], v[24:27], v[76:79]
    v_exp_f32 v67, v67
    v_mfma_f32_16x16x32_bf16 v[76:79], a[96:99], v[20:23], v[76:79]
    v_cvt_pk_bf16_f32 v17, v66, v67
    v_add_f32 v14, v14, v67
    v_mfma_f32_16x16x32_bf16 v[112:115], a[128:131], v[52:55], v[112:115]
    v_exp_f32 v68, v68
    v_mfma_f32_16x16x32_bf16 v[112:115], a[192:195], v[56:59], v[112:115]
    v_add_f32 v14, v14, v68
    v_mfma_f32_16x16x32_bf16 v[116:119], a[196:199], v[56:59], v[116:119]
    s_add_u32 m0, s58, 32
    v_exp_f32 v69, v69
    v_mfma_f32_16x16x32_bf16 v[116:119], a[132:135], v[52:55], v[116:119]
    s_waitcnt lgkmcnt(0)
    buffer_load_dwordx4 v88, s[32:35], s56 offen offset:1024 nt lds
    v_mfma_f32_16x16x32_bf16 v[120:123], a[136:139], v[52:55], v[120:123]
    v_exp_f32 v70, v70
    v_mfma_f32_16x16x32_bf16 v[120:123], a[200:203], v[56:59], v[120:123]
    v_cvt_pk_bf16_f32 v18, v68, v69
    v_add_f32 v14, v14, v70
    v_mfma_f32_16x16x32_bf16 v[124:127], a[204:207], v[56:59], v[124:127]
    v_exp_f32 v71, v71
    v_mfma_f32_16x16x32_bf16 v[124:127], a[140:143], v[52:55], v[124:127]
    v_cvt_pk_bf16_f32 v19, v70, v71
    v_add_f32 v14, v14, v71
    v_mfma_f32_16x16x32_bf16 v[80:83], a[144:147], v[20:23], 0
    v_exp_f32 v72, v72
    v_add_u32 v12, s65, v12
    v_mfma_f32_16x16x32_bf16 v[80:83], a[148:151], v[24:27], v[80:83]
    v_add_f32 v14, v14, v69
    v_add_f32 v15, v15, v72
    v_add_u32 v13, s65, v13
    v_mfma_f32_16x16x32_bf16 v[80:83], a[152:155], v[28:31], v[80:83]
    v_exp_f32 v73, v73
    v_mfma_f32_16x16x32_bf16 v[80:83], a[156:159], v[32:35], v[80:83]
    v_add_f32 v15, v15, v73
    v_cvt_pk_bf16_f32 v52, v72, v73
    v_mfma_f32_16x16x32_bf16 v[84:87], a[172:175], v[32:35], 0
    s_add_u32 m0, s58, 64
    v_exp_f32 v74, v74
    v_mfma_f32_16x16x32_bf16 v[84:87], a[168:171], v[28:31], v[84:87]
    buffer_load_dwordx4 v88, s[32:35], s56 offen offset:2048 nt lds
    v_mfma_f32_16x16x32_bf16 v[84:87], a[164:167], v[24:27], v[84:87]
    v_exp_f32 v75, v75
    v_mfma_f32_16x16x32_bf16 v[84:87], a[160:163], v[20:23], v[84:87]
    v_add_f32 v15, v15, v75
    v_cvt_pk_bf16_f32 v53, v74, v75
    v_mfma_f32_16x16x32_bf16 v[128:131], a[112:115], v[60:63], v[128:131]
    v_exp_f32 v76, v76
    v_mfma_f32_16x16x32_bf16 v[128:131], a[176:179], v[16:19], v[128:131]
    v_add_f32 v15, v15, v76
    v_add_f32 v15, v15, v74
    v_mfma_f32_16x16x32_bf16 v[132:135], a[180:183], v[16:19], v[132:135]
    v_exp_f32 v77, v77
    v_mfma_f32_16x16x32_bf16 v[132:135], a[116:119], v[60:63], v[132:135]
    buffer_load_dword v92, v93, s[72:75], 0 offen
    v_mfma_f32_16x16x32_bf16 v[136:139], a[120:123], v[60:63], v[136:139]
    v_exp_f32 v78, v78
    v_mfma_f32_16x16x32_bf16 v[136:139], a[184:187], v[16:19], v[136:139]
    v_add_f32 v15, v15, v78
    v_add_f32 v15, v15, v77
    v_mfma_f32_16x16x32_bf16 v[140:143], a[188:191], v[16:19], v[140:143]
    v_exp_f32 v79, v79
    v_mfma_f32_16x16x32_bf16 v[140:143], a[124:127], v[60:63], v[140:143]
    v_add_f32 v15, v15, v79
    v_cvt_pk_bf16_f32 v55, v78, v79
    v_mfma_f32_16x16x32_bf16 v[64:67], a[80:83], v[36:39], 0
    v_exp_f32 v80, v80
    v_mfma_f32_16x16x32_bf16 v[64:67], a[84:87], v[40:43], v[64:67]
    v_cvt_pk_bf16_f32 v54, v76, v77
    v_add_f32 v15, v15, v80
    v_mfma_f32_16x16x32_bf16 v[64:67], a[88:91], v[44:47], v[64:67]
    v_exp_f32 v81, v81
    v_mfma_f32_16x16x32_bf16 v[64:67], a[92:95], v[48:51], v[64:67]
    v_cvt_pk_bf16_f32 v56, v80, v81
    v_add_f32 v15, v15, v81
    v_mfma_f32_16x16x32_bf16 v[68:71], a[108:111], v[48:51], 0
    s_add_u32 m0, s58, 96
    v_exp_f32 v82, v82
    v_mfma_f32_16x16x32_bf16 v[68:71], a[104:107], v[44:47], v[68:71]
    buffer_load_dwordx4 v88, s[32:35], s56 offen offset:3072 nt lds
    v_mfma_f32_16x16x32_bf16 v[68:71], a[100:103], v[40:43], v[68:71]
    v_exp_f32 v83, v83
    v_mfma_f32_16x16x32_bf16 v[68:71], a[96:99], v[36:39], v[68:71]
    v_cvt_pk_bf16_f32 v57, v82, v83
    v_add_f32 v15, v15, v83
    v_mfma_f32_16x16x32_bf16 v[144:147], a[128:131], v[60:63], v[144:147]
    v_exp_f32 v84, v84
    v_mfma_f32_16x16x32_bf16 v[144:147], a[192:195], v[16:19], v[144:147]
    v_add_f32 v15, v15, v84
    v_add_f32 v15, v15, v82
    v_mfma_f32_16x16x32_bf16 v[148:151], a[196:199], v[16:19], v[148:151]
    v_exp_f32 v85, v85
    v_mfma_f32_16x16x32_bf16 v[148:151], a[132:135], v[60:63], v[148:151]
    v_cvt_pk_bf16_f32 v58, v84, v85
    v_add_f32 v15, v15, v85
    v_mfma_f32_16x16x32_bf16 v[152:155], a[136:139], v[60:63], v[152:155]
    v_exp_f32 v86, v86
    v_mfma_f32_16x16x32_bf16 v[152:155], a[200:203], v[16:19], v[152:155]
    v_add_f32 v15, v15, v86
    v_add_u32 v93, v91, v93
    v_mfma_f32_16x16x32_bf16 v[156:159], a[204:207], v[16:19], v[156:159]
    v_exp_f32 v87, v87
    v_mfma_f32_16x16x32_bf16 v[156:159], a[140:143], v[60:63], v[156:159]
    s_waitcnt vmcnt(9)
    v_cvt_pk_bf16_f32 v59, v86, v87
    v_add_f32 v15, v15, v87
    v_mfma_f32_16x16x32_bf16 v[72:75], a[144:147], v[36:39], 0
    s_barrier
    v_exp_f32 v64, v64
    v_mfma_f32_16x16x32_bf16 v[72:75], a[148:151], v[40:43], v[72:75]
    ds_read_b128 a[144:147], v11 offset:0
    v_add_f32 v89, v89, v64
    v_mfma_f32_16x16x32_bf16 v[72:75], a[152:155], v[44:47], v[72:75]
    ds_read_b128 a[152:155], v11 offset:128
    v_exp_f32 v65, v65
    v_mfma_f32_16x16x32_bf16 v[72:75], a[156:159], v[48:51], v[72:75]
    ds_read_b128 a[156:159], v11 offset:192
    v_add_f32 v89, v89, v65
    v_cvt_pk_bf16_f32 v60, v64, v65
    v_mfma_f32_16x16x32_bf16 v[76:79], a[172:175], v[48:51], 0
    s_add_u32 m0, s57, 0
    ds_read_b128 a[172:175], v11 offset:448
    v_exp_f32 v66, v66
    v_mfma_f32_16x16x32_bf16 v[76:79], a[168:171], v[44:47], v[76:79]
    buffer_load_dwordx4 v88, s[28:31], s55 offen offset:0 nt lds
    v_mfma_f32_16x16x32_bf16 v[76:79], a[164:167], v[40:43], v[76:79]
    s_add_u32 s56, s56, 16384
    ds_read_b128 a[164:167], v11 offset:320
    v_exp_f32 v67, v67
    v_mfma_f32_16x16x32_bf16 v[76:79], a[160:163], v[36:39], v[76:79]
    s_and_b32 s56, s56, 0x3ffff
    v_add_f32 v89, v89, v67
    v_cvt_pk_bf16_f32 v61, v66, v67
    v_mfma_f32_16x16x32_bf16 v[160:163], a[112:115], v[52:55], v[160:163]
    s_add_u32 s58, s57, 16896
    v_exp_f32 v68, v68
    v_mfma_f32_16x16x32_bf16 v[160:163], a[176:179], v[56:59], v[160:163]
    s_add_u32 s47, s47, s65
    v_add_f32 v89, v89, v68
    v_add_f32 v89, v89, v66
    v_mfma_f32_16x16x32_bf16 v[164:167], a[180:183], v[56:59], v[164:167]
    v_exp_f32 v69, v69
    v_mfma_f32_16x16x32_bf16 v[164:167], a[116:119], v[52:55], v[164:167]
    v_add_f32 v89, v89, v69
    v_cvt_pk_bf16_f32 v62, v68, v69
    v_mfma_f32_16x16x32_bf16 v[168:171], a[120:123], v[52:55], v[168:171]
    v_exp_f32 v70, v70
    v_mfma_f32_16x16x32_bf16 v[168:171], a[184:187], v[56:59], v[168:171]
    ds_read_b128 a[148:151], v11 offset:64
    v_add_f32 v89, v89, v70
    v_mfma_f32_16x16x32_bf16 v[172:175], a[188:191], v[56:59], v[172:175]
    v_exp_f32 v71, v71
    v_mfma_f32_16x16x32_bf16 v[172:175], a[124:127], v[52:55], v[172:175]
    v_add_f32 v89, v89, v71
    v_cvt_pk_bf16_f32 v63, v70, v71
    v_mfma_f32_16x16x32_bf16 v[80:83], a[80:83], a[64:67], 0
    v_exp_f32 v72, v72
    v_mfma_f32_16x16x32_bf16 v[80:83], a[84:87], a[68:71], v[80:83]
    ds_read_b128 a[80:83], v10 offset:0
    ds_read_b128 a[84:87], v10 offset:64
    v_mfma_f32_16x16x32_bf16 v[80:83], a[88:91], a[72:75], v[80:83]
    v_exp_f32 v73, v73
    v_mfma_f32_16x16x32_bf16 v[80:83], a[92:95], a[76:79], v[80:83]
    ds_read_b128 a[88:91], v10 offset:128
    ds_read_b128 a[92:95], v10 offset:192
    v_mfma_f32_16x16x32_bf16 v[84:87], a[108:111], a[76:79], 0
    v_exp_f32 v74, v74
    v_mfma_f32_16x16x32_bf16 v[84:87], a[104:107], a[72:75], v[84:87]
    ds_read_b128 a[108:111], v10 offset:448
    ds_read_b128 a[104:107], v10 offset:384
    v_mfma_f32_16x16x32_bf16 v[84:87], a[100:103], a[68:71], v[84:87]
    v_exp_f32 v75, v75
    v_mfma_f32_16x16x32_bf16 v[84:87], a[96:99], a[64:67], v[84:87]
    ds_read_b128 a[100:103], v10 offset:320
    ds_read_b128 a[96:99], v10 offset:256
    v_mfma_f32_16x16x32_bf16 v[176:179], a[128:131], v[52:55], v[176:179]
    s_add_u32 m0, s57, 32
    v_exp_f32 v76, v76
    v_mfma_f32_16x16x32_bf16 v[176:179], a[192:195], v[56:59], v[176:179]
    buffer_load_dwordx4 v88, s[28:31], s55 offen offset:1024 nt lds
    v_mfma_f32_16x16x32_bf16 v[180:183], a[196:199], v[56:59], v[180:183]
    v_exp_f32 v77, v77
    v_mfma_f32_16x16x32_bf16 v[180:183], a[132:135], v[52:55], v[180:183]
    v_cvt_pk_bf16_f32 v18, v76, v77
    v_cvt_pk_bf16_f32 v17, v74, v75
    v_mfma_f32_16x16x32_bf16 v[184:187], a[136:139], v[52:55], v[184:187]
    v_exp_f32 v78, v78
    v_mfma_f32_16x16x32_bf16 v[184:187], a[200:203], v[56:59], v[184:187]
    v_add_f32 v89, v89, v78
    v_cvt_pk_bf16_f32 v16, v72, v73
    v_mfma_f32_16x16x32_bf16 v[188:191], a[204:207], v[56:59], v[188:191]
    v_exp_f32 v79, v79
    v_mfma_f32_16x16x32_bf16 v[188:191], a[140:143], v[52:55], v[188:191]
    s_waitcnt lgkmcnt(0)
    v_cvt_pk_bf16_f32 v19, v78, v79
    v_add_f32 v89, v89, v79
    v_mfma_f32_16x16x32_bf16 v[64:67], a[80:83], a[0:3], 0
    v_exp_f32 v80, v80
    v_mfma_f32_16x16x32_bf16 v[64:67], a[84:87], a[4:7], v[64:67]
    v_add_f32 v89, v89, v77
    v_add_f32 v89, v89, v76
    v_mfma_f32_16x16x32_bf16 v[64:67], a[88:91], a[8:11], v[64:67]
    s_add_u32 m0, s57, 64
    v_exp_f32 v81, v81
    v_mfma_f32_16x16x32_bf16 v[64:67], a[92:95], a[12:15], v[64:67]
    buffer_load_dwordx4 v88, s[28:31], s55 offen offset:2048 nt lds
    v_mfma_f32_16x16x32_bf16 v[68:71], a[108:111], a[12:15], 0
    v_exp_f32 v82, v82
    v_mfma_f32_16x16x32_bf16 v[68:71], a[104:107], a[8:11], v[68:71]
    v_cvt_pk_bf16_f32 v56, v80, v81
    v_add_f32 v89, v89, v75
    v_mfma_f32_16x16x32_bf16 v[68:71], a[100:103], a[4:7], v[68:71]
    v_exp_f32 v83, v83
    v_mfma_f32_16x16x32_bf16 v[68:71], a[96:99], a[0:3], v[68:71]
    v_cvt_pk_bf16_f32 v57, v82, v83
    v_add_f32 v89, v89, v74
    v_mfma_f32_16x16x32_bf16 v[192:195], a[112:115], v[60:63], v[192:195]
    v_exp_f32 v84, v84
    v_mfma_f32_16x16x32_bf16 v[192:195], a[176:179], v[16:19], v[192:195]
    v_add_f32 v89, v89, v73
    v_add_f32 v89, v89, v72
    v_mfma_f32_16x16x32_bf16 v[196:199], a[180:183], v[16:19], v[196:199]
    s_add_u32 m0, s57, 96
    v_exp_f32 v85, v85
    v_mfma_f32_16x16x32_bf16 v[196:199], a[116:119], v[60:63], v[196:199]
    buffer_load_dwordx4 v88, s[28:31], s55 offen offset:3072 nt lds
    v_mfma_f32_16x16x32_bf16 v[200:203], a[120:123], v[60:63], v[200:203]
    s_add_u32 s55, s55, 16384
    v_exp_f32 v86, v86
    v_mfma_f32_16x16x32_bf16 v[200:203], a[184:187], v[16:19], v[200:203]
    s_and_b32 s55, s55, 0x3ffff
    ds_read_b128 a[168:171], v11 offset:384
    v_cvt_pk_bf16_f32 v58, v84, v85
    v_mfma_f32_16x16x32_bf16 v[204:207], a[188:191], v[16:19], v[204:207]
    s_add_u32 s59, s59, 1
    v_exp_f32 v87, v87
    v_mfma_f32_16x16x32_bf16 v[204:207], a[124:127], v[60:63], v[204:207]
    s_cmp_lt_u32 s59, 13
    ds_read_b128 a[160:163], v11 offset:256
    v_cvt_pk_bf16_f32 v59, v86, v87
    s_cbranch_scc1 L_tile
    s_lshr_b32 s62, s2, 3
    s_mul_i32 s63, s62, 9984
    s_lshl_b32 s64, s90, 7
    s_mul_i32 s62, s62, 3072
    s_add_u32 s62, s62, 712704
    s_sub_u32 s62, s62, s64
    v_lshl_add_u32 v94, v0, 7, s62
    v_or_b32 v95, 0x10000000, v94
    v_cmp_gt_u32 vcc, 24, v0
    s_lshl_b32 s62, s40, 20
    s_add_u32 s63, s63, s62
    v_cndmask_b32 v91, v95, v94, vcc
    v_add_u32 v93, 135168, v1
    s_lshr_b32 s62, s2, 3
    s_and_b32 s62, s62, 3
    s_lshl_b32 s62, s62, 2
    s_add_u32 s62, s62, s40
    s_getpc_b64 s[66:67]
L_pc4:
    s_add_u32 s66, s66, L_code4-L_pc4
    s_addc_u32 s67, s67, 0
    s_lshl_b32 s61, s62, 11
    v_and_b32 v94, 15, v0
    v_lshlrev_b32 v94, 7, v94
    v_add_u32 v94, s61, v94
    v_min_u32 v94, L_k1_end-L_code4, v94
    v_mov_b32 v95, s67
    v_add_co_u32 v94, vcc, s66, v94
    s_nop 1
    v_addc_co_u32 v95, vcc, 0, v95, vcc
    global_load_dword v92, v[94:95], off
    s_branch L_pg8
    .p2align 12
L_stub8:
    s_branch L_stub12
L_pg8:
L_code4:
    v_mfma_f32_16x16x32_bf16 v[72:75], a[144:147], a[0:3], 0
    ds_read_b64_tr_b16 a[188:189], v13 offset:96
    v_exp_f32 v64, v64
    v_mfma_f32_16x16x32_bf16 v[72:75], a[148:151], a[4:7], v[72:75]
    ds_read_b64_tr_b16 a[176:177], v13 offset:0
    ds_read_b64_tr_b16 a[178:179], v13 offset:256
    ds_read_b64_tr_b16 a[190:191], v13 offset:352
    v_mfma_f32_16x16x32_bf16 v[72:75], a[152:155], a[8:11], v[72:75]
    v_exp_f32 v65, v65
    v_mfma_f32_16x16x32_bf16 v[72:75], a[156:159], a[12:15], v[72:75]
    s_add_u32 m0, s58, 0
    ds_read_b64_tr_b16 a[180:181], v13 offset:32
    v_cvt_pk_bf16_f32 v52, v64, v65
    v_mfma_f32_16x16x32_bf16 v[76:79], a[172:175], a[12:15], 0
    s_waitcnt lgkmcnt(6)
    v_exp_f32 v66, v66
    v_mfma_f32_16x16x32_bf16 v[76:79], a[168:171], a[8:11], v[76:79]
    buffer_load_dwordx4 v88, s[32:35], s56 offen offset:0 nt lds
    v_mfma_f32_16x16x32_bf16 v[76:79], a[164:167], a[4:7], v[76:79]
    s_waitcnt lgkmcnt(4)
    v_exp_f32 v67, v67
    v_mfma_f32_16x16x32_bf16 v[76:79], a[160:163], a[0:3], v[76:79]
    ds_read_b64_tr_b16 a[182:183], v13 offset:288
    v_cvt_pk_bf16_f32 v53, v66, v67
    v_mfma_f32_16x16x32_bf16 v[224:227], a[112:115], v[56:59], v[224:227]
    v_exp_f32 v68, v68
    v_mfma_f32_16x16x32_bf16 v[228:231], a[116:119], v[56:59], v[228:231]
    ds_read_b64_tr_b16 a[112:113], v12 offset:0
    ds_read_b64_tr_b16 a[114:115], v12 offset:256
    v_mfma_f32_16x16x32_bf16 v[232:235], a[120:123], v[56:59], v[232:235]
    s_add_u32 m0, s58, 32
    v_exp_f32 v69, v69
    v_mfma_f32_16x16x32_bf16 v[236:239], a[124:127], v[56:59], v[236:239]
    buffer_load_dwordx4 v88, s[32:35], s56 offen offset:1024 nt lds
    v_mfma_f32_16x16x32_bf16 v[240:243], a[128:131], v[56:59], v[240:243]
    v_exp_f32 v70, v70
    v_mfma_f32_16x16x32_bf16 v[244:247], a[132:135], v[56:59], v[244:247]
    ds_read_b64_tr_b16 a[116:117], v12 offset:32
    v_cvt_pk_bf16_f32 v54, v68, v69
    v_mfma_f32_16x16x32_bf16 v[248:251], a[136:139], v[56:59], v[248:251]
    v_exp_f32 v71, v71
    v_mfma_f32_16x16x32_bf16 v[252:255], a[140:143], v[56:59], v[252:255]
    ds_read_b64_tr_b16 a[118:119], v12 offset:288
    v_cvt_pk_bf16_f32 v55, v70, v71
    v_mfma_f32_16x16x32_bf16 a[244:247], a[248:251], v[56:59], a[244:247]
    ds_read_b64_tr_b16 a[120:121], v12 offset:64
    ds_read_b64_tr_b16 a[122:123], v12 offset:320
    v_mfma_f32_16x16x32_bf16 v[80:83], a[80:83], a[16:19], 0
    v_exp_f32 v72, v72
    v_add_u32 v10, 33792, v10
    v_mfma_f32_16x16x32_bf16 v[80:83], a[84:87], a[20:23], v[80:83]
    ds_read_b64_tr_b16 a[124:125], v12 offset:96
    ds_read_b64_tr_b16 a[126:127], v12 offset:352
    v_add_u32 v11, 33792, v11
    v_mfma_f32_16x16x32_bf16 v[80:83], a[88:91], a[24:27], v[80:83]
    v_exp_f32 v73, v73
    v_mfma_f32_16x16x32_bf16 v[80:83], a[92:95], a[28:31], v[80:83]
    ds_read_b64_tr_b16 a[184:185], v13 offset:64
    v_cvt_pk_bf16_f32 v56, v72, v73
    v_mfma_f32_16x16x32_bf16 v[84:87], a[108:111], a[28:31], 0
    s_add_u32 m0, s58, 64
    v_exp_f32 v74, v74
    v_mfma_f32_16x16x32_bf16 v[84:87], a[104:107], a[24:27], v[84:87]
    buffer_load_dwordx4 v88, s[32:35], s56 offen offset:2048 nt lds
    v_mfma_f32_16x16x32_bf16 v[84:87], a[100:103], a[20:23], v[84:87]
    v_exp_f32 v75, v75
    v_mfma_f32_16x16x32_bf16 v[84:87], a[96:99], a[16:19], v[84:87]
    ds_read_b64_tr_b16 a[186:187], v13 offset:320
    v_cvt_pk_bf16_f32 v57, v74, v75
    v_mfma_f32_16x16x32_bf16 v[208:211], a[128:131], v[60:63], v[208:211]
    v_exp_f32 v76, v76
    v_mfma_f32_16x16x32_bf16 v[208:211], a[192:195], v[16:19], v[208:211]
    ds_read_b64_tr_b16 a[128:129], v12 offset:128
    ds_read_b64_tr_b16 a[130:131], v12 offset:384
    v_mfma_f32_16x16x32_bf16 v[212:215], a[196:199], v[16:19], v[212:215]
    s_add_u32 m0, s58, 96
    v_exp_f32 v77, v77
    v_mfma_f32_16x16x32_bf16 v[212:215], a[132:135], v[60:63], v[212:215]
    buffer_load_dwordx4 v88, s[32:35], s56 offen offset:3072 nt lds
    v_mfma_f32_16x16x32_bf16 v[216:219], a[136:139], v[60:63], v[216:219]
    v_exp_f32 v78, v78
    v_mfma_f32_16x16x32_bf16 v[216:219], a[200:203], v[16:19], v[216:219]
    ds_read_b64_tr_b16 a[192:193], v13 offset:128
    v_cvt_pk_bf16_f32 v58, v76, v77
    v_mfma_f32_16x16x32_bf16 v[220:223], a[204:207], v[16:19], v[220:223]
    v_exp_f32 v79, v79
    v_mfma_f32_16x16x32_bf16 v[220:223], a[140:143], v[60:63], v[220:223]
    ds_read_b64_tr_b16 a[194:195], v13 offset:384
    v_cvt_pk_bf16_f32 v59, v78, v79
    v_mfma_f32_16x16x32_bf16 v[64:67], a[144:147], a[16:19], 0
    v_exp_f32 v80, v80
    v_mfma_f32_16x16x32_bf16 v[64:67], a[148:151], a[20:23], v[64:67]
    ds_read_b64_tr_b16 a[196:197], v13 offset:160
    ds_read_b64_tr_b16 a[198:199], v13 offset:416
    v_add_f32 v14, v14, v80
    v_mfma_f32_16x16x32_bf16 v[64:67], a[152:155], a[24:27], v[64:67]
    v_exp_f32 v81, v81
    v_mfma_f32_16x16x32_bf16 v[64:67], a[156:159], a[28:31], v[64:67]
    s_xor_b32 s45, s52, 0
    ds_read_b64_tr_b16 a[132:133], v12 offset:160
    ds_read_b64_tr_b16 a[134:135], v12 offset:416
    v_add_f32 v14, v14, v81
    v_mfma_f32_16x16x32_bf16 v[68:71], a[172:175], a[28:31], 0
    s_add_u32 m0, s60, 101376
    v_exp_f32 v82, v82
    v_cvt_pk_bf16_f32 v60, v80, v81
    v_mfma_f32_16x16x32_bf16 v[68:71], a[168:171], a[24:27], v[68:71]
    buffer_load_dwordx4 v90, s[80:83], s45 offen offset:0 lds
    v_mfma_f32_16x16x32_bf16 v[68:71], a[164:167], a[20:23], v[68:71]
    v_exp_f32 v83, v83
    v_add_f32 v14, v14, v82
    v_mfma_f32_16x16x32_bf16 v[68:71], a[160:163], a[16:19], v[68:71]
    s_waitcnt lgkmcnt(2)
    ds_read_b64_tr_b16 a[136:137], v12 offset:192
    ds_read_b64_tr_b16 a[138:139], v12 offset:448
    v_mfma_f32_16x16x32_bf16 v[96:99], a[112:115], v[52:55], v[96:99]
    v_exp_f32 v84, v84
    v_mfma_f32_16x16x32_bf16 v[96:99], a[176:179], v[56:59], v[96:99]
    ds_read_b64_tr_b16 a[200:201], v13 offset:192
    v_add_f32 v14, v14, v84
    v_mfma_f32_16x16x32_bf16 v[100:103], a[180:183], v[56:59], v[100:103]
    s_add_u32 m0, s60, 101408
    v_exp_f32 v85, v85
    v_mfma_f32_16x16x32_bf16 v[100:103], a[116:119], v[52:55], v[100:103]
    buffer_load_dwordx4 v90, s[80:83], s45 offen offset:1024 lds
    v_mfma_f32_16x16x32_bf16 v[104:107], a[120:123], v[52:55], v[104:107]
    v_exp_f32 v86, v86
    v_mfma_f32_16x16x32_bf16 v[104:107], a[184:187], v[56:59], v[104:107]
    v_add_f32 v14, v14, v86
    v_add_f32 v14, v14, v85
    v_mfma_f32_16x16x32_bf16 v[108:111], a[188:191], v[56:59], v[108:111]
    v_exp_f32 v87, v87
    v_mfma_f32_16x16x32_bf16 v[108:111], a[124:127], v[52:55], v[108:111]
    v_add_f32 v14, v14, v87
    v_cvt_pk_bf16_f32 v63, v86, v87
    v_mfma_f32_16x16x32_bf16 a[240:243], a[248:251], v[52:55], a[240:243]
    ds_read_b64_tr_b16 a[202:203], v13 offset:448
    v_cvt_pk_bf16_f32 v62, v84, v85
    v_mfma_f32_16x16x32_bf16 a[240:243], a[248:251], v[56:59], a[240:243]
    ds_read_b64_tr_b16 a[204:205], v13 offset:224
    ds_read_b64_tr_b16 a[206:207], v13 offset:480
    v_mfma_f32_16x16x32_bf16 v[72:75], a[80:83], v[20:23], 0
    v_exp_f32 v64, v64
    v_mfma_f32_16x16x32_bf16 v[72:75], a[84:87], v[24:27], v[72:75]
    ds_read_b64_tr_b16 a[140:141], v12 offset:224
    ds_read_b64_tr_b16 a[142:143], v12 offset:480
    v_add_f32 v14, v14, v64
    v_mfma_f32_16x16x32_bf16 v[72:75], a[88:91], v[28:31], v[72:75]
    v_exp_f32 v65, v65
    v_mfma_f32_16x16x32_bf16 v[72:75], a[92:95], v[32:35], v[72:75]
    v_cvt_pk_bf16_f32 v16, v64, v65
    v_add_f32 v14, v14, v83
    v_add_f32 v14, v14, v65
    v_mfma_f32_16x16x32_bf16 v[76:79], a[108:111], v[32:35], 0
    s_add_u32 m0, s60, 101440
    v_exp_f32 v66, v66
    v_mfma_f32_16x16x32_bf16 v[76:79], a[104:107], v[28:31], v[76:79]
    buffer_load_dwordx4 v90, s[80:83], s45 offen offset:2048 lds
    v_mfma_f32_16x16x32_bf16 v[76:79], a[100:103], v[24:27], v[76:79]
    v_exp_f32 v67, v67
    v_mfma_f32_16x16x32_bf16 v[76:79], a[96:99], v[20:23], v[76:79]
    v_cvt_pk_bf16_f32 v17, v66, v67
    v_add_f32 v14, v14, v67
    v_mfma_f32_16x16x32_bf16 v[112:115], a[128:131], v[52:55], v[112:115]
    v_exp_f32 v68, v68
    v_mfma_f32_16x16x32_bf16 v[112:115], a[192:195], v[56:59], v[112:115]
    s_add_u32 m0, s60, 101472
    v_add_f32 v14, v14, v68
    v_cvt_pk_bf16_f32 v61, v82, v83
    v_mfma_f32_16x16x32_bf16 v[116:119], a[196:199], v[56:59], v[116:119]
    s_waitcnt lgkmcnt(0)
    v_exp_f32 v69, v69
    v_mfma_f32_16x16x32_bf16 v[116:119], a[132:135], v[52:55], v[116:119]
    buffer_load_dwordx4 v90, s[80:83], s45 offen offset:3072 lds
    v_mfma_f32_16x16x32_bf16 v[120:123], a[136:139], v[52:55], v[120:123]
    v_exp_f32 v70, v70
    v_mfma_f32_16x16x32_bf16 v[120:123], a[200:203], v[56:59], v[120:123]
    v_cvt_pk_bf16_f32 v18, v68, v69
    v_add_f32 v14, v14, v70
    v_mfma_f32_16x16x32_bf16 v[124:127], a[204:207], v[56:59], v[124:127]
    v_exp_f32 v71, v71
    v_mfma_f32_16x16x32_bf16 v[124:127], a[140:143], v[52:55], v[124:127]
    buffer_load_dword v92, v91, s[80:83], 0 offen
    v_mfma_f32_16x16x32_bf16 v[80:83], a[144:147], v[20:23], 0
    v_exp_f32 v72, v72
    v_add_u32 v12, 33792, v12
    v_mfma_f32_16x16x32_bf16 v[80:83], a[148:151], v[24:27], v[80:83]
    v_cvt_pk_bf16_f32 v19, v70, v71
    v_subrev_u32 v91, 98304, v91
    v_add_f32 v15, v15, v72
    v_mfma_f32_16x16x32_bf16 v[80:83], a[152:155], v[28:31], v[80:83]
    v_exp_f32 v73, v73
    v_add_u32 v13, 33792, v13
    v_mfma_f32_16x16x32_bf16 v[80:83], a[156:159], v[32:35], v[80:83]
    s_xor_b32 s45, s52, 32768
    v_add_f32 v14, v14, v71
    v_add_f32 v14, v14, v69
    v_cvt_pk_bf16_f32 v52, v72, v73
    v_mfma_f32_16x16x32_bf16 v[84:87], a[172:175], v[32:35], 0
    s_add_u32 m0, s60, 118272
    v_exp_f32 v74, v74
    v_mfma_f32_16x16x32_bf16 v[84:87], a[168:171], v[28:31], v[84:87]
    buffer_load_dwordx4 v90, s[80:83], s45 offen offset:0 lds
    v_mfma_f32_16x16x32_bf16 v[84:87], a[164:167], v[24:27], v[84:87]
    v_exp_f32 v75, v75
    v_mfma_f32_16x16x32_bf16 v[84:87], a[160:163], v[20:23], v[84:87]
    v_add_f32 v15, v15, v75
    v_cvt_pk_bf16_f32 v53, v74, v75
    v_mfma_f32_16x16x32_bf16 v[128:131], a[112:115], v[60:63], v[128:131]
    v_exp_f32 v76, v76
    v_mfma_f32_16x16x32_bf16 v[128:131], a[176:179], v[16:19], v[128:131]
    v_add_f32 v15, v15, v76
    v_add_f32 v14, v14, v66
    v_mfma_f32_16x16x32_bf16 v[132:135], a[180:183], v[16:19], v[132:135]
    s_add_u32 m0, s60, 118304
    v_exp_f32 v77, v77
    v_mfma_f32_16x16x32_bf16 v[132:135], a[116:119], v[60:63], v[132:135]
    buffer_load_dwordx4 v90, s[80:83], s45 offen offset:1024 lds
    v_mfma_f32_16x16x32_bf16 v[136:139], a[120:123], v[60:63], v[136:139]
    v_exp_f32 v78, v78
    v_mfma_f32_16x16x32_bf16 v[136:139], a[184:187], v[16:19], v[136:139]
    v_add_f32 v15, v15, v78
    v_add_f32 v15, v15, v77
    v_mfma_f32_16x16x32_bf16 v[140:143], a[188:191], v[16:19], v[140:143]
    v_exp_f32 v79, v79
    v_mfma_f32_16x16x32_bf16 v[140:143], a[124:127], v[60:63], v[140:143]
    v_add_f32 v15, v15, v79
    v_cvt_pk_bf16_f32 v55, v78, v79
    v_mfma_f32_16x16x32_bf16 v[64:67], a[80:83], v[36:39], 0
    v_exp_f32 v80, v80
    v_mfma_f32_16x16x32_bf16 v[64:67], a[84:87], v[40:43], v[64:67]
    v_cvt_pk_bf16_f32 v54, v76, v77
    v_add_f32 v15, v15, v74
    v_add_f32 v15, v15, v80
    v_mfma_f32_16x16x32_bf16 v[64:67], a[88:91], v[44:47], v[64:67]
    v_exp_f32 v81, v81
    v_mfma_f32_16x16x32_bf16 v[64:67], a[92:95], v[48:51], v[64:67]
    v_cvt_pk_bf16_f32 v56, v80, v81
    v_add_f32 v15, v15, v73
    v_add_f32 v15, v15, v81
    v_mfma_f32_16x16x32_bf16 v[68:71], a[108:111], v[48:51], 0
    s_add_u32 m0, s60, 118336
    v_exp_f32 v82, v82
    v_mfma_f32_16x16x32_bf16 v[68:71], a[104:107], v[44:47], v[68:71]
    buffer_load_dwordx4 v90, s[80:83], s45 offen offset:2048 lds
    v_mfma_f32_16x16x32_bf16 v[68:71], a[100:103], v[40:43], v[68:71]
    v_exp_f32 v83, v83
    v_mfma_f32_16x16x32_bf16 v[68:71], a[96:99], v[36:39], v[68:71]
    v_cvt_pk_bf16_f32 v57, v82, v83
    v_add_f32 v15, v15, v83
    v_mfma_f32_16x16x32_bf16 v[144:147], a[128:131], v[60:63], v[144:147]
    v_exp_f32 v84, v84
    v_mfma_f32_16x16x32_bf16 v[144:147], a[192:195], v[16:19], v[144:147]
    v_add_f32 v15, v15, v84
    v_add_f32 v15, v15, v82
    v_mfma_f32_16x16x32_bf16 v[148:151], a[196:199], v[16:19], v[148:151]
    s_add_u32 m0, s60, 118368
    v_exp_f32 v85, v85
    v_mfma_f32_16x16x32_bf16 v[148:151], a[132:135], v[60:63], v[148:151]
    buffer_load_dwordx4 v90, s[80:83], s45 offen offset:3072 lds
    v_mfma_f32_16x16x32_bf16 v[152:155], a[136:139], v[60:63], v[152:155]
    v_exp_f32 v86, v86
    v_mfma_f32_16x16x32_bf16 v[152:155], a[200:203], v[16:19], v[152:155]
    v_cvt_pk_bf16_f32 v58, v84, v85
    v_add_f32 v15, v15, v86
    v_mfma_f32_16x16x32_bf16 v[156:159], a[204:207], v[16:19], v[156:159]
    v_exp_f32 v87, v87
    v_mfma_f32_16x16x32_bf16 v[156:159], a[140:143], v[60:63], v[156:159]
    buffer_load_dword v92, v91, s[80:83], 0 offen
    s_waitcnt vmcnt(19)
    s_barrier
    v_mfma_f32_16x16x32_bf16 v[72:75], a[144:147], v[36:39], 0
    ds_read_b128 a[144:147], v11 offset:0
    v_exp_f32 v64, v64
    v_mfma_f32_16x16x32_bf16 v[72:75], a[148:151], v[40:43], v[72:75]
    s_xor_b32 s45, s52, 65536
    v_cvt_pk_bf16_f32 v59, v86, v87
    v_subrev_u32 v91, 98304, v91
    v_add_f32 v89, v89, v64
    v_mfma_f32_16x16x32_bf16 v[72:75], a[152:155], v[44:47], v[72:75]
    s_add_u32 m0, s60, 135168
    ds_read_b128 a[148:151], v11 offset:64
    v_exp_f32 v65, v65
    v_mfma_f32_16x16x32_bf16 v[72:75], a[156:159], v[48:51], v[72:75]
    buffer_load_dwordx4 v90, s[80:83], s45 offen offset:0 lds
    v_mfma_f32_16x16x32_bf16 v[76:79], a[172:175], v[48:51], 0
    v_exp_f32 v66, v66
    v_add_f32 v89, v89, v65
    v_mfma_f32_16x16x32_bf16 v[76:79], a[168:171], v[44:47], v[76:79]
    v_add_f32 v15, v15, v87
    v_add_f32 v15, v15, v85
    v_add_f32 v89, v89, v66
    v_mfma_f32_16x16x32_bf16 v[76:79], a[164:167], v[40:43], v[76:79]
    v_exp_f32 v67, v67
    v_cvt_pk_bf16_f32 v60, v64, v65
    v_mfma_f32_16x16x32_bf16 v[76:79], a[160:163], v[36:39], v[76:79]
    ds_read_b128 a[152:155], v11 offset:128
    v_add_f32 v89, v89, v67
    v_cvt_pk_bf16_f32 v61, v66, v67
    v_mfma_f32_16x16x32_bf16 v[160:163], a[112:115], v[52:55], v[160:163]
    s_add_u32 m0, s60, 135200
    ds_read_b128 a[156:159], v11 offset:192
    v_exp_f32 v68, v68
    v_mfma_f32_16x16x32_bf16 v[160:163], a[176:179], v[56:59], v[160:163]
    buffer_load_dwordx4 v90, s[80:83], s45 offen offset:1024 lds
    v_mfma_f32_16x16x32_bf16 v[164:167], a[180:183], v[56:59], v[164:167]
    ds_read_b128 a[172:175], v11 offset:448
    v_exp_f32 v69, v69
    v_mfma_f32_16x16x32_bf16 v[164:167], a[116:119], v[52:55], v[164:167]
    ds_read_b128 a[168:171], v11 offset:384
    v_add_f32 v89, v89, v69
    v_cvt_pk_bf16_f32 v62, v68, v69
    v_mfma_f32_16x16x32_bf16 v[168:171], a[120:123], v[52:55], v[168:171]
    ds_read_b128 a[164:167], v11 offset:320
    v_exp_f32 v70, v70
    v_mfma_f32_16x16x32_bf16 v[168:171], a[184:187], v[56:59], v[168:171]
    ds_read_b128 a[160:163], v11 offset:256
    v_add_f32 v89, v89, v70
    v_add_f32 v89, v89, v68
    v_mfma_f32_16x16x32_bf16 v[172:175], a[188:191], v[56:59], v[172:175]
    v_exp_f32 v71, v71
    v_mfma_f32_16x16x32_bf16 v[172:175], a[124:127], v[52:55], v[172:175]
    v_add_f32 v89, v89, v71
    v_cvt_pk_bf16_f32 v63, v70, v71
    v_mfma_f32_16x16x32_bf16 v[80:83], a[80:83], a[64:67], 0
    v_exp_f32 v72, v72
    v_mfma_f32_16x16x32_bf16 v[80:83], a[84:87], a[68:71], v[80:83]
    ds_read_b128 a[80:83], v10 offset:0
    ds_read_b128 a[84:87], v10 offset:64
    v_add_f32 v89, v89, v72
    v_mfma_f32_16x16x32_bf16 v[80:83], a[88:91], a[72:75], v[80:83]
    v_exp_f32 v73, v73
    v_mfma_f32_16x16x32_bf16 v[80:83], a[92:95], a[76:79], v[80:83]
    ds_read_b128 a[88:91], v10 offset:128
    ds_read_b128 a[92:95], v10 offset:192
    v_cvt_pk_bf16_f32 v16, v72, v73
    v_mfma_f32_16x16x32_bf16 v[84:87], a[108:111], a[76:79], 0
    v_exp_f32 v74, v74
    v_add_f32 v89, v89, v73
    v_mfma_f32_16x16x32_bf16 v[84:87], a[104:107], a[72:75], v[84:87]
    ds_read_b128 a[108:111], v10 offset:448
    ds_read_b128 a[104:107], v10 offset:384
    v_add_f32 v89, v89, v74
    v_mfma_f32_16x16x32_bf16 v[84:87], a[100:103], a[68:71], v[84:87]
    v_exp_f32 v75, v75
    v_mfma_f32_16x16x32_bf16 v[84:87], a[96:99], a[64:67], v[84:87]
    ds_read_b128 a[100:103], v10 offset:320
    ds_read_b128 a[96:99], v10 offset:256
    v_mfma_f32_16x16x32_bf16 v[176:179], a[128:131], v[52:55], v[176:179]
    s_add_u32 m0, s60, 135232
    v_exp_f32 v76, v76
    v_mfma_f32_16x16x32_bf16 v[176:179], a[192:195], v[56:59], v[176:179]
    buffer_load_dwordx4 v90, s[80:83], s45 offen offset:2048 lds
    v_mfma_f32_16x16x32_bf16 v[180:183], a[196:199], v[56:59], v[180:183]
    v_exp_f32 v77, v77
    v_mfma_f32_16x16x32_bf16 v[180:183], a[132:135], v[52:55], v[180:183]
    v_cvt_pk_bf16_f32 v18, v76, v77
    v_cvt_pk_bf16_f32 v17, v74, v75
    v_mfma_f32_16x16x32_bf16 v[184:187], a[136:139], v[52:55], v[184:187]
    s_add_u32 m0, s60, 135264
    v_exp_f32 v78, v78
    v_mfma_f32_16x16x32_bf16 v[184:187], a[200:203], v[56:59], v[184:187]
    buffer_load_dwordx4 v90, s[80:83], s45 offen offset:3072 lds
    v_mfma_f32_16x16x32_bf16 v[188:191], a[204:207], v[56:59], v[188:191]
    s_xor_b32 s45, s52, 98304
    v_exp_f32 v79, v79
    v_mfma_f32_16x16x32_bf16 v[188:191], a[140:143], v[52:55], v[188:191]
    s_waitcnt lgkmcnt(0)
    v_cvt_pk_bf16_f32 v19, v78, v79
    v_add_f32 v89, v89, v79
    v_mfma_f32_16x16x32_bf16 v[64:67], a[80:83], a[0:3], 0
    s_add_u32 m0, s60, 33792
    v_exp_f32 v80, v80
    v_mfma_f32_16x16x32_bf16 v[64:67], a[84:87], a[4:7], v[64:67]
    buffer_load_dwordx4 v90, s[80:83], s45 offen offset:0 lds
    v_mfma_f32_16x16x32_bf16 v[64:67], a[88:91], a[8:11], v[64:67]
    v_exp_f32 v81, v81
    v_mfma_f32_16x16x32_bf16 v[64:67], a[92:95], a[12:15], v[64:67]
    v_cvt_pk_bf16_f32 v56, v80, v81
    v_add_f32 v89, v89, v78
    v_mfma_f32_16x16x32_bf16 v[68:71], a[108:111], a[12:15], 0
    s_add_u32 m0, s60, 33824
    v_exp_f32 v82, v82
    v_mfma_f32_16x16x32_bf16 v[68:71], a[104:107], a[8:11], v[68:71]
    buffer_load_dwordx4 v90, s[80:83], s45 offen offset:1024 lds
    v_mfma_f32_16x16x32_bf16 v[68:71], a[100:103], a[4:7], v[68:71]
    v_exp_f32 v83, v83
    v_mfma_f32_16x16x32_bf16 v[68:71], a[96:99], a[0:3], v[68:71]
    v_cvt_pk_bf16_f32 v57, v82, v83
    v_add_f32 v89, v89, v77
    v_mfma_f32_16x16x32_bf16 v[192:195], a[112:115], v[60:63], v[192:195]
    s_add_u32 m0, s60, 33856
    v_exp_f32 v84, v84
    v_mfma_f32_16x16x32_bf16 v[192:195], a[176:179], v[16:19], v[192:195]
    buffer_load_dwordx4 v90, s[80:83], s45 offen offset:2048 lds
    v_mfma_f32_16x16x32_bf16 v[196:199], a[180:183], v[16:19], v[196:199]
    v_exp_f32 v85, v85
    v_mfma_f32_16x16x32_bf16 v[196:199], a[116:119], v[60:63], v[196:199]
    v_cvt_pk_bf16_f32 v58, v84, v85
    v_add_f32 v89, v89, v76
    v_mfma_f32_16x16x32_bf16 v[200:203], a[120:123], v[60:63], v[200:203]
    s_add_u32 m0, s60, 33888
    v_exp_f32 v86, v86
    v_mfma_f32_16x16x32_bf16 v[200:203], a[184:187], v[16:19], v[200:203]
    buffer_load_dwordx4 v90, s[80:83], s45 offen offset:3072 lds
    v_mfma_f32_16x16x32_bf16 v[204:207], a[188:191], v[16:19], v[204:207]
    v_exp_f32 v87, v87
    v_mfma_f32_16x16x32_bf16 v[204:207], a[124:127], v[60:63], v[204:207]
    v_cvt_pk_bf16_f32 v59, v86, v87
    v_add_f32 v89, v89, v75
    v_mfma_f32_16x16x32_bf16 v[72:75], a[144:147], a[0:3], 0
    ds_read_b64_tr_b16 a[188:189], v13 offset:96
    v_exp_f32 v64, v64
    v_mfma_f32_16x16x32_bf16 v[72:75], a[148:151], a[4:7], v[72:75]
    ds_read_b64_tr_b16 a[176:177], v13 offset:0
    ds_read_b64_tr_b16 a[178:179], v13 offset:256
    ds_read_b64_tr_b16 a[190:191], v13 offset:352
    v_mfma_f32_16x16x32_bf16 v[72:75], a[152:155], a[8:11], v[72:75]
    v_exp_f32 v65, v65
    v_mfma_f32_16x16x32_bf16 v[72:75], a[156:159], a[12:15], v[72:75]
    s_xor_b32 s45, s52, 131072
    ds_read_b64_tr_b16 a[180:181], v13 offset:32
    v_cvt_pk_bf16_f32 v52, v64, v65
    v_mfma_f32_16x16x32_bf16 v[76:79], a[172:175], a[12:15], 0
    s_add_u32 m0, s60, 50688
    v_exp_f32 v66, v66
    v_mfma_f32_16x16x32_bf16 v[76:79], a[168:171], a[8:11], v[76:79]
    buffer_load_dwordx4 v90, s[80:83], s45 offen offset:0 lds
    v_mfma_f32_16x16x32_bf16 v[76:79], a[164:167], a[4:7], v[76:79]
    v_exp_f32 v67, v67
    v_mfma_f32_16x16x32_bf16 v[76:79], a[160:163], a[0:3], v[76:79]
    ds_read_b64_tr_b16 a[182:183], v13 offset:288
    v_cvt_pk_bf16_f32 v53, v66, v67
    v_mfma_f32_16x16x32_bf16 v[224:227], a[112:115], v[56:59], v[224:227]
    v_exp_f32 v68, v68
    v_mfma_f32_16x16x32_bf16 v[228:231], a[116:119], v[56:59], v[228:231]
    ds_read_b64_tr_b16 a[112:113], v12 offset:0
    ds_read_b64_tr_b16 a[114:115], v12 offset:256
    v_mfma_f32_16x16x32_bf16 v[232:235], a[120:123], v[56:59], v[232:235]
    s_add_u32 m0, s60, 50720
    v_exp_f32 v69, v69
    v_mfma_f32_16x16x32_bf16 v[236:239], a[124:127], v[56:59], v[236:239]
    buffer_load_dwordx4 v90, s[80:83], s45 offen offset:1024 lds
    v_mfma_f32_16x16x32_bf16 v[240:243], a[128:131], v[56:59], v[240:243]
    v_exp_f32 v70, v70
    v_mfma_f32_16x16x32_bf16 v[244:247], a[132:135], v[56:59], v[244:247]
    ds_read_b64_tr_b16 a[116:117], v12 offset:32
    v_cvt_pk_bf16_f32 v54, v68, v69
    v_mfma_f32_16x16x32_bf16 v[248:251], a[136:139], v[56:59], v[248:251]
    v_exp_f32 v71, v71
    v_mfma_f32_16x16x32_bf16 v[252:255], a[140:143], v[56:59], v[252:255]
    ds_read_b64_tr_b16 a[118:119], v12 offset:288
    v_cvt_pk_bf16_f32 v55, v70, v71
    v_mfma_f32_16x16x32_bf16 a[244:247], a[248:251], v[56:59], a[244:247]
    ds_read_b64_tr_b16 a[120:121], v12 offset:64
    ds_read_b64_tr_b16 a[122:123], v12 offset:320
    v_mfma_f32_16x16x32_bf16 v[80:83], a[80:83], a[16:19], 0
    v_exp_f32 v72, v72
    v_add_u32 v10, -67584, v10
    v_mfma_f32_16x16x32_bf16 v[80:83], a[84:87], a[20:23], v[80:83]
    ds_read_b64_tr_b16 a[124:125], v12 offset:96
    ds_read_b64_tr_b16 a[126:127], v12 offset:352
    v_add_u32 v11, -67584, v11
    v_mfma_f32_16x16x32_bf16 v[80:83], a[88:91], a[24:27], v[80:83]
    v_exp_f32 v73, v73
    v_mfma_f32_16x16x32_bf16 v[80:83], a[92:95], a[28:31], v[80:83]
    ds_read_b64_tr_b16 a[184:185], v13 offset:64
    v_cvt_pk_bf16_f32 v56, v72, v73
    v_mfma_f32_16x16x32_bf16 v[84:87], a[108:111], a[28:31], 0
    s_add_u32 m0, s60, 50752
    v_exp_f32 v74, v74
    v_mfma_f32_16x16x32_bf16 v[84:87], a[104:107], a[24:27], v[84:87]
    buffer_load_dwordx4 v90, s[80:83], s45 offen offset:2048 lds
    v_mfma_f32_16x16x32_bf16 v[84:87], a[100:103], a[20:23], v[84:87]
    v_exp_f32 v75, v75
    v_mfma_f32_16x16x32_bf16 v[84:87], a[96:99], a[16:19], v[84:87]
    ds_read_b64_tr_b16 a[186:187], v13 offset:320
    v_cvt_pk_bf16_f32 v57, v74, v75
    v_mfma_f32_16x16x32_bf16 v[208:211], a[128:131], v[60:63], v[208:211]
    v_exp_f32 v76, v76
    v_mfma_f32_16x16x32_bf16 v[208:211], a[192:195], v[16:19], v[208:211]
    ds_read_b64_tr_b16 a[128:129], v12 offset:128
    ds_read_b64_tr_b16 a[130:131], v12 offset:384
    v_mfma_f32_16x16x32_bf16 v[212:215], a[196:199], v[16:19], v[212:215]
    s_add_u32 m0, s60, 50784
    v_exp_f32 v77, v77
    v_mfma_f32_16x16x32_bf16 v[212:215], a[132:135], v[60:63], v[212:215]
    buffer_load_dwordx4 v90, s[80:83], s45 offen offset:3072 lds
    v_mfma_f32_16x16x32_bf16 v[216:219], a[136:139], v[60:63], v[216:219]
    v_exp_f32 v78, v78
    v_mfma_f32_16x16x32_bf16 v[216:219], a[200:203], v[16:19], v[216:219]
    ds_read_b64_tr_b16 a[192:193], v13 offset:128
    v_cvt_pk_bf16_f32 v58, v76, v77
    v_mfma_f32_16x16x32_bf16 v[220:223], a[204:207], v[16:19], v[220:223]
    v_exp_f32 v79, v79
    v_mfma_f32_16x16x32_bf16 v[220:223], a[140:143], v[60:63], v[220:223]
    ds_read_b64_tr_b16 a[194:195], v13 offset:384
    v_cvt_pk_bf16_f32 v59, v78, v79
    v_mfma_f32_16x16x32_bf16 v[64:67], a[144:147], a[16:19], 0
    v_exp_f32 v80, v80
    v_mfma_f32_16x16x32_bf16 v[64:67], a[148:151], a[20:23], v[64:67]
    ds_read_b64_tr_b16 a[196:197], v13 offset:160
    ds_read_b64_tr_b16 a[198:199], v13 offset:416
    v_add_f32 v14, v14, v80
    v_mfma_f32_16x16x32_bf16 v[64:67], a[152:155], a[24:27], v[64:67]
    v_exp_f32 v81, v81
    v_mfma_f32_16x16x32_bf16 v[64:67], a[156:159], a[28:31], v[64:67]
    ds_read_b64_tr_b16 a[132:133], v12 offset:160
    ds_read_b64_tr_b16 a[134:135], v12 offset:416
    v_add_f32 v14, v14, v81
    v_mfma_f32_16x16x32_bf16 v[68:71], a[172:175], a[28:31], 0
    v_exp_f32 v82, v82
    v_cvt_pk_bf16_f32 v60, v80, v81
    v_mfma_f32_16x16x32_bf16 v[68:71], a[168:171], a[24:27], v[68:71]
    buffer_load_dword v92, v91, s[80:83], 0 offen
    v_mfma_f32_16x16x32_bf16 v[68:71], a[164:167], a[20:23], v[68:71]
    v_exp_f32 v83, v83
    v_add_f32 v14, v14, v82
    v_mfma_f32_16x16x32_bf16 v[68:71], a[160:163], a[16:19], v[68:71]
    s_waitcnt lgkmcnt(2)
    ds_read_b64_tr_b16 a[136:137], v12 offset:192
    v_subrev_u32 v91, 98304, v91
    v_mfma_f32_16x16x32_bf16 v[96:99], a[112:115], v[52:55], v[96:99]
    s_waitcnt vmcnt(19)
    ds_read_b64_tr_b16 a[32:33], v5 offset:33792
    v_exp_f32 v84, v84
    v_mfma_f32_16x16x32_bf16 v[96:99], a[176:179], v[56:59], v[96:99]
    ds_read_b64_tr_b16 a[138:139], v12 offset:448
    ds_read_b64_tr_b16 a[34:35], v5 offset:34304
    v_add_f32 v14, v14, v84
    v_mfma_f32_16x16x32_bf16 v[100:103], a[180:183], v[56:59], v[100:103]
    ds_read_b64_tr_b16 a[36:37], v5 offset:33824
    v_exp_f32 v85, v85
    v_mfma_f32_16x16x32_bf16 v[100:103], a[116:119], v[52:55], v[100:103]
    ds_read_b64_tr_b16 a[38:39], v5 offset:34336
    v_add_f32 v14, v14, v85
    v_cvt_pk_bf16_f32 v62, v84, v85
    v_mfma_f32_16x16x32_bf16 v[104:107], a[120:123], v[52:55], v[104:107]
    ds_read_b64_tr_b16 a[40:41], v5 offset:33856
    v_exp_f32 v86, v86
    v_mfma_f32_16x16x32_bf16 v[104:107], a[184:187], v[56:59], v[104:107]
    ds_read_b64_tr_b16 a[200:201], v13 offset:192
    ds_read_b64_tr_b16 a[42:43], v5 offset:34368
    v_add_f32 v14, v14, v86
    v_mfma_f32_16x16x32_bf16 v[108:111], a[188:191], v[56:59], v[108:111]
    ds_read_b64_tr_b16 a[44:45], v5 offset:33888
    v_exp_f32 v87, v87
    v_mfma_f32_16x16x32_bf16 v[108:111], a[124:127], v[52:55], v[108:111]
    ds_read_b64_tr_b16 a[46:47], v5 offset:34400
    v_add_f32 v14, v14, v87
    v_cvt_pk_bf16_f32 v63, v86, v87
    v_mfma_f32_16x16x32_bf16 a[240:243], a[248:251], v[52:55], a[240:243]
    ds_read_b64_tr_b16 a[202:203], v13 offset:448
    ds_read_b64_tr_b16 a[204:205], v13 offset:224
    v_mfma_f32_16x16x32_bf16 a[240:243], a[248:251], v[56:59], a[240:243]
    ds_read_b64_tr_b16 a[206:207], v13 offset:480
    ds_read_b64_tr_b16 a[140:141], v12 offset:224
    v_mfma_f32_16x16x32_bf16 v[72:75], a[80:83], v[20:23], 0
    v_exp_f32 v64, v64
    v_mfma_f32_16x16x32_bf16 v[72:75], a[84:87], v[24:27], v[72:75]
    ds_read_b64_tr_b16 a[142:143], v12 offset:480
    v_add_f32 v14, v14, v83
    v_add_f32 v14, v14, v64
    v_mfma_f32_16x16x32_bf16 v[72:75], a[88:91], v[28:31], v[72:75]
    v_exp_f32 v65, v65
    v_mfma_f32_16x16x32_bf16 v[72:75], a[92:95], v[32:35], v[72:75]
    v_cvt_pk_bf16_f32 v16, v64, v65
    v_cvt_pk_bf16_f32 v61, v82, v83
    v_add_f32 v14, v14, v65
    v_mfma_f32_16x16x32_bf16 v[76:79], a[108:111], v[32:35], 0
    v_exp_f32 v66, v66
    v_mfma_f32_16x16x32_bf16 v[76:79], a[104:107], v[28:31], v[76:79]
    buffer_load_dword v92, v91, s[80:83], 0 offen
    v_mfma_f32_16x16x32_bf16 v[76:79], a[100:103], v[24:27], v[76:79]
    v_exp_f32 v67, v67
    v_add_f32 v14, v14, v66
    v_mfma_f32_16x16x32_bf16 v[76:79], a[96:99], v[20:23], v[76:79]
    v_subrev_u32 v91, 98304, v91
    v_cvt_pk_bf16_f32 v17, v66, v67
    v_mfma_f32_16x16x32_bf16 v[112:115], a[128:131], v[52:55], v[112:115]
    s_waitcnt vmcnt(15)
    v_exp_f32 v68, v68
    v_mfma_f32_16x16x32_bf16 v[112:115], a[192:195], v[56:59], v[112:115]
    ds_read_b64_tr_b16 a[48:49], v5 offset:50688
    v_add_f32 v14, v14, v68
    v_mfma_f32_16x16x32_bf16 v[116:119], a[196:199], v[56:59], v[116:119]
    s_waitcnt lgkmcnt(1)
    v_exp_f32 v69, v69
    v_mfma_f32_16x16x32_bf16 v[116:119], a[132:135], v[52:55], v[116:119]
    v_cvt_pk_bf16_f32 v18, v68, v69
    v_add_f32 v14, v14, v69
    v_mfma_f32_16x16x32_bf16 v[120:123], a[136:139], v[52:55], v[120:123]
    v_exp_f32 v70, v70
    v_mfma_f32_16x16x32_bf16 v[120:123], a[200:203], v[56:59], v[120:123]
    ds_read_b64_tr_b16 a[50:51], v5 offset:51200
    v_add_f32 v14, v14, v70
    v_mfma_f32_16x16x32_bf16 v[124:127], a[204:207], v[56:59], v[124:127]
    v_exp_f32 v71, v71
    v_mfma_f32_16x16x32_bf16 v[124:127], a[140:143], v[52:55], v[124:127]
    v_cvt_pk_bf16_f32 v19, v70, v71
    v_add_f32 v14, v14, v71
    v_mfma_f32_16x16x32_bf16 v[80:83], a[144:147], v[20:23], 0
    s_branch L_pg9
    .p2align 12
L_stub9:
    s_branch L_stub13
L_pg9:
    v_exp_f32 v72, v72
    v_add_u32 v12, -67584, v12
    v_mfma_f32_16x16x32_bf16 v[80:83], a[148:151], v[24:27], v[80:83]
    ds_read_b64_tr_b16 a[52:53], v5 offset:50720
    ds_read_b64_tr_b16 a[54:55], v5 offset:51232
    v_add_f32 v15, v15, v72
    v_mfma_f32_16x16x32_bf16 v[80:83], a[152:155], v[28:31], v[80:83]
    v_exp_f32 v73, v73
    v_add_u32 v13, -67584, v13
    v_mfma_f32_16x16x32_bf16 v[80:83], a[156:159], v[32:35], v[80:83]
    s_xor_b32 s45, s52, 163840
    ds_read_b64_tr_b16 a[56:57], v5 offset:50752
    ds_read_b64_tr_b16 a[58:59], v5 offset:51264
    v_add_f32 v15, v15, v73
    v_mfma_f32_16x16x32_bf16 v[84:87], a[172:175], v[32:35], 0
    s_add_u32 m0, s60, 101376
    v_exp_f32 v74, v74
    v_cvt_pk_bf16_f32 v52, v72, v73
    v_mfma_f32_16x16x32_bf16 v[84:87], a[168:171], v[28:31], v[84:87]
    buffer_load_dwordx4 v90, s[80:83], s45 offen offset:0 lds
    v_mfma_f32_16x16x32_bf16 v[84:87], a[164:167], v[24:27], v[84:87]
    v_exp_f32 v75, v75
    v_add_f32 v15, v15, v74
    v_mfma_f32_16x16x32_bf16 v[84:87], a[160:163], v[20:23], v[84:87]
    ds_read_b64_tr_b16 a[60:61], v5 offset:50784
    ds_read_b64_tr_b16 a[62:63], v5 offset:51296
    v_cvt_pk_bf16_f32 v53, v74, v75
    v_mfma_f32_16x16x32_bf16 v[128:131], a[112:115], v[60:63], v[128:131]
    v_exp_f32 v76, v76
    v_mfma_f32_16x16x32_bf16 v[128:131], a[176:179], v[16:19], v[128:131]
    v_add_f32 v15, v15, v76
    v_add_f32 v14, v14, v67
    v_mfma_f32_16x16x32_bf16 v[132:135], a[180:183], v[16:19], v[132:135]
    s_add_u32 m0, s60, 101408
    v_exp_f32 v77, v77
    v_mfma_f32_16x16x32_bf16 v[132:135], a[116:119], v[60:63], v[132:135]
    buffer_load_dwordx4 v90, s[80:83], s45 offen offset:1024 lds
    v_mfma_f32_16x16x32_bf16 v[136:139], a[120:123], v[60:63], v[136:139]
    v_exp_f32 v78, v78
    v_mfma_f32_16x16x32_bf16 v[136:139], a[184:187], v[16:19], v[136:139]
    v_add_f32 v15, v15, v78
    v_add_f32 v15, v15, v77
    v_mfma_f32_16x16x32_bf16 v[140:143], a[188:191], v[16:19], v[140:143]
    v_exp_f32 v79, v79
    v_mfma_f32_16x16x32_bf16 v[140:143], a[124:127], v[60:63], v[140:143]
    s_add_u32 m0, s60, 101440
    v_add_f32 v15, v15, v79
    v_cvt_pk_bf16_f32 v55, v78, v79
    v_mfma_f32_16x16x32_bf16 v[64:67], a[80:83], v[36:39], 0
    s_waitcnt vmcnt(12)
    ds_read_b64_tr_b16 a[208:209], v93 offset:0
    v_exp_f32 v80, v80
    v_mfma_f32_16x16x32_bf16 v[64:67], a[84:87], v[40:43], v[64:67]
    buffer_load_dwordx4 v90, s[80:83], s45 offen offset:2048 lds
    v_mfma_f32_16x16x32_bf16 v[64:67], a[88:91], v[44:47], v[64:67]
    v_exp_f32 v81, v81
    v_add_f32 v15, v15, v80
    v_mfma_f32_16x16x32_bf16 v[64:67], a[92:95], v[48:51], v[64:67]
    v_cvt_pk_bf16_f32 v56, v80, v81
    v_cvt_pk_bf16_f32 v54, v76, v77
    v_add_f32 v15, v15, v81
    v_mfma_f32_16x16x32_bf16 v[68:71], a[108:111], v[48:51], 0
    s_add_u32 m0, s60, 101472
    ds_read_b64_tr_b16 a[210:211], v93 offset:512
    v_exp_f32 v82, v82
    v_mfma_f32_16x16x32_bf16 v[68:71], a[104:107], v[44:47], v[68:71]
    buffer_load_dwordx4 v90, s[80:83], s45 offen offset:3072 lds
    v_mfma_f32_16x16x32_bf16 v[68:71], a[100:103], v[40:43], v[68:71]
    ds_read_b64_tr_b16 a[212:213], v93 offset:32
    v_exp_f32 v83, v83
    v_mfma_f32_16x16x32_bf16 v[68:71], a[96:99], v[36:39], v[68:71]
    s_xor_b32 s45, s52, 196608
    ds_read_b64_tr_b16 a[214:215], v93 offset:544
    v_cvt_pk_bf16_f32 v57, v82, v83
    v_add_f32 v15, v15, v75
    v_mfma_f32_16x16x32_bf16 v[144:147], a[128:131], v[60:63], v[144:147]
    s_add_u32 m0, s60, 118272
    ds_read_b64_tr_b16 a[216:217], v93 offset:64
    v_exp_f32 v84, v84
    v_mfma_f32_16x16x32_bf16 v[144:147], a[192:195], v[16:19], v[144:147]
    s_waitcnt lgkmcnt(4)
    buffer_load_dwordx4 v90, s[80:83], s45 offen offset:0 lds
    v_mfma_f32_16x16x32_bf16 v[148:151], a[196:199], v[16:19], v[148:151]
    ds_read_b64_tr_b16 a[218:219], v93 offset:576
    v_exp_f32 v85, v85
    v_mfma_f32_16x16x32_bf16 v[148:151], a[132:135], v[60:63], v[148:151]
    ds_read_b64_tr_b16 a[220:221], v93 offset:96
    v_cvt_pk_bf16_f32 v58, v84, v85
    v_add_f32 v15, v15, v85
    v_mfma_f32_16x16x32_bf16 v[152:155], a[136:139], v[60:63], v[152:155]
    s_add_u32 m0, s60, 118304
    ds_read_b64_tr_b16 a[222:223], v93 offset:608
    v_exp_f32 v86, v86
    v_mfma_f32_16x16x32_bf16 v[152:155], a[200:203], v[16:19], v[152:155]
    buffer_load_dwordx4 v90, s[80:83], s45 offen offset:1024 lds
    v_mfma_f32_16x16x32_bf16 v[156:159], a[204:207], v[16:19], v[156:159]
    v_exp_f32 v87, v87
    v_mfma_f32_16x16x32_bf16 v[156:159], a[140:143], v[60:63], v[156:159]
    v_cvt_pk_bf16_f32 v59, v86, v87
    v_add_f32 v15, v15, v87
    s_barrier
    v_mfma_f32_16x16x32_bf16 v[72:75], a[144:147], v[36:39], 0
    ds_read_b128 a[144:147], v11 offset:0
    v_exp_f32 v64, v64
    v_mfma_f32_16x16x32_bf16 v[72:75], a[148:151], v[40:43], v[72:75]
    v_add_f32 v15, v15, v86
    v_add_f32 v15, v15, v84
    v_add_f32 v89, v89, v64
    v_mfma_f32_16x16x32_bf16 v[72:75], a[152:155], v[44:47], v[72:75]
    s_add_u32 m0, s60, 118336
    ds_read_b128 a[148:151], v11 offset:64
    v_exp_f32 v65, v65
    v_mfma_f32_16x16x32_bf16 v[72:75], a[156:159], v[48:51], v[72:75]
    buffer_load_dwordx4 v90, s[80:83], s45 offen offset:2048 lds
    v_mfma_f32_16x16x32_bf16 v[76:79], a[172:175], v[48:51], 0
    v_exp_f32 v66, v66
    v_add_f32 v89, v89, v65
    v_mfma_f32_16x16x32_bf16 v[76:79], a[168:171], v[44:47], v[76:79]
    v_add_f32 v15, v15, v83
    v_add_f32 v15, v15, v82
    v_add_f32 v89, v89, v66
    v_mfma_f32_16x16x32_bf16 v[76:79], a[164:167], v[40:43], v[76:79]
    v_exp_f32 v67, v67
    v_cvt_pk_bf16_f32 v60, v64, v65
    v_mfma_f32_16x16x32_bf16 v[76:79], a[160:163], v[36:39], v[76:79]
    ds_read_b128 a[152:155], v11 offset:128
    v_add_f32 v89, v89, v67
    v_cvt_pk_bf16_f32 v61, v66, v67
    v_mfma_f32_16x16x32_bf16 v[160:163], a[112:115], v[52:55], v[160:163]
    s_add_u32 m0, s60, 118368
    ds_read_b128 a[156:159], v11 offset:192
    v_exp_f32 v68, v68
    v_mfma_f32_16x16x32_bf16 v[160:163], a[176:179], v[56:59], v[160:163]
    buffer_load_dwordx4 v90, s[80:83], s45 offen offset:3072 lds
    v_mfma_f32_16x16x32_bf16 v[164:167], a[180:183], v[56:59], v[164:167]
    ds_read_b128 a[172:175], v11 offset:448
    v_exp_f32 v69, v69
    v_mfma_f32_16x16x32_bf16 v[164:167], a[116:119], v[52:55], v[164:167]
    ds_read_b128 a[168:171], v11 offset:384
    v_add_f32 v89, v89, v69
    v_cvt_pk_bf16_f32 v62, v68, v69
    v_mfma_f32_16x16x32_bf16 v[168:171], a[120:123], v[52:55], v[168:171]
    ds_read_b128 a[164:167], v11 offset:320
    v_exp_f32 v70, v70
    v_mfma_f32_16x16x32_bf16 v[168:171], a[184:187], v[56:59], v[168:171]
    ds_read_b128 a[160:163], v11 offset:256
    v_add_f32 v89, v89, v70
    v_add_f32 v89, v89, v68
    v_mfma_f32_16x16x32_bf16 v[172:175], a[188:191], v[56:59], v[172:175]
    v_exp_f32 v71, v71
    v_mfma_f32_16x16x32_bf16 v[172:175], a[124:127], v[52:55], v[172:175]
    v_add_f32 v89, v89, v71
    v_cvt_pk_bf16_f32 v63, v70, v71
    v_mfma_f32_16x16x32_bf16 v[80:83], a[80:83], a[64:67], 0
    v_exp_f32 v72, v72
    v_mfma_f32_16x16x32_bf16 v[80:83], a[84:87], a[68:71], v[80:83]
    ds_read_b128 a[80:83], v10 offset:0
    ds_read_b128 a[84:87], v10 offset:64
    v_add_f32 v89, v89, v72
    v_mfma_f32_16x16x32_bf16 v[80:83], a[88:91], a[72:75], v[80:83]
    v_exp_f32 v73, v73
    v_mfma_f32_16x16x32_bf16 v[80:83], a[92:95], a[76:79], v[80:83]
    ds_read_b128 a[88:91], v10 offset:128
    ds_read_b128 a[92:95], v10 offset:192
    v_cvt_pk_bf16_f32 v16, v72, v73
    v_mfma_f32_16x16x32_bf16 v[84:87], a[108:111], a[76:79], 0
    v_exp_f32 v74, v74
    v_add_f32 v89, v89, v73
    v_mfma_f32_16x16x32_bf16 v[84:87], a[104:107], a[72:75], v[84:87]
    ds_read_b128 a[108:111], v10 offset:448
    ds_read_b128 a[104:107], v10 offset:384
    v_add_f32 v89, v89, v74
    v_mfma_f32_16x16x32_bf16 v[84:87], a[100:103], a[68:71], v[84:87]
    s_xor_b32 s45, s52, 229376
    v_exp_f32 v75, v75
    v_mfma_f32_16x16x32_bf16 v[84:87], a[96:99], a[64:67], v[84:87]
    s_add_u32 m0, s60, 67584
    ds_read_b128 a[100:103], v10 offset:320
    ds_read_b128 a[96:99], v10 offset:256
    v_add_f32 v89, v89, v75
    v_mfma_f32_16x16x32_bf16 v[176:179], a[128:131], v[52:55], v[176:179]
    s_waitcnt vmcnt(14)
    ds_read_b64_tr_b16 a[228:229], v1 offset:33824
    v_exp_f32 v76, v76
    v_mfma_f32_16x16x32_bf16 v[176:179], a[192:195], v[56:59], v[176:179]
    buffer_load_dwordx4 v90, s[80:83], s45 offen offset:0 lds
    v_mfma_f32_16x16x32_bf16 v[180:183], a[196:199], v[56:59], v[180:183]
    ds_read_b64_tr_b16 a[230:231], v1 offset:34336
    v_exp_f32 v77, v77
    v_mfma_f32_16x16x32_bf16 v[180:183], a[132:135], v[52:55], v[180:183]
    ds_read_b64_tr_b16 a[232:233], v1 offset:33856
    v_cvt_pk_bf16_f32 v18, v76, v77
    v_cvt_pk_bf16_f32 v17, v74, v75
    v_mfma_f32_16x16x32_bf16 v[184:187], a[136:139], v[52:55], v[184:187]
    s_add_u32 m0, s60, 67616
    ds_read_b64_tr_b16 a[234:235], v1 offset:34368
    v_exp_f32 v78, v78
    v_mfma_f32_16x16x32_bf16 v[184:187], a[200:203], v[56:59], v[184:187]
    buffer_load_dwordx4 v90, s[80:83], s45 offen offset:1024 lds
    v_mfma_f32_16x16x32_bf16 v[188:191], a[204:207], v[56:59], v[188:191]
    ds_read_b64_tr_b16 a[236:237], v1 offset:33888
    v_exp_f32 v79, v79
    v_mfma_f32_16x16x32_bf16 v[188:191], a[140:143], v[52:55], v[188:191]
    s_waitcnt lgkmcnt(4)
    ds_read_b64_tr_b16 a[238:239], v1 offset:34400
    v_cvt_pk_bf16_f32 v19, v78, v79
    v_add_f32 v89, v89, v79
    v_mfma_f32_16x16x32_bf16 v[64:67], a[80:83], a[0:3], 0
    s_add_u32 m0, s60, 67648
    v_exp_f32 v80, v80
    v_mfma_f32_16x16x32_bf16 v[64:67], a[84:87], a[4:7], v[64:67]
    buffer_load_dwordx4 v90, s[80:83], s45 offen offset:2048 lds
    v_mfma_f32_16x16x32_bf16 v[64:67], a[88:91], a[8:11], v[64:67]
    v_exp_f32 v81, v81
    v_mfma_f32_16x16x32_bf16 v[64:67], a[92:95], a[12:15], v[64:67]
    v_cvt_pk_bf16_f32 v56, v80, v81
    v_add_f32 v89, v89, v78
    v_mfma_f32_16x16x32_bf16 v[68:71], a[108:111], a[12:15], 0
    s_add_u32 m0, s60, 67680
    v_exp_f32 v82, v82
    v_mfma_f32_16x16x32_bf16 v[68:71], a[104:107], a[8:11], v[68:71]
    buffer_load_dwordx4 v90, s[80:83], s45 offen offset:3072 lds
    v_mfma_f32_16x16x32_bf16 v[68:71], a[100:103], a[4:7], v[68:71]
    v_exp_f32 v83, v83
    v_mfma_f32_16x16x32_bf16 v[68:71], a[96:99], a[0:3], v[68:71]
    v_cvt_pk_bf16_f32 v57, v82, v83
    v_add_f32 v89, v89, v77
    v_mfma_f32_16x16x32_bf16 v[192:195], a[112:115], v[60:63], v[192:195]
    v_exp_f32 v84, v84
    v_mfma_f32_16x16x32_bf16 v[192:195], a[176:179], v[16:19], v[192:195]
    ds_read_b64_tr_b16 a[224:225], v1 offset:33792
    v_add_f32 v89, v89, v76
    v_mfma_f32_16x16x32_bf16 v[196:199], a[180:183], v[16:19], v[196:199]
    v_exp_f32 v85, v85
    v_mfma_f32_16x16x32_bf16 v[196:199], a[116:119], v[60:63], v[196:199]
    buffer_load_dword v92, v91, s[80:83], 0 offen
    v_mfma_f32_16x16x32_bf16 v[200:203], a[120:123], v[60:63], v[200:203]
    v_exp_f32 v86, v86
    v_mfma_f32_16x16x32_bf16 v[200:203], a[184:187], v[16:19], v[200:203]
    v_subrev_u32 v91, 98304, v91
    v_cvt_pk_bf16_f32 v58, v84, v85
    v_mfma_f32_16x16x32_bf16 v[204:207], a[188:191], v[16:19], v[204:207]
    v_exp_f32 v87, v87
    v_mfma_f32_16x16x32_bf16 v[204:207], a[124:127], v[60:63], v[204:207]
    ds_read_b64_tr_b16 a[226:227], v1 offset:34304
    v_cvt_pk_bf16_f32 v59, v86, v87
    v_mfma_f32_16x16x32_bf16 v[72:75], a[144:147], a[0:3], 0
    ds_read_b64_tr_b16 a[188:189], v13 offset:96
    v_exp_f32 v64, v64
    v_mfma_f32_16x16x32_bf16 v[72:75], a[148:151], a[4:7], v[72:75]
    ds_read_b64_tr_b16 a[176:177], v13 offset:0
    ds_read_b64_tr_b16 a[178:179], v13 offset:256
    ds_read_b64_tr_b16 a[190:191], v13 offset:352
    v_mfma_f32_16x16x32_bf16 v[72:75], a[152:155], a[8:11], v[72:75]
    v_exp_f32 v65, v65
    v_mfma_f32_16x16x32_bf16 v[72:75], a[156:159], a[12:15], v[72:75]
    s_xor_b32 s45, s52, 262144
    ds_read_b64_tr_b16 a[180:181], v13 offset:32
    v_cvt_pk_bf16_f32 v52, v64, v65
    v_mfma_f32_16x16x32_bf16 v[76:79], a[172:175], a[12:15], 0
    s_add_u32 m0, s60, 135168
    v_exp_f32 v66, v66
    v_mfma_f32_16x16x32_bf16 v[76:79], a[168:171], a[8:11], v[76:79]
    buffer_load_dwordx4 v90, s[80:83], s45 offen offset:0 lds
    v_mfma_f32_16x16x32_bf16 v[76:79], a[164:167], a[4:7], v[76:79]
    v_exp_f32 v67, v67
    v_mfma_f32_16x16x32_bf16 v[76:79], a[160:163], a[0:3], v[76:79]
    ds_read_b64_tr_b16 a[182:183], v13 offset:288
    v_cvt_pk_bf16_f32 v53, v66, v67
    v_mfma_f32_16x16x32_bf16 v[224:227], a[112:115], v[56:59], v[224:227]
    v_exp_f32 v68, v68
    v_mfma_f32_16x16x32_bf16 v[228:231], a[116:119], v[56:59], v[228:231]
    ds_read_b64_tr_b16 a[112:113], v12 offset:0
    ds_read_b64_tr_b16 a[114:115], v12 offset:256
    v_mfma_f32_16x16x32_bf16 v[232:235], a[120:123], v[56:59], v[232:235]
    s_add_u32 m0, s60, 135200
    v_exp_f32 v69, v69
    v_mfma_f32_16x16x32_bf16 v[236:239], a[124:127], v[56:59], v[236:239]
    buffer_load_dwordx4 v90, s[80:83], s45 offen offset:1024 lds
    v_mfma_f32_16x16x32_bf16 v[240:243], a[128:131], v[56:59], v[240:243]
    v_exp_f32 v70, v70
    v_mfma_f32_16x16x32_bf16 v[244:247], a[132:135], v[56:59], v[244:247]
    ds_read_b64_tr_b16 a[116:117], v12 offset:32
    v_cvt_pk_bf16_f32 v54, v68, v69
    v_mfma_f32_16x16x32_bf16 v[248:251], a[136:139], v[56:59], v[248:251]
    v_exp_f32 v71, v71
    v_mfma_f32_16x16x32_bf16 v[252:255], a[140:143], v[56:59], v[252:255]
    ds_read_b64_tr_b16 a[118:119], v12 offset:288
    v_cvt_pk_bf16_f32 v55, v70, v71
    v_mfma_f32_16x16x32_bf16 a[244:247], a[248:251], v[56:59], a[244:247]
    ds_read_b64_tr_b16 a[120:121], v12 offset:64
    ds_read_b64_tr_b16 a[122:123], v12 offset:320
    v_mfma_f32_16x16x32_bf16 v[80:83], a[80:83], a[64:67], 0
    v_exp_f32 v72, v72
    v_mfma_f32_16x16x32_bf16 v[80:83], a[84:87], a[68:71], v[80:83]
    ds_read_b64_tr_b16 a[124:125], v12 offset:96
    ds_read_b64_tr_b16 a[126:127], v12 offset:352
    v_mfma_f32_16x16x32_bf16 v[80:83], a[88:91], a[72:75], v[80:83]
    v_exp_f32 v73, v73
    v_mfma_f32_16x16x32_bf16 v[80:83], a[92:95], a[76:79], v[80:83]
    ds_read_b64_tr_b16 a[184:185], v13 offset:64
    v_cvt_pk_bf16_f32 v56, v72, v73
    v_mfma_f32_16x16x32_bf16 v[84:87], a[108:111], a[76:79], 0
    s_add_u32 m0, s60, 135232
    v_exp_f32 v74, v74
    v_mfma_f32_16x16x32_bf16 v[84:87], a[104:107], a[72:75], v[84:87]
    buffer_load_dwordx4 v90, s[80:83], s45 offen offset:2048 lds
    v_mfma_f32_16x16x32_bf16 v[84:87], a[100:103], a[68:71], v[84:87]
    v_exp_f32 v75, v75
    v_mfma_f32_16x16x32_bf16 v[84:87], a[96:99], a[64:67], v[84:87]
    ds_read_b64_tr_b16 a[186:187], v13 offset:320
    v_cvt_pk_bf16_f32 v57, v74, v75
    v_mfma_f32_16x16x32_bf16 v[208:211], a[128:131], v[60:63], v[208:211]
    v_exp_f32 v76, v76
    v_mfma_f32_16x16x32_bf16 v[208:211], a[192:195], v[16:19], v[208:211]
    ds_read_b64_tr_b16 a[128:129], v12 offset:128
    ds_read_b64_tr_b16 a[130:131], v12 offset:384
    v_mfma_f32_16x16x32_bf16 v[212:215], a[196:199], v[16:19], v[212:215]
    s_add_u32 m0, s60, 135264
    v_exp_f32 v77, v77
    v_mfma_f32_16x16x32_bf16 v[212:215], a[132:135], v[60:63], v[212:215]
    buffer_load_dwordx4 v90, s[80:83], s45 offen offset:3072 lds
    v_mfma_f32_16x16x32_bf16 v[216:219], a[136:139], v[60:63], v[216:219]
    v_exp_f32 v78, v78
    v_mfma_f32_16x16x32_bf16 v[216:219], a[200:203], v[16:19], v[216:219]
    ds_read_b64_tr_b16 a[192:193], v13 offset:128
    v_cvt_pk_bf16_f32 v58, v76, v77
    v_mfma_f32_16x16x32_bf16 v[220:223], a[204:207], v[16:19], v[220:223]
    v_exp_f32 v79, v79
    v_mfma_f32_16x16x32_bf16 v[220:223], a[140:143], v[60:63], v[220:223]
    ds_read_b64_tr_b16 a[194:195], v13 offset:384
    v_cvt_pk_bf16_f32 v59, v78, v79
    v_mfma_f32_16x16x32_bf16 v[64:67], a[80:83], a[16:19], 0
    v_exp_f32 v80, v80
    v_mfma_f32_16x16x32_bf16 v[64:67], a[84:87], a[20:23], v[64:67]
    ds_read_b64_tr_b16 a[196:197], v13 offset:160
    ds_read_b64_tr_b16 a[198:199], v13 offset:416
    v_mfma_f32_16x16x32_bf16 v[64:67], a[88:91], a[24:27], v[64:67]
    v_exp_f32 v81, v81
    v_mfma_f32_16x16x32_bf16 v[64:67], a[92:95], a[28:31], v[64:67]
    s_xor_b32 s45, s52, 294912
    ds_read_b64_tr_b16 a[132:133], v12 offset:160
    ds_read_b64_tr_b16 a[134:135], v12 offset:416
    v_mfma_f32_16x16x32_bf16 v[68:71], a[108:111], a[28:31], 0
    s_add_u32 m0, s60, 33792
    v_exp_f32 v82, v82
    v_mfma_f32_16x16x32_bf16 v[68:71], a[104:107], a[24:27], v[68:71]
    s_waitcnt lgkmcnt(4)
    buffer_load_dwordx4 v90, s[80:83], s45 offen offset:0 lds
    v_mfma_f32_16x16x32_bf16 v[68:71], a[100:103], a[20:23], v[68:71]
    v_exp_f32 v83, v83
    v_mfma_f32_16x16x32_bf16 v[68:71], a[96:99], a[16:19], v[68:71]
    ds_read_b64_tr_b16 a[136:137], v12 offset:192
    ds_read_b64_tr_b16 a[138:139], v12 offset:448
    v_mfma_f32_16x16x32_bf16 v[96:99], a[112:115], v[52:55], v[96:99]
    v_exp_f32 v84, v84
    v_mfma_f32_16x16x32_bf16 v[96:99], a[176:179], v[56:59], v[96:99]
    ds_read_b64_tr_b16 a[200:201], v13 offset:192
    ds_read_b64_tr_b16 a[202:203], v13 offset:448
    v_mfma_f32_16x16x32_bf16 v[100:103], a[180:183], v[56:59], v[100:103]
    s_add_u32 m0, s60, 33824
    v_exp_f32 v85, v85
    v_mfma_f32_16x16x32_bf16 v[100:103], a[116:119], v[52:55], v[100:103]
    buffer_load_dwordx4 v90, s[80:83], s45 offen offset:1024 lds
    v_mfma_f32_16x16x32_bf16 v[104:107], a[120:123], v[52:55], v[104:107]
    v_exp_f32 v86, v86
    v_mfma_f32_16x16x32_bf16 v[104:107], a[184:187], v[56:59], v[104:107]
    ds_read_b64_tr_b16 a[204:205], v13 offset:224
    v_cvt_pk_bf16_f32 v62, v84, v85
    v_mfma_f32_16x16x32_bf16 v[108:111], a[188:191], v[56:59], v[108:111]
    v_exp_f32 v87, v87
    v_mfma_f32_16x16x32_bf16 v[108:111], a[124:127], v[52:55], v[108:111]
    ds_read_b64_tr_b16 a[206:207], v13 offset:480
    v_cvt_pk_bf16_f32 v63, v86, v87
    v_mfma_f32_16x16x32_bf16 a[240:243], a[248:251], v[52:55], a[240:243]
    ds_read_b64_tr_b16 a[140:141], v12 offset:224
    ds_read_b64_tr_b16 a[142:143], v12 offset:480
    v_mfma_f32_16x16x32_bf16 a[240:243], a[248:251], v[56:59], a[240:243]
    v_cvt_pk_bf16_f32 v61, v82, v83
    v_cvt_pk_bf16_f32 v60, v80, v81
    v_mfma_f32_16x16x32_bf16 v[72:75], a[144:147], a[16:19], 0
    v_exp_f32 v64, v64
    v_mfma_f32_16x16x32_bf16 v[72:75], a[148:151], a[20:23], v[72:75]
    v_add_f32 v14, v14, v64
    v_mfma_f32_16x16x32_bf16 v[72:75], a[152:155], a[24:27], v[72:75]
    v_exp_f32 v65, v65
    v_mfma_f32_16x16x32_bf16 v[72:75], a[156:159], a[28:31], v[72:75]
    v_add_f32 v14, v14, v65
    v_cvt_pk_bf16_f32 v16, v64, v65
    v_mfma_f32_16x16x32_bf16 v[76:79], a[172:175], a[28:31], 0
    s_add_u32 m0, s60, 33856
    v_exp_f32 v66, v66
    v_accvgpr_read_b32 v88, a240
    v_rcp_f32 v94, v88
    v_mfma_f32_16x16x32_bf16 v[76:79], a[168:171], a[24:27], v[76:79]
    buffer_load_dwordx4 v90, s[80:83], s45 offen offset:2048 lds
    v_mul_f32 v96, v94, v96
    v_mul_f32 v97, v94, v97
    v_mul_f32 v98, v94, v98
    v_mfma_f32_16x16x32_bf16 v[76:79], a[164:167], a[20:23], v[76:79]
    v_exp_f32 v67, v67
    v_mul_f32 v99, v94, v99
    v_mul_f32 v100, v94, v100
    v_mul_f32 v101, v94, v101
    v_mfma_f32_16x16x32_bf16 v[76:79], a[160:163], a[16:19], v[76:79]
    v_add_f32 v14, v14, v67
    v_cvt_pk_bf16_f32 v17, v66, v67
    v_mul_f32 v102, v94, v102
    v_mul_f32 v103, v94, v103
    v_cvt_pk_bf16_f32 v96, v96, v97
    v_mfma_f32_16x16x32_bf16 v[112:115], a[128:131], v[52:55], v[112:115]
    v_exp_f32 v68, v68
    v_cvt_pk_bf16_f32 v97, v98, v99
    v_cvt_pk_bf16_f32 v98, v100, v101
    v_cvt_pk_bf16_f32 v99, v102, v103
    v_mfma_f32_16x16x32_bf16 v[112:115], a[192:195], v[56:59], v[112:115]
    s_waitcnt lgkmcnt(0)
    buffer_store_dwordx4 v[96:99], v2, s[36:39], s84 offen offset:0 sc1
    v_add_f32 v14, v14, v68
    v_add_f32 v14, v14, v66
    v_mul_f32 v104, v94, v104
    v_mfma_f32_16x16x32_bf16 v[116:119], a[196:199], v[56:59], v[116:119]
    s_add_u32 m0, s60, 33888
    v_exp_f32 v69, v69
    v_mul_f32 v105, v94, v105
    v_mul_f32 v106, v94, v106
    v_mul_f32 v107, v94, v107
    v_mfma_f32_16x16x32_bf16 v[116:119], a[132:135], v[52:55], v[116:119]
    buffer_load_dwordx4 v90, s[80:83], s45 offen offset:3072 lds
    v_mul_f32 v108, v94, v108
    v_mul_f32 v109, v94, v109
    v_mul_f32 v110, v94, v110
    v_mfma_f32_16x16x32_bf16 v[120:123], a[136:139], v[52:55], v[120:123]
    v_exp_f32 v70, v70
    v_mul_f32 v111, v94, v111
    v_cvt_pk_bf16_f32 v104, v104, v105
    v_cvt_pk_bf16_f32 v105, v106, v107
    v_mfma_f32_16x16x32_bf16 v[120:123], a[200:203], v[56:59], v[120:123]
    v_add_f32 v14, v14, v70
    v_add_f32 v14, v14, v69
    v_cvt_pk_bf16_f32 v106, v108, v109
    v_cvt_pk_bf16_f32 v107, v110, v111
    v_mfma_f32_16x16x32_bf16 v[124:127], a[204:207], v[56:59], v[124:127]
    buffer_store_dwordx4 v[104:107], v2, s[36:39], s84 offen offset:1024 sc1
    v_exp_f32 v71, v71
    v_mfma_f32_16x16x32_bf16 v[124:127], a[140:143], v[52:55], v[124:127]
    v_add_f32 v14, v14, v71
    v_cvt_pk_bf16_f32 v19, v70, v71
    v_mfma_f32_16x16x32_bf16 v[80:83], a[80:83], v[20:23], 0
    v_exp_f32 v72, v72
    v_mul_f32 v112, v94, v112
    v_mul_f32 v113, v94, v113
    v_mul_f32 v114, v94, v114
    v_mfma_f32_16x16x32_bf16 v[80:83], a[84:87], v[24:27], v[80:83]
    v_add_f32 v14, v14, v72
    v_cvt_pk_bf16_f32 v18, v68, v69
    v_mul_f32 v115, v94, v115
    v_mul_f32 v116, v94, v116
    v_mul_f32 v117, v94, v117
    v_mfma_f32_16x16x32_bf16 v[80:83], a[88:91], v[28:31], v[80:83]
    v_exp_f32 v73, v73
    v_mul_f32 v118, v94, v118
    v_mul_f32 v119, v94, v119
    v_cvt_pk_bf16_f32 v112, v112, v113
    v_mfma_f32_16x16x32_bf16 v[80:83], a[92:95], v[32:35], v[80:83]
    v_add_f32 v14, v14, v73
    v_cvt_pk_bf16_f32 v52, v72, v73
    v_cvt_pk_bf16_f32 v113, v114, v115
    v_cvt_pk_bf16_f32 v114, v116, v117
    v_cvt_pk_bf16_f32 v115, v118, v119
    v_mfma_f32_16x16x32_bf16 v[84:87], a[108:111], v[32:35], 0
    buffer_store_dwordx4 v[112:115], v2, s[36:39], s84 offen offset:2048 sc1
    v_exp_f32 v74, v74
    v_mul_f32 v120, v94, v120
    v_mfma_f32_16x16x32_bf16 v[84:87], a[104:107], v[28:31], v[84:87]
    v_add_f32 v14, v14, v74
    v_mul_f32 v121, v94, v121
    v_mul_f32 v122, v94, v122
    v_mul_f32 v123, v94, v123
    v_mul_f32 v124, v94, v124
    v_mfma_f32_16x16x32_bf16 v[84:87], a[100:103], v[24:27], v[84:87]
    v_exp_f32 v75, v75
    v_mul_f32 v125, v94, v125
    v_mul_f32 v126, v94, v126
    v_mul_f32 v127, v94, v127
    v_mfma_f32_16x16x32_bf16 v[84:87], a[96:99], v[20:23], v[84:87]
    v_add_f32 v14, v14, v75
    v_cvt_pk_bf16_f32 v53, v74, v75
    v_cvt_pk_bf16_f32 v120, v120, v121
    v_cvt_pk_bf16_f32 v121, v122, v123
    v_cvt_pk_bf16_f32 v122, v124, v125
    v_mfma_f32_16x16x32_bf16 v[224:227], a[112:115], v[60:63], v[224:227]
    v_exp_f32 v76, v76
    v_cvt_pk_bf16_f32 v123, v126, v127
    v_mfma_f32_16x16x32_bf16 v[228:231], a[116:119], v[60:63], v[228:231]
    buffer_store_dwordx4 v[120:123], v2, s[36:39], s84 offen offset:3072 sc1
    v_add_f32 v14, v14, v76
    v_mfma_f32_16x16x32_bf16 v[232:235], a[120:123], v[60:63], v[232:235]
    v_exp_f32 v77, v77
    v_mfma_f32_16x16x32_bf16 v[236:239], a[124:127], v[60:63], v[236:239]
    v_add_f32 v14, v14, v77
    v_cvt_pk_bf16_f32 v54, v76, v77
    v_mfma_f32_16x16x32_bf16 v[240:243], a[128:131], v[60:63], v[240:243]
    v_exp_f32 v78, v78
    v_mfma_f32_16x16x32_bf16 v[244:247], a[132:135], v[60:63], v[244:247]
    v_add_f32 v14, v14, v78
    v_mfma_f32_16x16x32_bf16 v[248:251], a[136:139], v[60:63], v[248:251]
    v_exp_f32 v79, v79
    v_mfma_f32_16x16x32_bf16 v[252:255], a[140:143], v[60:63], v[252:255]
    v_add_f32 v14, v14, v79
    v_cvt_pk_bf16_f32 v55, v78, v79
    v_mfma_f32_16x16x32_bf16 a[244:247], a[248:251], v[60:63], a[244:247]
    v_mfma_f32_16x16x32_bf16 v[64:67], a[144:147], v[20:23], 0
    v_exp_f32 v80, v80
    v_mfma_f32_16x16x32_bf16 v[64:67], a[148:151], v[24:27], v[64:67]
    v_add_f32 v15, v15, v80
    v_mfma_f32_16x16x32_bf16 v[64:67], a[152:155], v[28:31], v[64:67]
    v_exp_f32 v81, v81
    v_mfma_f32_16x16x32_bf16 v[64:67], a[156:159], v[32:35], v[64:67]
    v_add_f32 v15, v15, v81
    v_cvt_pk_bf16_f32 v56, v80, v81
    v_mfma_f32_16x16x32_bf16 v[68:71], a[172:175], v[32:35], 0
    v_exp_f32 v82, v82
    v_mov_b32 v94, v14
    v_mfma_f32_16x16x32_bf16 v[68:71], a[168:171], v[28:31], v[68:71]
    v_add_f32 v15, v15, v82
    v_accvgpr_read_b32 v91, a244
    s_cmp_eq_u32 s41, 0
    s_cbranch_scc1 L_send_hi
    ds_write_b128 v3, v[224:227] offset:0
    ds_write_b128 v3, v[228:231] offset:1024
    ds_write_b128 v3, v[232:235] offset:2048
    ds_write_b128 v3, v[236:239] offset:3072
    v_mov_b32 v224, v240
    v_mov_b32 v225, v241
    v_mov_b32 v226, v242
    v_mov_b32 v227, v243
    v_mov_b32 v228, v244
    v_mov_b32 v229, v245
    v_mov_b32 v230, v246
    v_mov_b32 v231, v247
    v_mov_b32 v232, v248
    v_mov_b32 v233, v249
    v_mov_b32 v234, v250
    v_mov_b32 v235, v251
    v_mov_b32 v236, v252
    v_mov_b32 v237, v253
    v_mov_b32 v238, v254
    v_mov_b32 v239, v255
    s_branch L_sent
L_send_hi:
    ds_write_b128 v3, v[240:243] offset:0
    ds_write_b128 v3, v[244:247] offset:1024
    ds_write_b128 v3, v[248:251] offset:2048
    ds_write_b128 v3, v[252:255] offset:3072
L_sent:
    v_mfma_f32_16x16x32_bf16 v[68:71], a[164:167], v[24:27], v[68:71]
    ds_write_b32 v6, v91
    v_exp_f32 v83, v83
    v_permlane32_swap_b32 v94, v14
    v_add_f32 v14, v14, v94
    v_mfma_f32_16x16x32_bf16 v[68:71], a[160:163], v[20:23], v[68:71]
    v_add_f32 v15, v15, v83
    v_cvt_pk_bf16_f32 v57, v82, v83
    v_mov_b32 v94, v14
    v_mfma_f32_16x16x32_bf16 v[128:131], a[112:115], v[16:19], v[128:131]
    v_exp_f32 v84, v84
    v_mfma_f32_16x16x32_bf16 v[128:131], a[176:179], v[52:55], v[128:131]
    v_add_f32 v15, v15, v84
    v_permlane16_swap_b32 v94, v14
    v_add_f32 v14, v14, v94
    v_rcp_f32 v94, v14
    v_mfma_f32_16x16x32_bf16 v[132:135], a[180:183], v[52:55], v[132:135]
    v_exp_f32 v85, v85
    v_mfma_f32_16x16x32_bf16 v[132:135], a[116:119], v[16:19], v[132:135]
    v_add_f32 v15, v15, v85
    v_cvt_pk_bf16_f32 v58, v84, v85
    v_mfma_f32_16x16x32_bf16 v[136:139], a[120:123], v[16:19], v[136:139]
    v_exp_f32 v86, v86
    v_mfma_f32_16x16x32_bf16 v[136:139], a[184:187], v[52:55], v[136:139]
    v_add_f32 v15, v15, v86
    v_mfma_f32_16x16x32_bf16 v[140:143], a[188:191], v[52:55], v[140:143]
    v_exp_f32 v87, v87
    v_mfma_f32_16x16x32_bf16 v[140:143], a[124:127], v[16:19], v[140:143]
    v_add_f32 v15, v15, v87
    v_cvt_pk_bf16_f32 v59, v86, v87
    s_waitcnt lgkmcnt(0)
    s_barrier
    v_mfma_f32_16x16x32_bf16 v[72:75], a[80:83], v[36:39], 0
    ds_read_b32 v95, v7
    v_exp_f32 v64, v64
    v_mul_f32 v128, v94, v128
    v_mul_f32 v129, v94, v129
    v_mfma_f32_16x16x32_bf16 v[72:75], a[84:87], v[40:43], v[72:75]
    s_xor_b32 s45, s52, 327680
    v_add_f32 v15, v15, v64
    v_mul_f32 v130, v94, v130
    v_mul_f32 v131, v94, v131
    v_mul_f32 v132, v94, v132
    v_mul_f32 v133, v94, v133
    v_mfma_f32_16x16x32_bf16 v[72:75], a[88:91], v[44:47], v[72:75]
    s_add_u32 m0, s60, 0
    ds_read_b128 v[240:243], v4 offset:0
    v_exp_f32 v65, v65
    v_mul_f32 v134, v94, v134
    v_mul_f32 v135, v94, v135
    v_mfma_f32_16x16x32_bf16 v[72:75], a[92:95], v[48:51], v[72:75]
    buffer_load_dwordx4 v90, s[80:83], s45 offen offset:0 lds
    v_cvt_pk_bf16_f32 v128, v128, v129
    v_cvt_pk_bf16_f32 v129, v130, v131
    v_cvt_pk_bf16_f32 v130, v132, v133
    v_mfma_f32_16x16x32_bf16 v[76:79], a[108:111], v[48:51], 0
    ds_read_b128 v[244:247], v4 offset:1024
    v_exp_f32 v66, v66
    v_cvt_pk_bf16_f32 v131, v134, v135
    v_mfma_f32_16x16x32_bf16 v[76:79], a[104:107], v[44:47], v[76:79]
    buffer_store_dwordx4 v[128:131], v2, s[36:39], s85 offen offset:0 sc1
    v_add_f32 v15, v15, v66
    v_add_f32 v15, v15, v65
    v_mul_f32 v136, v94, v136
    v_mfma_f32_16x16x32_bf16 v[76:79], a[100:103], v[40:43], v[76:79]
    ds_read_b128 v[248:251], v4 offset:2048
    v_exp_f32 v67, v67
    v_mul_f32 v137, v94, v137
    v_mul_f32 v138, v94, v138
    v_mfma_f32_16x16x32_bf16 v[76:79], a[96:99], v[36:39], v[76:79]
    v_add_f32 v15, v15, v67
    v_cvt_pk_bf16_f32 v61, v66, v67
    v_mul_f32 v139, v94, v139
    v_mul_f32 v140, v94, v140
    v_mul_f32 v141, v94, v141
    s_branch L_pg10
    .p2align 12
L_stub10:
    s_branch L_warm_ret
L_pg10:
    v_mfma_f32_16x16x32_bf16 v[144:147], a[128:131], v[16:19], v[144:147]
    ds_read_b128 v[252:255], v4 offset:3072
    v_exp_f32 v68, v68
    v_mul_f32 v142, v94, v142
    v_mul_f32 v143, v94, v143
    v_mfma_f32_16x16x32_bf16 v[144:147], a[192:195], v[52:55], v[144:147]
    v_add_f32 v15, v15, v68
    v_cvt_pk_bf16_f32 v60, v64, v65
    v_cvt_pk_bf16_f32 v136, v136, v137
    v_cvt_pk_bf16_f32 v137, v138, v139
    v_cvt_pk_bf16_f32 v138, v140, v141
    v_mfma_f32_16x16x32_bf16 v[148:151], a[196:199], v[52:55], v[148:151]
    s_add_u32 m0, s60, 32
    v_exp_f32 v69, v69
    v_cvt_pk_bf16_f32 v139, v142, v143
    v_mfma_f32_16x16x32_bf16 v[148:151], a[132:135], v[16:19], v[148:151]
    buffer_load_dwordx4 v90, s[80:83], s45 offen offset:1024 lds
    v_mfma_f32_16x16x32_bf16 v[152:155], a[136:139], v[16:19], v[152:155]
    buffer_store_dwordx4 v[136:139], v2, s[36:39], s85 offen offset:1024 sc1
    v_exp_f32 v70, v70
    v_mfma_f32_16x16x32_bf16 v[152:155], a[200:203], v[52:55], v[152:155]
    v_add_f32 v15, v15, v70
    v_add_f32 v15, v15, v69
    v_mfma_f32_16x16x32_bf16 v[156:159], a[204:207], v[52:55], v[156:159]
    v_exp_f32 v71, v71
    v_mfma_f32_16x16x32_bf16 v[156:159], a[140:143], v[16:19], v[156:159]
    v_add_f32 v15, v15, v71
    v_cvt_pk_bf16_f32 v63, v70, v71
    v_mfma_f32_16x16x32_bf16 v[80:83], a[144:147], v[36:39], 0
    v_exp_f32 v72, v72
    v_mul_f32 v144, v94, v144
    v_mul_f32 v145, v94, v145
    v_mul_f32 v146, v94, v146
    v_mfma_f32_16x16x32_bf16 v[80:83], a[148:151], v[40:43], v[80:83]
    v_cvt_pk_bf16_f32 v62, v68, v69
    v_add_f32 v89, v89, v72
    v_mul_f32 v147, v94, v147
    v_mul_f32 v148, v94, v148
    v_mul_f32 v149, v94, v149
    v_mfma_f32_16x16x32_bf16 v[80:83], a[152:155], v[44:47], v[80:83]
    s_add_u32 m0, s60, 64
    v_exp_f32 v73, v73
    v_mul_f32 v150, v94, v150
    v_mul_f32 v151, v94, v151
    v_cvt_pk_bf16_f32 v144, v144, v145
    v_mfma_f32_16x16x32_bf16 v[80:83], a[156:159], v[48:51], v[80:83]
    buffer_load_dwordx4 v90, s[80:83], s45 offen offset:2048 lds
    v_cvt_pk_bf16_f32 v145, v146, v147
    v_cvt_pk_bf16_f32 v146, v148, v149
    v_cvt_pk_bf16_f32 v147, v150, v151
    v_mfma_f32_16x16x32_bf16 v[84:87], a[172:175], v[48:51], 0
    buffer_store_dwordx4 v[144:147], v2, s[36:39], s85 offen offset:2048 sc1
    v_exp_f32 v74, v74
    v_mul_f32 v152, v94, v152
    v_mfma_f32_16x16x32_bf16 v[84:87], a[168:171], v[44:47], v[84:87]
    v_add_f32 v89, v89, v74
    v_add_f32 v89, v89, v73
    v_mul_f32 v153, v94, v153
    v_mul_f32 v154, v94, v154
    v_mul_f32 v155, v94, v155
    v_mfma_f32_16x16x32_bf16 v[84:87], a[164:167], v[40:43], v[84:87]
    v_exp_f32 v75, v75
    v_mul_f32 v156, v94, v156
    v_mul_f32 v157, v94, v157
    v_mul_f32 v158, v94, v158
    v_mfma_f32_16x16x32_bf16 v[84:87], a[160:163], v[36:39], v[84:87]
    v_add_f32 v89, v89, v75
    v_cvt_pk_bf16_f32 v17, v74, v75
    v_mul_f32 v159, v94, v159
    v_cvt_pk_bf16_f32 v152, v152, v153
    v_cvt_pk_bf16_f32 v153, v154, v155
    v_mfma_f32_16x16x32_bf16 v[160:163], a[112:115], v[56:59], v[160:163]
    v_exp_f32 v76, v76
    v_cvt_pk_bf16_f32 v154, v156, v157
    v_cvt_pk_bf16_f32 v155, v158, v159
    v_mfma_f32_16x16x32_bf16 v[160:163], a[176:179], v[60:63], v[160:163]
    s_waitcnt lgkmcnt(0)
    buffer_store_dwordx4 v[152:155], v2, s[36:39], s85 offen offset:3072 sc1
    v_add_f32 v89, v89, v76
    v_cvt_pk_bf16_f32 v16, v72, v73
    v_add_f32 v95, v91, v95
    v_mfma_f32_16x16x32_bf16 v[164:167], a[180:183], v[60:63], v[164:167]
    s_add_u32 m0, s60, 96
    v_exp_f32 v77, v77
    v_rcp_f32 v95, v95
    v_mfma_f32_16x16x32_bf16 v[164:167], a[116:119], v[56:59], v[164:167]
    buffer_load_dwordx4 v90, s[80:83], s45 offen offset:3072 lds
    v_add_f32 v224, v224, v240
    v_add_f32 v225, v225, v241
    v_add_f32 v226, v226, v242
    v_mfma_f32_16x16x32_bf16 v[168:171], a[120:123], v[56:59], v[168:171]
    v_exp_f32 v78, v78
    v_cvt_pk_bf16_f32 v18, v76, v77
    v_add_f32 v227, v227, v243
    v_add_f32 v228, v228, v244
    v_mfma_f32_16x16x32_bf16 v[168:171], a[184:187], v[60:63], v[168:171]
    v_add_f32 v89, v89, v78
    v_add_f32 v89, v89, v77
    v_add_f32 v229, v229, v245
    v_add_f32 v230, v230, v246
    v_add_f32 v231, v231, v247
    v_mfma_f32_16x16x32_bf16 v[172:175], a[188:191], v[60:63], v[172:175]
    v_exp_f32 v79, v79
    v_add_f32 v232, v232, v248
    v_add_f32 v233, v233, v249
    v_add_f32 v234, v234, v250
    v_mfma_f32_16x16x32_bf16 v[172:175], a[124:127], v[56:59], v[172:175]
    s_xor_b32 s45, s52, 360448
    v_add_f32 v89, v89, v79
    v_cvt_pk_bf16_f32 v19, v78, v79
    v_add_f32 v235, v235, v251
    v_add_f32 v236, v236, v252
    v_add_f32 v237, v237, v253
    s_nop 0
    s_add_u32 m0, s60, 16896
    v_exp_f32 v80, v80
    v_add_f32 v238, v238, v254
    v_add_f32 v239, v239, v255
    v_mul_f32 v224, v95, v224
    s_nop 0
    buffer_load_dwordx4 v90, s[80:83], s45 offen offset:0 lds
    v_mul_f32 v225, v95, v225
    v_mul_f32 v226, v95, v226
    v_mul_f32 v227, v95, v227
    s_nop 0
    v_exp_f32 v81, v81
    v_add_f32 v89, v89, v80
    v_mul_f32 v228, v95, v228
    v_mul_f32 v229, v95, v229
    s_nop 0
    v_add_f32 v89, v89, v81
    v_cvt_pk_bf16_f32 v52, v80, v81
    v_mul_f32 v230, v95, v230
    v_mul_f32 v231, v95, v231
    v_cvt_pk_bf16_f32 v224, v224, v225
    s_nop 0
    s_add_u32 m0, s60, 16928
    v_exp_f32 v82, v82
    v_cvt_pk_bf16_f32 v225, v226, v227
    v_cvt_pk_bf16_f32 v226, v228, v229
    v_cvt_pk_bf16_f32 v227, v230, v231
    s_nop 0
    buffer_load_dwordx4 v90, s[80:83], s45 offen offset:1024 lds
    s_nop 0
    buffer_store_dwordx4 v[224:227], v2, s[36:39], s88 offen offset:0 sc1
    v_exp_f32 v83, v83
    v_add_f32 v89, v89, v82
    s_nop 0
    v_add_f32 v89, v89, v83
    v_cvt_pk_bf16_f32 v53, v82, v83
    v_mul_f32 v232, v95, v232
    v_mul_f32 v233, v95, v233
    v_mul_f32 v234, v95, v234
    v_mfma_f32_16x16x32_bf16 v[176:179], a[128:131], v[56:59], v[176:179]
    s_add_u32 m0, s60, 16960
    v_exp_f32 v84, v84
    v_mul_f32 v235, v95, v235
    v_mul_f32 v236, v95, v236
    v_mul_f32 v237, v95, v237
    v_mfma_f32_16x16x32_bf16 v[176:179], a[192:195], v[60:63], v[176:179]
    buffer_load_dwordx4 v90, s[80:83], s45 offen offset:2048 lds
    v_mul_f32 v238, v95, v238
    v_mul_f32 v239, v95, v239
    v_cvt_pk_bf16_f32 v232, v232, v233
    v_mfma_f32_16x16x32_bf16 v[180:183], a[196:199], v[60:63], v[180:183]
    v_exp_f32 v85, v85
    v_add_f32 v89, v89, v84
    v_cvt_pk_bf16_f32 v233, v234, v235
    v_cvt_pk_bf16_f32 v234, v236, v237
    v_mfma_f32_16x16x32_bf16 v[180:183], a[132:135], v[56:59], v[180:183]
    s_add_u32 m0, s60, 16992
    v_add_f32 v89, v89, v85
    v_cvt_pk_bf16_f32 v54, v84, v85
    v_cvt_pk_bf16_f32 v235, v238, v239
    v_mfma_f32_16x16x32_bf16 v[184:187], a[136:139], v[56:59], v[184:187]
    buffer_store_dwordx4 v[232:235], v2, s[36:39], s88 offen offset:1024 sc1
    v_exp_f32 v86, v86
    v_mov_b32 v94, v15
    v_mfma_f32_16x16x32_bf16 v[184:187], a[200:203], v[60:63], v[184:187]
    buffer_load_dwordx4 v90, s[80:83], s45 offen offset:3072 lds
    v_mfma_f32_16x16x32_bf16 v[188:191], a[204:207], v[60:63], v[188:191]
    v_exp_f32 v87, v87
    v_add_f32 v89, v89, v86
    v_permlane32_swap_b32 v94, v15
    v_add_f32 v15, v15, v94
    v_mfma_f32_16x16x32_bf16 v[188:191], a[140:143], v[56:59], v[188:191]
    v_add_f32 v89, v89, v87
    v_cvt_pk_bf16_f32 v55, v86, v87
    v_mov_b32 v94, v15
    s_nop 1
    v_mfma_f32_16x16x32_bf16 v[192:195], a[112:115], v[16:19], v[192:195]
    s_waitcnt vmcnt(41)
    ds_read_b64_tr_b16 a[0:1], v1 offset:50688
    v_mfma_f32_16x16x32_bf16 v[192:195], a[176:179], v[52:55], v[192:195]
    ds_read_b64_tr_b16 a[2:3], v1 offset:51200
    v_permlane16_swap_b32 v94, v15
    v_add_f32 v15, v15, v94
    v_rcp_f32 v94, v15
    v_mfma_f32_16x16x32_bf16 v[196:199], a[180:183], v[52:55], v[196:199]
    ds_read_b64_tr_b16 a[4:5], v1 offset:50720
    v_mul_f32 v160, v94, v160
    v_mul_f32 v161, v94, v161
    v_mul_f32 v162, v94, v162
    v_mul_f32 v163, v94, v163
    v_mfma_f32_16x16x32_bf16 v[196:199], a[116:119], v[16:19], v[196:199]
    ds_read_b64_tr_b16 a[6:7], v1 offset:51232
    v_mul_f32 v164, v94, v164
    v_mul_f32 v165, v94, v165
    v_mul_f32 v166, v94, v166
    v_mul_f32 v167, v94, v167
    v_mfma_f32_16x16x32_bf16 v[200:203], a[120:123], v[16:19], v[200:203]
    ds_read_b64_tr_b16 a[8:9], v1 offset:50752
    v_cvt_pk_bf16_f32 v160, v160, v161
    v_cvt_pk_bf16_f32 v161, v162, v163
    v_cvt_pk_bf16_f32 v162, v164, v165
    v_cvt_pk_bf16_f32 v163, v166, v167
    v_mfma_f32_16x16x32_bf16 v[200:203], a[184:187], v[52:55], v[200:203]
    ds_read_b64_tr_b16 a[10:11], v1 offset:51264
    buffer_store_dwordx4 v[160:163], v2, s[36:39], s86 offen offset:0 sc1
    v_mul_f32 v168, v94, v168
    v_mul_f32 v169, v94, v169
    v_mfma_f32_16x16x32_bf16 v[204:207], a[188:191], v[52:55], v[204:207]
    ds_read_b64_tr_b16 a[12:13], v1 offset:50784
    v_mul_f32 v170, v94, v170
    v_mul_f32 v171, v94, v171
    v_mul_f32 v172, v94, v172
    v_mul_f32 v173, v94, v173
    v_mfma_f32_16x16x32_bf16 v[204:207], a[124:127], v[16:19], v[204:207]
    ds_read_b64_tr_b16 a[14:15], v1 offset:51296
    v_mul_f32 v174, v94, v174
    v_mul_f32 v175, v94, v175
    v_cvt_pk_bf16_f32 v168, v168, v169
    v_cvt_pk_bf16_f32 v169, v170, v171
    v_mfma_f32_16x16x32_bf16 v[208:211], a[128:131], v[16:19], v[208:211]
    s_waitcnt vmcnt(36)
    ds_read_b64_tr_b16 a[64:65], v5 offset:33792
    v_cvt_pk_bf16_f32 v170, v172, v173
    v_cvt_pk_bf16_f32 v171, v174, v175
    v_mfma_f32_16x16x32_bf16 v[208:211], a[192:195], v[52:55], v[208:211]
    ds_read_b64_tr_b16 a[66:67], v5 offset:34304
    buffer_store_dwordx4 v[168:171], v2, s[36:39], s86 offen offset:1024 sc1
    v_mul_f32 v176, v94, v176
    v_mul_f32 v177, v94, v177
    v_mfma_f32_16x16x32_bf16 v[212:215], a[196:199], v[52:55], v[212:215]
    ds_read_b64_tr_b16 a[68:69], v5 offset:33824
    v_mul_f32 v178, v94, v178
    v_mul_f32 v179, v94, v179
    v_mul_f32 v180, v94, v180
    v_mul_f32 v181, v94, v181
    v_mfma_f32_16x16x32_bf16 v[212:215], a[132:135], v[16:19], v[212:215]
    ds_read_b64_tr_b16 a[70:71], v5 offset:34336
    v_mul_f32 v182, v94, v182
    v_mul_f32 v183, v94, v183
    v_cvt_pk_bf16_f32 v176, v176, v177
    v_cvt_pk_bf16_f32 v177, v178, v179
    v_mfma_f32_16x16x32_bf16 v[216:219], a[136:139], v[16:19], v[216:219]
    ds_read_b64_tr_b16 a[72:73], v5 offset:33856
    v_cvt_pk_bf16_f32 v178, v180, v181
    v_cvt_pk_bf16_f32 v179, v182, v183
    v_mfma_f32_16x16x32_bf16 v[216:219], a[200:203], v[52:55], v[216:219]
    ds_read_b64_tr_b16 a[74:75], v5 offset:34368
    buffer_store_dwordx4 v[176:179], v2, s[36:39], s86 offen offset:2048 sc1
    v_mul_f32 v184, v94, v184
    v_mul_f32 v185, v94, v185
    v_mfma_f32_16x16x32_bf16 v[220:223], a[204:207], v[52:55], v[220:223]
    ds_read_b64_tr_b16 a[76:77], v5 offset:33888
    v_mul_f32 v186, v94, v186
    v_mul_f32 v187, v94, v187
    v_mul_f32 v188, v94, v188
    v_mul_f32 v189, v94, v189
    v_mfma_f32_16x16x32_bf16 v[220:223], a[140:143], v[16:19], v[220:223]
    ds_read_b64_tr_b16 a[78:79], v5 offset:34400
    v_mul_f32 v190, v94, v190
    v_mul_f32 v191, v94, v191
    v_cvt_pk_bf16_f32 v184, v184, v185
    v_cvt_pk_bf16_f32 v185, v186, v187
    s_nop 1
    v_cvt_pk_bf16_f32 v186, v188, v189
    v_cvt_pk_bf16_f32 v187, v190, v191
    buffer_store_dwordx4 v[184:187], v2, s[36:39], s86 offen offset:3072 sc1
    v_mov_b32 v94, v89
    s_nop 1
    v_permlane32_swap_b32 v94, v89
    v_add_f32 v89, v89, v94
    v_mov_b32 v94, v89
    s_nop 1
    v_permlane16_swap_b32 v94, v89
    v_add_f32 v89, v89, v94
L_tail:
    v_mov_b32 v6, v90
    v_mov_b32 v4, v93
    s_xor_b32 s45, s52, 393216
    v_rcp_f32 v36, v89
    v_add_f32 v41, v88, v14
    s_nop 3
    v_mul_f32 v192, v36, v192
    v_mul_f32 v193, v36, v193
    v_mul_f32 v194, v36, v194
    v_mul_f32 v195, v36, v195
    v_mul_f32 v196, v36, v196
    v_mul_f32 v197, v36, v197
    v_mul_f32 v198, v36, v198
    v_mul_f32 v199, v36, v199
    v_cvt_pk_bf16_f32 v192, v192, v193
    v_cvt_pk_bf16_f32 v193, v194, v195
    v_cvt_pk_bf16_f32 v194, v196, v197
    v_cvt_pk_bf16_f32 v195, v198, v199
    buffer_store_dwordx4 v[192:195], v2, s[36:39], s87 offen offset:0 sc1
    v_mul_f32 v200, v36, v200
    v_mul_f32 v201, v36, v201
    v_mul_f32 v202, v36, v202
    v_mul_f32 v203, v36, v203
    v_mul_f32 v204, v36, v204
    v_mul_f32 v205, v36, v205
    v_mul_f32 v206, v36, v206
    v_mul_f32 v207, v36, v207
    v_cvt_pk_bf16_f32 v200, v200, v201
    v_cvt_pk_bf16_f32 v201, v202, v203
    v_cvt_pk_bf16_f32 v202, v204, v205
    v_cvt_pk_bf16_f32 v203, v206, v207
    buffer_store_dwordx4 v[200:203], v2, s[36:39], s87 offen offset:1024 sc1
    v_mul_f32 v208, v36, v208
    v_mul_f32 v209, v36, v209
    v_mul_f32 v210, v36, v210
    v_mul_f32 v211, v36, v211
    v_mul_f32 v212, v36, v212
    v_mul_f32 v213, v36, v213
    v_mul_f32 v214, v36, v214
    v_mul_f32 v215, v36, v215
    v_cvt_pk_bf16_f32 v208, v208, v209
    v_cvt_pk_bf16_f32 v209, v210, v211
    v_cvt_pk_bf16_f32 v210, v212, v213
    v_cvt_pk_bf16_f32 v211, v214, v215
    buffer_store_dwordx4 v[208:211], v2, s[36:39], s87 offen offset:2048 sc1
    v_mul_f32 v216, v36, v216
    v_mul_f32 v217, v36, v217
    v_mul_f32 v218, v36, v218
    v_mul_f32 v219, v36, v219
    v_mul_f32 v220, v36, v220
    v_mul_f32 v221, v36, v221
    v_mul_f32 v222, v36, v222
    v_mul_f32 v223, v36, v223
    v_cvt_pk_bf16_f32 v216, v216, v217
    v_cvt_pk_bf16_f32 v217, v218, v219
    v_cvt_pk_bf16_f32 v218, v220, v221
    v_cvt_pk_bf16_f32 v219, v222, v223
    buffer_store_dwordx4 v[216:219], v2, s[36:39], s87 offen offset:3072 sc1
    v_add_f32 v42, v15, v89
    v_min3_f32 v43, v88, v14, v15
    v_add_f32 v41, v41, v42
    v_min3_f32 v43, v43, v89, v91
    v_add_f32 v41, v41, v91
    v_cmp_nle_f32 vcc, 0x2f800000, v43
    s_nop 1
    s_mov_b64 s[62:63], vcc
    v_cmp_nge_f32 vcc, 0x53800000, v41
    s_nop 1
    s_or_b64 vcc, vcc, s[62:63]
    s_cmp_lg_u64 vcc, 0
    s_cselect_b32 s61, 1, 0
    s_lshl_b32 s62, s40, 2
    s_add_u32 s62, s62, 153088
    v_mov_b32 v41, s61
    v_mov_b32 v42, s62
    ds_write_b32 v42, v41
    v_mov_b32 v40, 153088
    s_waitcnt lgkmcnt(0)
    s_lshr_b32 s61, s2, 3
    s_mul_i32 s61, s61, 20480
    s_lshl_b32 s62, s40, 20
    s_add_u32 s61, s61, s62
    s_add_u32 s61, s61, 393600
    v_min_u32 v10, 19, v0
    v_lshl_add_u32 v10, v10, 10, s61
    global_load_dword v13, v10, s[12:13]
    s_and_b32 s64, s89, 1
    v_bfe_u32 v10, v0, 3, 1
    v_mov_b32 v11, 0x10000000
    v_cmp_eq_u32 vcc, s64, v10
    v_and_b32 v10, 15, v0
    v_lshrrev_b32 v12, 4, v0
    v_cndmask_b32 v7, v11, v2, vcc
    v_lshlrev_b32 v12, 3, v12
    v_lshl_add_u32 v12, v10, 10, v12
    s_lshl_b32 s61, s90, 7
    s_lshl_b32 s62, s40, 5
    s_add_u32 s61, s61, s62
    v_add_u32 v14, s61, v12
    v_cndmask_b32 v15, v11, v14, vcc
    v_mov_b32 v10, 1
    s_waitcnt vmcnt(1)
    s_barrier
    ds_read_b128 v[44:47], v40
    s_add_u32 m0, s60, 50688
    s_nop 0
    buffer_load_dwordx4 v6, s[80:83], s45 offen offset:0 lds
    s_add_u32 m0, s60, 50720
    s_nop 0
    buffer_load_dwordx4 v6, s[80:83], s45 offen offset:1024 lds
    s_add_u32 m0, s60, 50752
    s_nop 0
    buffer_load_dwordx4 v6, s[80:83], s45 offen offset:2048 lds
    s_add_u32 m0, s60, 50784
    s_nop 0
    buffer_load_dwordx4 v6, s[80:83], s45 offen offset:3072 lds
    s_xor_b32 s45, s52, 425984
    s_waitcnt lgkmcnt(0)
    v_or3_b32 v44, v44, v45, v46
    v_or_b32 v44, v44, v47
    s_nop 0
    v_readfirstlane_b32 s61, v44
    s_nop 1
    s_andn2_b32 s61, s61, s101
    s_cmp_lg_u32 s61, 0
    s_cbranch_scc1 L_restart
    s_cmp_lg_u32 s40, 0
    s_cbranch_scc1 L_published
    s_mov_b64 exec, 1
    buffer_atomic_add v10, off, s[92:95], s54
    s_mov_b64 exec, -1
L_published:
    s_add_u32 m0, s60, 101376
    s_nop 0
    buffer_load_dwordx4 v6, s[80:83], s45 offen offset:0 lds
    s_add_u32 m0, s60, 101408
    s_nop 0
    buffer_load_dwordx4 v6, s[80:83], s45 offen offset:1024 lds
    s_add_u32 m0, s60, 101440
    s_nop 0
    buffer_load_dwordx4 v6, s[80:83], s45 offen offset:2048 lds
    s_add_u32 m0, s60, 101472
    s_nop 0
    buffer_load_dwordx4 v6, s[80:83], s45 offen offset:3072 lds
    s_xor_b32 s45, s52, 458752
    s_add_u32 m0, s60, 84480
    s_nop 0
    buffer_load_dwordx4 v6, s[80:83], s45 offen offset:0 lds
    s_add_u32 m0, s60, 84512
    s_nop 0
    buffer_load_dwordx4 v6, s[80:83], s45 offen offset:1024 lds
    s_add_u32 m0, s60, 84544
    s_nop 0
    buffer_load_dwordx4 v6, s[80:83], s45 offen offset:2048 lds
    s_add_u32 m0, s60, 84576
    s_nop 0
    buffer_load_dwordx4 v6, s[80:83], s45 offen offset:3072 lds
    s_xor_b32 s45, s52, 491520
    ds_read_b64_tr_b16 a[16:17], v5 offset:50688
    ds_read_b64_tr_b16 a[18:19], v5 offset:51200
    ds_read_b64_tr_b16 a[20:21], v5 offset:50720
    ds_read_b64_tr_b16 a[22:23], v5 offset:51232
    ds_read_b64_tr_b16 a[24:25], v5 offset:50752
    ds_read_b64_tr_b16 a[26:27], v5 offset:51264
    ds_read_b64_tr_b16 a[28:29], v5 offset:50784
    ds_read_b64_tr_b16 a[30:31], v5 offset:51296
    s_waitcnt lgkmcnt(0)
    s_add_u32 m0, s60, 118272
    s_nop 0
    buffer_load_dwordx4 v6, s[80:83], s45 offen offset:0 lds
    s_add_u32 m0, s60, 118304
    s_nop 0
    buffer_load_dwordx4 v6, s[80:83], s45 offen offset:1024 lds
    s_add_u32 m0, s60, 118336
    s_nop 0
    buffer_load_dwordx4 v6, s[80:83], s45 offen offset:2048 lds
    s_add_u32 m0, s60, 118368
    s_nop 0
    buffer_load_dwordx4 v6, s[80:83], s45 offen offset:3072 lds
    s_xor_b32 s45, s52, 524288
    ds_read_b64_tr_b16 a[160:161], v5 offset:0
    ds_read_b64_tr_b16 a[162:163], v5 offset:512
    ds_read_b64_tr_b16 a[164:165], v5 offset:32
    ds_read_b64_tr_b16 a[166:167], v5 offset:544
    ds_read_b64_tr_b16 a[168:169], v5 offset:64
    ds_read_b64_tr_b16 a[170:171], v5 offset:576
    ds_read_b64_tr_b16 a[172:173], v5 offset:96
    ds_read_b64_tr_b16 a[174:175], v5 offset:608
    s_waitcnt lgkmcnt(0)
    s_add_u32 m0, s60, 67584
    s_nop 0
    buffer_load_dwordx4 v6, s[80:83], s45 offen offset:0 lds
    s_add_u32 m0, s60, 67616
    s_nop 0
    buffer_load_dwordx4 v6, s[80:83], s45 offen offset:1024 lds
    s_add_u32 m0, s60, 67648
    s_nop 0
    buffer_load_dwordx4 v6, s[80:83], s45 offen offset:2048 lds
    s_add_u32 m0, s60, 67680
    s_nop 0
    buffer_load_dwordx4 v6, s[80:83], s45 offen offset:3072 lds
    s_xor_b32 s45, s52, 557056
    ds_read_b64_tr_b16 a[176:177], v4 offset:0
    ds_read_b64_tr_b16 a[178:179], v4 offset:512
    ds_read_b64_tr_b16 a[180:181], v4 offset:32
    ds_read_b64_tr_b16 a[182:183], v4 offset:544
    ds_read_b64_tr_b16 a[184:185], v4 offset:64
    ds_read_b64_tr_b16 a[186:187], v4 offset:576
    ds_read_b64_tr_b16 a[188:189], v4 offset:96
    ds_read_b64_tr_b16 a[190:191], v4 offset:608
    s_waitcnt lgkmcnt(0)
    s_add_u32 m0, s60, 135168
    s_nop 0
    buffer_load_dwordx4 v6, s[80:83], s45 offen offset:0 lds
    s_add_u32 m0, s60, 135200
    s_nop 0
    buffer_load_dwordx4 v6, s[80:83], s45 offen offset:1024 lds
    s_add_u32 m0, s60, 135232
    s_nop 0
    buffer_load_dwordx4 v6, s[80:83], s45 offen offset:2048 lds
    s_add_u32 m0, s60, 135264
    s_nop 0
    buffer_load_dwordx4 v6, s[80:83], s45 offen offset:3072 lds
    s_xor_b32 s45, s52, 589824
    ds_read_b64_tr_b16 a[192:193], v1 offset:33792
    ds_read_b64_tr_b16 a[194:195], v1 offset:34304
    ds_read_b64_tr_b16 a[196:197], v1 offset:33824
    ds_read_b64_tr_b16 a[198:199], v1 offset:34336
    ds_read_b64_tr_b16 a[200:201], v1 offset:33856
    ds_read_b64_tr_b16 a[202:203], v1 offset:34368
    ds_read_b64_tr_b16 a[204:205], v1 offset:33888
    ds_read_b64_tr_b16 a[206:207], v1 offset:34400
    s_waitcnt lgkmcnt(0)
    s_add_u32 m0, s60, 33792
    s_nop 0
    buffer_load_dwordx4 v6, s[80:83], s45 offen offset:0 lds
    s_add_u32 m0, s60, 33824
    s_nop 0
    buffer_load_dwordx4 v6, s[80:83], s45 offen offset:1024 lds
    s_add_u32 m0, s60, 33856
    s_nop 0
    buffer_load_dwordx4 v6, s[80:83], s45 offen offset:2048 lds
    s_add_u32 m0, s60, 33888
    s_nop 0
    buffer_load_dwordx4 v6, s[80:83], s45 offen offset:3072 lds
    s_xor_b32 s45, s52, 622592
    ds_read_b64_tr_b16 a[240:241], v1 offset:0
    ds_read_b64_tr_b16 a[242:243], v1 offset:512
    ds_read_b64_tr_b16 a[244:245], v1 offset:32
    ds_read_b64_tr_b16 a[246:247], v1 offset:544
    ds_read_b64_tr_b16 a[248:249], v1 offset:64
    ds_read_b64_tr_b16 a[250:251], v1 offset:576
    ds_read_b64_tr_b16 a[252:253], v1 offset:96
    ds_read_b64_tr_b16 a[254:255], v1 offset:608
    s_waitcnt lgkmcnt(0)
    s_add_u32 m0, s60, 0
    s_nop 0
    buffer_load_dwordx4 v6, s[80:83], s45 offen offset:0 lds
    s_add_u32 m0, s60, 32
    s_nop 0
    buffer_load_dwordx4 v6, s[80:83], s45 offen offset:1024 lds
    s_add_u32 m0, s60, 64
    s_nop 0
    buffer_load_dwordx4 v6, s[80:83], s45 offen offset:2048 lds
    s_add_u32 m0, s60, 96
    s_nop 0
    buffer_load_dwordx4 v6, s[80:83], s45 offen offset:3072 lds
    s_xor_b32 s45, s52, 655360
    ds_read_b64_tr_b16 a[144:145], v1 offset:16896
    ds_read_b64_tr_b16 a[146:147], v1 offset:17408
    ds_read_b64_tr_b16 a[148:149], v1 offset:16928
    ds_read_b64_tr_b16 a[150:151], v1 offset:17440
    ds_read_b64_tr_b16 a[152:153], v1 offset:16960
    ds_read_b64_tr_b16 a[154:155], v1 offset:17472
    ds_read_b64_tr_b16 a[156:157], v1 offset:16992
    ds_read_b64_tr_b16 a[158:159], v1 offset:17504
    s_waitcnt lgkmcnt(0)
    s_add_u32 m0, s60, 16896
    s_nop 0
    buffer_load_dwordx4 v6, s[80:83], s45 offen offset:0 lds
    s_add_u32 m0, s60, 16928
    s_nop 0
    buffer_load_dwordx4 v6, s[80:83], s45 offen offset:1024 lds
    s_add_u32 m0, s60, 16960
    s_nop 0
    buffer_load_dwordx4 v6, s[80:83], s45 offen offset:2048 lds
    s_add_u32 m0, s60, 16992
    s_nop 0
    buffer_load_dwordx4 v6, s[80:83], s45 offen offset:3072 lds
    s_xor_b32 s45, s52, 688128
    s_waitcnt vmcnt(32)
    ds_read_b64_tr_b16 a[128:129], v1 offset:50688
    ds_read_b64_tr_b16 a[130:131], v1 offset:51200
    ds_read_b64_tr_b16 a[132:133], v1 offset:50720
    ds_read_b64_tr_b16 a[134:135], v1 offset:51232
    ds_read_b64_tr_b16 a[136:137], v1 offset:50752
    ds_read_b64_tr_b16 a[138:139], v1 offset:51264
    ds_read_b64_tr_b16 a[140:141], v1 offset:50784
    ds_read_b64_tr_b16 a[142:143], v1 offset:51296
    s_waitcnt lgkmcnt(0)
    s_add_u32 m0, s60, 50688
    s_nop 0
    buffer_load_dwordx4 v6, s[80:83], s45 offen offset:0 lds
    s_add_u32 m0, s60, 50720
    s_nop 0
    buffer_load_dwordx4 v6, s[80:83], s45 offen offset:1024 lds
    s_add_u32 m0, s60, 50752
    s_nop 0
    buffer_load_dwordx4 v6, s[80:83], s45 offen offset:2048 lds
    s_add_u32 m0, s60, 50784
    s_nop 0
    buffer_load_dwordx4 v6, s[80:83], s45 offen offset:3072 lds
    s_xor_b32 s45, s52, 720896
    s_waitcnt vmcnt(32)
    ds_read_b64_tr_b16 v[224:225], v5 offset:33792
    ds_read_b64_tr_b16 v[226:227], v5 offset:34304
    ds_read_b64_tr_b16 v[228:229], v5 offset:33824
    ds_read_b64_tr_b16 v[230:231], v5 offset:34336
    ds_read_b64_tr_b16 v[232:233], v5 offset:33856
    ds_read_b64_tr_b16 v[234:235], v5 offset:34368
    ds_read_b64_tr_b16 v[236:237], v5 offset:33888
    ds_read_b64_tr_b16 v[238:239], v5 offset:34400
    s_waitcnt lgkmcnt(0)
    s_add_u32 m0, s60, 101376
    s_nop 0
    buffer_load_dwordx4 v6, s[80:83], s45 offen offset:0 lds
    s_add_u32 m0, s60, 101408
    s_nop 0
    buffer_load_dwordx4 v6, s[80:83], s45 offen offset:1024 lds
    s_add_u32 m0, s60, 101440
    s_nop 0
    buffer_load_dwordx4 v6, s[80:83], s45 offen offset:2048 lds
    s_add_u32 m0, s60, 101472
    s_nop 0
    buffer_load_dwordx4 v6, s[80:83], s45 offen offset:3072 lds
    s_xor_b32 s45, s52, 753664
    s_waitcnt vmcnt(32)
    ds_read_b64_tr_b16 v[240:241], v5 offset:16896
    ds_read_b64_tr_b16 v[242:243], v5 offset:17408
    ds_read_b64_tr_b16 v[244:245], v5 offset:16928
    ds_read_b64_tr_b16 v[246:247], v5 offset:17440
    ds_read_b64_tr_b16 v[248:249], v5 offset:16960
    ds_read_b64_tr_b16 v[250:251], v5 offset:17472
    ds_read_b64_tr_b16 v[252:253], v5 offset:16992
    ds_read_b64_tr_b16 v[254:255], v5 offset:17504
    s_waitcnt lgkmcnt(0)
    s_add_u32 m0, s60, 84480
    s_nop 0
    buffer_load_dwordx4 v6, s[80:83], s45 offen offset:0 lds
    s_add_u32 m0, s60, 84512
    s_nop 0
    buffer_load_dwordx4 v6, s[80:83], s45 offen offset:1024 lds
    s_add_u32 m0, s60, 84544
    s_nop 0
    buffer_load_dwordx4 v6, s[80:83], s45 offen offset:2048 lds
    s_add_u32 m0, s60, 84576
    s_nop 0
    buffer_load_dwordx4 v6, s[80:83], s45 offen offset:3072 lds
    s_xor_b32 s45, s52, 786432
    s_waitcnt vmcnt(32)
    ds_read_b64_tr_b16 v[16:17], v5 offset:50688
    ds_read_b64_tr_b16 v[18:19], v5 offset:51200
    ds_read_b64_tr_b16 v[20:21], v5 offset:50720
    ds_read_b64_tr_b16 v[22:23], v5 offset:51232
    ds_read_b64_tr_b16 v[24:25], v5 offset:50752
    ds_read_b64_tr_b16 v[26:27], v5 offset:51264
    ds_read_b64_tr_b16 v[28:29], v5 offset:50784
    ds_read_b64_tr_b16 v[30:31], v5 offset:51296
    s_waitcnt lgkmcnt(0)
    s_add_u32 m0, s60, 118272
    s_nop 0
    buffer_load_dwordx4 v6, s[80:83], s45 offen offset:0 lds
    s_add_u32 m0, s60, 118304
    s_nop 0
    s_branch L_pg11
    .p2align 12
L_stub11:
    s_branch L_warm_ret
L_pg11:
    buffer_load_dwordx4 v6, s[80:83], s45 offen offset:1024 lds
    s_add_u32 m0, s60, 118336
    s_nop 0
    buffer_load_dwordx4 v6, s[80:83], s45 offen offset:2048 lds
    s_add_u32 m0, s60, 118368
    s_nop 0
    buffer_load_dwordx4 v6, s[80:83], s45 offen offset:3072 lds
    s_xor_b32 s45, s52, 819200
    s_waitcnt vmcnt(32)
    ds_read_b64_tr_b16 v[48:49], v5 offset:0
    ds_read_b64_tr_b16 v[50:51], v5 offset:512
    ds_read_b64_tr_b16 v[52:53], v5 offset:32
    ds_read_b64_tr_b16 v[54:55], v5 offset:544
    ds_read_b64_tr_b16 v[56:57], v5 offset:64
    ds_read_b64_tr_b16 v[58:59], v5 offset:576
    ds_read_b64_tr_b16 v[60:61], v5 offset:96
    ds_read_b64_tr_b16 v[62:63], v5 offset:608
    s_waitcnt lgkmcnt(0)
    s_add_u32 m0, s60, 67584
    s_nop 0
    buffer_load_dwordx4 v6, s[80:83], s45 offen offset:0 lds
    s_add_u32 m0, s60, 67616
    s_nop 0
    buffer_load_dwordx4 v6, s[80:83], s45 offen offset:1024 lds
    s_add_u32 m0, s60, 67648
    s_nop 0
    buffer_load_dwordx4 v6, s[80:83], s45 offen offset:2048 lds
    s_add_u32 m0, s60, 67680
    s_nop 0
    buffer_load_dwordx4 v6, s[80:83], s45 offen offset:3072 lds
    s_xor_b32 s45, s52, 851968
    s_waitcnt vmcnt(32)
    ds_read_b64_tr_b16 v[64:65], v4 offset:0
    ds_read_b64_tr_b16 v[66:67], v4 offset:512
    ds_read_b64_tr_b16 v[68:69], v4 offset:32
    ds_read_b64_tr_b16 v[70:71], v4 offset:544
    ds_read_b64_tr_b16 v[72:73], v4 offset:64
    ds_read_b64_tr_b16 v[74:75], v4 offset:576
    ds_read_b64_tr_b16 v[76:77], v4 offset:96
    ds_read_b64_tr_b16 v[78:79], v4 offset:608
    s_waitcnt lgkmcnt(0)
    s_add_u32 m0, s60, 135168
    s_nop 0
    buffer_load_dwordx4 v6, s[80:83], s45 offen offset:0 lds
    s_add_u32 m0, s60, 135200
    s_nop 0
    buffer_load_dwordx4 v6, s[80:83], s45 offen offset:1024 lds
    s_add_u32 m0, s60, 135232
    s_nop 0
    buffer_load_dwordx4 v6, s[80:83], s45 offen offset:2048 lds
    s_add_u32 m0, s60, 135264
    s_nop 0
    buffer_load_dwordx4 v6, s[80:83], s45 offen offset:3072 lds
    s_xor_b32 s45, s52, 884736
    s_waitcnt vmcnt(32)
    ds_read_b64_tr_b16 v[32:33], v1 offset:33792
    ds_read_b64_tr_b16 v[34:35], v1 offset:34304
    ds_read_b64_tr_b16 v[36:37], v1 offset:33824
    ds_read_b64_tr_b16 v[38:39], v1 offset:34336
    ds_read_b64_tr_b16 v[40:41], v1 offset:33856
    ds_read_b64_tr_b16 v[42:43], v1 offset:34368
    ds_read_b64_tr_b16 v[44:45], v1 offset:33888
    ds_read_b64_tr_b16 v[46:47], v1 offset:34400
    s_waitcnt lgkmcnt(0)
    s_add_u32 m0, s60, 33792
    s_nop 0
    buffer_load_dwordx4 v6, s[80:83], s45 offen offset:0 lds
    s_add_u32 m0, s60, 33824
    s_nop 0
    buffer_load_dwordx4 v6, s[80:83], s45 offen offset:1024 lds
    s_add_u32 m0, s60, 33856
    s_nop 0
    buffer_load_dwordx4 v6, s[80:83], s45 offen offset:2048 lds
    s_add_u32 m0, s60, 33888
    s_nop 0
    buffer_load_dwordx4 v6, s[80:83], s45 offen offset:3072 lds
    s_xor_b32 s45, s52, 917504
    s_waitcnt vmcnt(32)
    ds_read_b64_tr_b16 v[80:81], v1 offset:0
    ds_read_b64_tr_b16 v[82:83], v1 offset:512
    ds_read_b64_tr_b16 v[84:85], v1 offset:32
    ds_read_b64_tr_b16 v[86:87], v1 offset:544
    ds_read_b64_tr_b16 v[88:89], v1 offset:64
    ds_read_b64_tr_b16 v[90:91], v1 offset:576
    ds_read_b64_tr_b16 v[92:93], v1 offset:96
    ds_read_b64_tr_b16 v[94:95], v1 offset:608
    s_waitcnt lgkmcnt(0)
    s_add_u32 m0, s60, 0
    s_nop 0
    buffer_load_dwordx4 v6, s[80:83], s45 offen offset:0 lds
    s_add_u32 m0, s60, 32
    s_nop 0
    buffer_load_dwordx4 v6, s[80:83], s45 offen offset:1024 lds
    s_add_u32 m0, s60, 64
    s_nop 0
    buffer_load_dwordx4 v6, s[80:83], s45 offen offset:2048 lds
    s_add_u32 m0, s60, 96
    s_nop 0
    buffer_load_dwordx4 v6, s[80:83], s45 offen offset:3072 lds
    s_xor_b32 s45, s52, 950272
    s_waitcnt vmcnt(32)
    ds_read_b64_tr_b16 v[176:177], v1 offset:16896
    ds_read_b64_tr_b16 v[178:179], v1 offset:17408
    ds_read_b64_tr_b16 v[180:181], v1 offset:16928
    ds_read_b64_tr_b16 v[182:183], v1 offset:17440
    ds_read_b64_tr_b16 v[184:185], v1 offset:16960
    ds_read_b64_tr_b16 v[186:187], v1 offset:17472
    ds_read_b64_tr_b16 v[188:189], v1 offset:16992
    ds_read_b64_tr_b16 v[190:191], v1 offset:17504
    s_waitcnt lgkmcnt(0)
    s_add_u32 m0, s60, 16896
    s_nop 0
    buffer_load_dwordx4 v6, s[80:83], s45 offen offset:0 lds
    s_add_u32 m0, s60, 16928
    s_nop 0
    buffer_load_dwordx4 v6, s[80:83], s45 offen offset:1024 lds
    s_add_u32 m0, s60, 16960
    s_nop 0
    buffer_load_dwordx4 v6, s[80:83], s45 offen offset:2048 lds
    s_add_u32 m0, s60, 16992
    s_nop 0
    buffer_load_dwordx4 v6, s[80:83], s45 offen offset:3072 lds
    s_xor_b32 s45, s52, 983040
    s_mov_b64 exec, 1
    buffer_load_dword v11, off, s[92:95], s50 sc1
    s_mov_b64 exec, -1
    s_waitcnt vmcnt(33)
    ds_read_b64_tr_b16 v[192:193], v1 offset:50688
    ds_read_b64_tr_b16 v[194:195], v1 offset:51200
    ds_read_b64_tr_b16 v[196:197], v1 offset:50720
    ds_read_b64_tr_b16 v[198:199], v1 offset:51232
    ds_read_b64_tr_b16 v[200:201], v1 offset:50752
    ds_read_b64_tr_b16 v[202:203], v1 offset:51264
    ds_read_b64_tr_b16 v[204:205], v1 offset:50784
    ds_read_b64_tr_b16 v[206:207], v1 offset:51296
    s_waitcnt lgkmcnt(0)
    s_add_u32 m0, s60, 50688
    s_nop 0
    buffer_load_dwordx4 v6, s[80:83], s45 offen offset:0 lds
    s_add_u32 m0, s60, 50720
    s_nop 0
    buffer_load_dwordx4 v6, s[80:83], s45 offen offset:1024 lds
    s_add_u32 m0, s60, 50752
    s_nop 0
    buffer_load_dwordx4 v6, s[80:83], s45 offen offset:2048 lds
    s_add_u32 m0, s60, 50784
    s_nop 0
    buffer_load_dwordx4 v6, s[80:83], s45 offen offset:3072 lds
    s_xor_b32 s45, s52, 1015808
    s_waitcnt vmcnt(33)
    ds_read_b64_tr_b16 v[208:209], v5 offset:33792
    ds_read_b64_tr_b16 v[210:211], v5 offset:34304
    ds_read_b64_tr_b16 v[212:213], v5 offset:33824
    ds_read_b64_tr_b16 v[214:215], v5 offset:34336
    ds_read_b64_tr_b16 v[216:217], v5 offset:33856
    ds_read_b64_tr_b16 v[218:219], v5 offset:34368
    ds_read_b64_tr_b16 v[220:221], v5 offset:33888
    ds_read_b64_tr_b16 v[222:223], v5 offset:34400
    s_waitcnt lgkmcnt(0)
    s_xor_b32 s96, s53, 0
    s_xor_b32 s97, s53, 131072
    s_xor_b32 s98, s53, 262144
    s_xor_b32 s99, s53, 393216
    s_xor_b32 s100, s51, 0
    s_mov_b32 s63, 0x200000
    s_waitcnt vmcnt(4)
L_poll:
    v_readfirstlane_b32 s62, v11
    s_nop 1
    s_cmp_ge_u32 s62, 8
    s_cbranch_scc1 L_ready
    s_sub_u32 s63, s63, 1
    s_cmp_eq_u32 s63, 0
    s_cbranch_scc1 L_ready
    s_mov_b64 exec, 1
    buffer_load_dword v11, off, s[92:95], s50 sc1
    s_mov_b64 exec, -1
    s_waitcnt vmcnt(0)
    s_branch L_poll
L_ready:
    buffer_load_dwordx4 a[80:83], v2, s[20:23], s96 offen offset:0 sc1
    buffer_load_dwordx4 a[84:87], v2, s[20:23], s96 offen offset:1024 sc1
    buffer_load_dwordx4 a[88:91], v2, s[20:23], s97 offen offset:0 sc1
    buffer_load_dwordx4 a[92:95], v2, s[20:23], s97 offen offset:1024 sc1
    buffer_load_dwordx4 a[96:99], v2, s[20:23], s98 offen offset:0 sc1
    buffer_load_dwordx4 a[100:103], v2, s[20:23], s98 offen offset:1024 sc1
    buffer_load_dwordx4 a[104:107], v2, s[20:23], s99 offen offset:0 sc1
    buffer_load_dwordx4 a[108:111], v2, s[20:23], s99 offen offset:1024 sc1
    buffer_load_dwordx4 a[112:115], v7, s[20:23], s100 offen offset:0 sc1
    buffer_load_dwordx4 a[116:119], v7, s[20:23], s100 offen offset:1024 sc1
    buffer_load_dwordx4 a[120:123], v2, s[20:23], s96 offen offset:2048 sc1
    buffer_load_dwordx4 a[124:127], v2, s[20:23], s96 offen offset:3072 sc1
    s_add_u32 m0, s60, 101376
    s_nop 0
    buffer_load_dwordx4 v6, s[80:83], s45 offen offset:0 lds
    s_add_u32 m0, s60, 101408
    s_nop 0
    buffer_load_dwordx4 v6, s[80:83], s45 offen offset:1024 lds
    s_add_u32 m0, s60, 101440
    s_nop 0
    buffer_load_dwordx4 v6, s[80:83], s45 offen offset:2048 lds
    s_add_u32 m0, s60, 101472
    s_nop 0
    buffer_load_dwordx4 v6, s[80:83], s45 offen offset:3072 lds
    s_xor_b32 s45, s52, 1048576
    s_waitcnt vmcnt(14)
    v_mfma_f32_16x16x32_bf16 v[96:99], a[32:35], a[80:83], 0
    v_mfma_f32_16x16x32_bf16 v[96:99], a[48:51], a[84:87], v[96:99]
    v_mfma_f32_16x16x32_bf16 v[100:103], a[52:55], a[84:87], 0
    v_mfma_f32_16x16x32_bf16 v[100:103], a[36:39], a[80:83], v[100:103]
    v_mfma_f32_16x16x32_bf16 v[104:107], a[40:43], a[80:83], 0
    v_mfma_f32_16x16x32_bf16 v[104:107], a[56:59], a[84:87], v[104:107]
    v_mfma_f32_16x16x32_bf16 v[108:111], a[60:63], a[84:87], 0
    v_mfma_f32_16x16x32_bf16 v[108:111], a[44:47], a[80:83], v[108:111]
    s_waitcnt vmcnt(12)
    v_mfma_f32_16x16x32_bf16 v[112:115], a[32:35], a[88:91], 0
    buffer_load_dwordx4 a[80:83], v2, s[20:23], s97 offen offset:2048 sc1
    v_mfma_f32_16x16x32_bf16 v[112:115], a[48:51], a[92:95], v[112:115]
    v_mfma_f32_16x16x32_bf16 v[116:119], a[52:55], a[92:95], 0
    buffer_load_dwordx4 a[84:87], v2, s[20:23], s97 offen offset:3072 sc1
    v_mfma_f32_16x16x32_bf16 v[116:119], a[36:39], a[88:91], v[116:119]
    v_mfma_f32_16x16x32_bf16 v[120:123], a[40:43], a[88:91], 0
    v_mfma_f32_16x16x32_bf16 v[120:123], a[56:59], a[92:95], v[120:123]
    v_mfma_f32_16x16x32_bf16 v[124:127], a[60:63], a[92:95], 0
    v_mfma_f32_16x16x32_bf16 v[124:127], a[44:47], a[88:91], v[124:127]
    s_waitcnt vmcnt(12)
    v_mfma_f32_16x16x32_bf16 v[128:131], a[32:35], a[96:99], 0
    buffer_load_dwordx4 a[88:91], v2, s[20:23], s98 offen offset:2048 sc1
    v_mfma_f32_16x16x32_bf16 v[128:131], a[48:51], a[100:103], v[128:131]
    v_mfma_f32_16x16x32_bf16 v[132:135], a[52:55], a[100:103], 0
    buffer_load_dwordx4 a[92:95], v2, s[20:23], s98 offen offset:3072 sc1
    v_mfma_f32_16x16x32_bf16 v[132:135], a[36:39], a[96:99], v[132:135]
    v_mfma_f32_16x16x32_bf16 v[136:139], a[40:43], a[96:99], 0
    v_mfma_f32_16x16x32_bf16 v[136:139], a[56:59], a[100:103], v[136:139]
    v_mfma_f32_16x16x32_bf16 v[140:143], a[60:63], a[100:103], 0
    v_mfma_f32_16x16x32_bf16 v[140:143], a[44:47], a[96:99], v[140:143]
    s_waitcnt vmcnt(12)
    v_mfma_f32_16x16x32_bf16 v[144:147], a[32:35], a[104:107], 0
    buffer_load_dwordx4 a[96:99], v2, s[20:23], s99 offen offset:2048 sc1
    v_mfma_f32_16x16x32_bf16 v[144:147], a[48:51], a[108:111], v[144:147]
    v_mfma_f32_16x16x32_bf16 v[148:151], a[52:55], a[108:111], 0
    buffer_load_dwordx4 a[100:103], v2, s[20:23], s99 offen offset:3072 sc1
    v_mfma_f32_16x16x32_bf16 v[148:151], a[36:39], a[104:107], v[148:151]
    v_mfma_f32_16x16x32_bf16 v[152:155], a[40:43], a[104:107], 0
    v_mfma_f32_16x16x32_bf16 v[152:155], a[56:59], a[108:111], v[152:155]
    v_mfma_f32_16x16x32_bf16 v[156:159], a[60:63], a[108:111], 0
    v_mfma_f32_16x16x32_bf16 v[156:159], a[44:47], a[104:107], v[156:159]
    s_waitcnt vmcnt(12)
    v_mfma_f32_16x16x32_bf16 v[160:163], a[32:35], a[112:115], 0
    buffer_load_dwordx4 a[104:107], v7, s[20:23], s100 offen offset:2048 sc1
    v_mfma_f32_16x16x32_bf16 v[160:163], a[48:51], a[116:119], v[160:163]
    v_mfma_f32_16x16x32_bf16 v[164:167], a[52:55], a[116:119], 0
    buffer_load_dwordx4 a[108:111], v7, s[20:23], s100 offen offset:3072 sc1
    v_mfma_f32_16x16x32_bf16 v[164:167], a[36:39], a[112:115], v[164:167]
    v_mfma_f32_16x16x32_bf16 v[168:171], a[40:43], a[112:115], 0
    v_mfma_f32_16x16x32_bf16 v[168:171], a[56:59], a[116:119], v[168:171]
    v_mfma_f32_16x16x32_bf16 v[172:175], a[60:63], a[116:119], 0
    s_xor_b32 s96, s53, 4096
    v_mfma_f32_16x16x32_bf16 v[172:175], a[44:47], a[112:115], v[172:175]
    s_waitcnt vmcnt(12)
    v_mfma_f32_16x16x32_bf16 v[96:99], a[208:211], a[120:123], v[96:99]
    buffer_load_dwordx4 a[112:115], v2, s[20:23], s96 offen offset:0 sc1
    v_mfma_f32_16x16x32_bf16 v[96:99], a[224:227], a[124:127], v[96:99]
    ds_read_b64_tr_b16 a[32:33], v5 offset:16896
    ds_read_b64_tr_b16 a[34:35], v5 offset:17408
    v_mfma_f32_16x16x32_bf16 v[100:103], a[228:231], a[124:127], v[100:103]
    buffer_load_dwordx4 a[116:119], v2, s[20:23], s96 offen offset:1024 sc1
    v_mfma_f32_16x16x32_bf16 v[100:103], a[212:215], a[120:123], v[100:103]
    ds_read_b64_tr_b16 a[36:37], v5 offset:16928
    ds_read_b64_tr_b16 a[38:39], v5 offset:17440
    v_mfma_f32_16x16x32_bf16 v[104:107], a[216:219], a[120:123], v[104:107]
    ds_read_b64_tr_b16 a[40:41], v5 offset:16960
    ds_read_b64_tr_b16 a[42:43], v5 offset:17472
    v_mfma_f32_16x16x32_bf16 v[104:107], a[232:235], a[124:127], v[104:107]
    ds_read_b64_tr_b16 a[44:45], v5 offset:16992
    ds_read_b64_tr_b16 a[46:47], v5 offset:17504
    v_mfma_f32_16x16x32_bf16 v[108:111], a[236:239], a[124:127], v[108:111]
    s_xor_b32 s97, s53, 135168
    v_mfma_f32_16x16x32_bf16 v[108:111], a[220:223], a[120:123], v[108:111]
    s_waitcnt vmcnt(8)
    v_mfma_f32_16x16x32_bf16 v[112:115], a[208:211], a[80:83], v[112:115]
    buffer_load_dwordx4 a[120:123], v2, s[20:23], s97 offen offset:0 sc1
    v_mfma_f32_16x16x32_bf16 v[112:115], a[224:227], a[84:87], v[112:115]
    ds_read_b64_tr_b16 a[48:49], v5 offset:50688
    ds_read_b64_tr_b16 a[50:51], v5 offset:51200
    v_mfma_f32_16x16x32_bf16 v[116:119], a[228:231], a[84:87], v[116:119]
    buffer_load_dwordx4 a[124:127], v2, s[20:23], s97 offen offset:1024 sc1
    v_mfma_f32_16x16x32_bf16 v[116:119], a[212:215], a[80:83], v[116:119]
    ds_read_b64_tr_b16 a[52:53], v5 offset:50720
    ds_read_b64_tr_b16 a[54:55], v5 offset:51232
    v_mfma_f32_16x16x32_bf16 v[120:123], a[216:219], a[80:83], v[120:123]
    ds_read_b64_tr_b16 a[56:57], v5 offset:50752
    ds_read_b64_tr_b16 a[58:59], v5 offset:51264
    v_mfma_f32_16x16x32_bf16 v[120:123], a[232:235], a[84:87], v[120:123]
    ds_read_b64_tr_b16 a[60:61], v5 offset:50784
    ds_read_b64_tr_b16 a[62:63], v5 offset:51296
    v_mfma_f32_16x16x32_bf16 v[124:127], a[236:239], a[84:87], v[124:127]
    s_xor_b32 s98, s53, 266240
    v_mfma_f32_16x16x32_bf16 v[124:127], a[220:223], a[80:83], v[124:127]
    s_waitcnt vmcnt(8)
    v_mfma_f32_16x16x32_bf16 v[128:131], a[208:211], a[88:91], v[128:131]
    buffer_load_dwordx4 a[80:83], v2, s[20:23], s98 offen offset:0 sc1
    v_mfma_f32_16x16x32_bf16 v[128:131], a[224:227], a[92:95], v[128:131]
    v_mfma_f32_16x16x32_bf16 v[132:135], a[228:231], a[92:95], v[132:135]
    buffer_load_dwordx4 a[84:87], v2, s[20:23], s98 offen offset:1024 sc1
    v_mfma_f32_16x16x32_bf16 v[132:135], a[212:215], a[88:91], v[132:135]
    v_mfma_f32_16x16x32_bf16 v[136:139], a[216:219], a[88:91], v[136:139]
    v_mfma_f32_16x16x32_bf16 v[136:139], a[232:235], a[92:95], v[136:139]
    v_mfma_f32_16x16x32_bf16 v[140:143], a[236:239], a[92:95], v[140:143]
    s_xor_b32 s99, s53, 397312
    v_mfma_f32_16x16x32_bf16 v[140:143], a[220:223], a[88:91], v[140:143]
    s_waitcnt vmcnt(8)
    v_mfma_f32_16x16x32_bf16 v[144:147], a[208:211], a[96:99], v[144:147]
    buffer_load_dwordx4 a[88:91], v2, s[20:23], s99 offen offset:0 sc1
    v_mfma_f32_16x16x32_bf16 v[144:147], a[224:227], a[100:103], v[144:147]
    v_mfma_f32_16x16x32_bf16 v[148:151], a[228:231], a[100:103], v[148:151]
    buffer_load_dwordx4 a[92:95], v2, s[20:23], s99 offen offset:1024 sc1
    v_mfma_f32_16x16x32_bf16 v[148:151], a[212:215], a[96:99], v[148:151]
    v_mfma_f32_16x16x32_bf16 v[152:155], a[216:219], a[96:99], v[152:155]
    v_mfma_f32_16x16x32_bf16 v[152:155], a[232:235], a[100:103], v[152:155]
    v_mfma_f32_16x16x32_bf16 v[156:159], a[236:239], a[100:103], v[156:159]
    s_xor_b32 s100, s51, 4096
    v_mfma_f32_16x16x32_bf16 v[156:159], a[220:223], a[96:99], v[156:159]
    s_waitcnt vmcnt(8)
    v_mfma_f32_16x16x32_bf16 v[160:163], a[208:211], a[104:107], v[160:163]
    buffer_load_dwordx4 a[96:99], v7, s[20:23], s100 offen offset:0 sc1
    v_mfma_f32_16x16x32_bf16 v[160:163], a[224:227], a[108:111], v[160:163]
    v_mfma_f32_16x16x32_bf16 v[164:167], a[228:231], a[108:111], v[164:167]
    buffer_load_dwordx4 a[100:103], v7, s[20:23], s100 offen offset:1024 sc1
    v_mfma_f32_16x16x32_bf16 v[164:167], a[212:215], a[104:107], v[164:167]
    v_mfma_f32_16x16x32_bf16 v[168:171], a[216:219], a[104:107], v[168:171]
    v_mfma_f32_16x16x32_bf16 v[168:171], a[232:235], a[108:111], v[168:171]
    v_mfma_f32_16x16x32_bf16 v[172:175], a[236:239], a[108:111], v[172:175]
    v_mfma_f32_16x16x32_bf16 v[172:175], a[220:223], a[104:107], v[172:175]
    s_waitcnt vmcnt(8)
    v_mfma_f32_16x16x32_bf16 v[96:99], a[0:3], a[112:115], v[96:99]
    buffer_load_dwordx4 a[104:107], v2, s[20:23], s96 offen offset:2048 sc1
    v_mfma_f32_16x16x32_bf16 v[96:99], a[64:67], a[116:119], v[96:99]
    ds_read_b64_tr_b16 a[208:209], v5 offset:0
    ds_read_b64_tr_b16 a[210:211], v5 offset:512
    v_mfma_f32_16x16x32_bf16 v[100:103], a[68:71], a[116:119], v[100:103]
    buffer_load_dwordx4 a[108:111], v2, s[20:23], s96 offen offset:3072 sc1
    v_mfma_f32_16x16x32_bf16 v[100:103], a[4:7], a[112:115], v[100:103]
    ds_read_b64_tr_b16 a[212:213], v5 offset:32
    ds_read_b64_tr_b16 a[214:215], v5 offset:544
    v_mfma_f32_16x16x32_bf16 v[104:107], a[8:11], a[112:115], v[104:107]
    ds_read_b64_tr_b16 a[216:217], v5 offset:64
    ds_read_b64_tr_b16 a[218:219], v5 offset:576
    v_mfma_f32_16x16x32_bf16 v[104:107], a[72:75], a[116:119], v[104:107]
    ds_read_b64_tr_b16 a[220:221], v5 offset:96
    ds_read_b64_tr_b16 a[222:223], v5 offset:608
    v_mfma_f32_16x16x32_bf16 v[108:111], a[76:79], a[116:119], v[108:111]
    ds_read_b64_tr_b16 a[224:225], v4 offset:0
    ds_read_b64_tr_b16 a[226:227], v4 offset:512
    v_mfma_f32_16x16x32_bf16 v[108:111], a[12:15], a[112:115], v[108:111]
    s_waitcnt vmcnt(8)
    ds_read_b64_tr_b16 a[228:229], v4 offset:32
    ds_read_b64_tr_b16 a[230:231], v4 offset:544
    v_mfma_f32_16x16x32_bf16 v[112:115], a[0:3], a[120:123], v[112:115]
    buffer_load_dwordx4 a[112:115], v2, s[20:23], s97 offen offset:2048 sc1
    v_mfma_f32_16x16x32_bf16 v[112:115], a[64:67], a[124:127], v[112:115]
    ds_read_b64_tr_b16 a[232:233], v4 offset:64
    ds_read_b64_tr_b16 a[234:235], v4 offset:576
    v_mfma_f32_16x16x32_bf16 v[116:119], a[68:71], a[124:127], v[116:119]
    buffer_load_dwordx4 a[116:119], v2, s[20:23], s97 offen offset:3072 sc1
    v_mfma_f32_16x16x32_bf16 v[116:119], a[4:7], a[120:123], v[116:119]
    ds_read_b64_tr_b16 a[236:237], v4 offset:96
    ds_read_b64_tr_b16 a[238:239], v4 offset:608
    v_mfma_f32_16x16x32_bf16 v[120:123], a[8:11], a[120:123], v[120:123]
    v_mfma_f32_16x16x32_bf16 v[120:123], a[72:75], a[124:127], v[120:123]
    v_mfma_f32_16x16x32_bf16 v[124:127], a[76:79], a[124:127], v[124:127]
    v_mfma_f32_16x16x32_bf16 v[124:127], a[12:15], a[120:123], v[124:127]
    s_waitcnt vmcnt(8)
    v_mfma_f32_16x16x32_bf16 v[128:131], a[0:3], a[80:83], v[128:131]
    buffer_load_dwordx4 a[120:123], v2, s[20:23], s98 offen offset:2048 sc1
    v_mfma_f32_16x16x32_bf16 v[128:131], a[64:67], a[84:87], v[128:131]
    v_mfma_f32_16x16x32_bf16 v[132:135], a[68:71], a[84:87], v[132:135]
    buffer_load_dwordx4 a[124:127], v2, s[20:23], s98 offen offset:3072 sc1
    v_mfma_f32_16x16x32_bf16 v[132:135], a[4:7], a[80:83], v[132:135]
    v_mfma_f32_16x16x32_bf16 v[136:139], a[8:11], a[80:83], v[136:139]
    v_mfma_f32_16x16x32_bf16 v[136:139], a[72:75], a[84:87], v[136:139]
    v_mfma_f32_16x16x32_bf16 v[140:143], a[76:79], a[84:87], v[140:143]
    v_mfma_f32_16x16x32_bf16 v[140:143], a[12:15], a[80:83], v[140:143]
    s_waitcnt vmcnt(8)
    v_mfma_f32_16x16x32_bf16 v[144:147], a[0:3], a[88:91], v[144:147]
    buffer_load_dwordx4 a[80:83], v2, s[20:23], s99 offen offset:2048 sc1
    v_mfma_f32_16x16x32_bf16 v[144:147], a[64:67], a[92:95], v[144:147]
    v_mfma_f32_16x16x32_bf16 v[148:151], a[68:71], a[92:95], v[148:151]
    buffer_load_dwordx4 a[84:87], v2, s[20:23], s99 offen offset:3072 sc1
    v_mfma_f32_16x16x32_bf16 v[148:151], a[4:7], a[88:91], v[148:151]
    v_mfma_f32_16x16x32_bf16 v[152:155], a[8:11], a[88:91], v[152:155]
    v_mfma_f32_16x16x32_bf16 v[152:155], a[72:75], a[92:95], v[152:155]
    v_mfma_f32_16x16x32_bf16 v[156:159], a[76:79], a[92:95], v[156:159]
    v_mfma_f32_16x16x32_bf16 v[156:159], a[12:15], a[88:91], v[156:159]
    s_waitcnt vmcnt(8)
    v_mfma_f32_16x16x32_bf16 v[160:163], a[0:3], a[96:99], v[160:163]
    buffer_load_dwordx4 a[88:91], v7, s[20:23], s100 offen offset:2048 sc1
    v_mfma_f32_16x16x32_bf16 v[160:163], a[64:67], a[100:103], v[160:163]
    v_mfma_f32_16x16x32_bf16 v[164:167], a[68:71], a[100:103], v[164:167]
    buffer_load_dwordx4 a[92:95], v7, s[20:23], s100 offen offset:3072 sc1
    v_mfma_f32_16x16x32_bf16 v[164:167], a[4:7], a[96:99], v[164:167]
    v_mfma_f32_16x16x32_bf16 v[168:171], a[8:11], a[96:99], v[168:171]
    v_mfma_f32_16x16x32_bf16 v[168:171], a[72:75], a[100:103], v[168:171]
    v_mfma_f32_16x16x32_bf16 v[172:175], a[76:79], a[100:103], v[172:175]
    s_xor_b32 s96, s53, 8192
    v_mfma_f32_16x16x32_bf16 v[172:175], a[12:15], a[96:99], v[172:175]
    s_waitcnt vmcnt(8)
    v_mfma_f32_16x16x32_bf16 v[96:99], a[16:19], a[104:107], v[96:99]
    buffer_load_dwordx4 a[96:99], v2, s[20:23], s96 offen offset:0 sc1
    v_mfma_f32_16x16x32_bf16 v[96:99], a[160:163], a[108:111], v[96:99]
    ds_read_b64_tr_b16 a[0:1], v1 offset:33792
    ds_read_b64_tr_b16 a[2:3], v1 offset:34304
    v_mfma_f32_16x16x32_bf16 v[100:103], a[164:167], a[108:111], v[100:103]
    buffer_load_dwordx4 a[100:103], v2, s[20:23], s96 offen offset:1024 sc1
    v_mfma_f32_16x16x32_bf16 v[100:103], a[20:23], a[104:107], v[100:103]
    ds_read_b64_tr_b16 a[4:5], v1 offset:33824
    ds_read_b64_tr_b16 a[6:7], v1 offset:34336
    v_mfma_f32_16x16x32_bf16 v[104:107], a[24:27], a[104:107], v[104:107]
    ds_read_b64_tr_b16 a[8:9], v1 offset:33856
    ds_read_b64_tr_b16 a[10:11], v1 offset:34368
    v_mfma_f32_16x16x32_bf16 v[104:107], a[168:171], a[108:111], v[104:107]
    ds_read_b64_tr_b16 a[12:13], v1 offset:33888
    ds_read_b64_tr_b16 a[14:15], v1 offset:34400
    v_mfma_f32_16x16x32_bf16 v[108:111], a[172:175], a[108:111], v[108:111]
    s_xor_b32 s97, s53, 139264
    v_mfma_f32_16x16x32_bf16 v[108:111], a[28:31], a[104:107], v[108:111]
    s_waitcnt vmcnt(8)
    v_mfma_f32_16x16x32_bf16 v[112:115], a[16:19], a[112:115], v[112:115]
    buffer_load_dwordx4 a[104:107], v2, s[20:23], s97 offen offset:0 sc1
    v_mfma_f32_16x16x32_bf16 v[112:115], a[160:163], a[116:119], v[112:115]
    ds_read_b64_tr_b16 a[64:65], v1 offset:0
    ds_read_b64_tr_b16 a[66:67], v1 offset:512
    v_mfma_f32_16x16x32_bf16 v[116:119], a[164:167], a[116:119], v[116:119]
    buffer_load_dwordx4 a[108:111], v2, s[20:23], s97 offen offset:1024 sc1
    v_mfma_f32_16x16x32_bf16 v[116:119], a[20:23], a[112:115], v[116:119]
    ds_read_b64_tr_b16 a[68:69], v1 offset:32
    ds_read_b64_tr_b16 a[70:71], v1 offset:544
    v_mfma_f32_16x16x32_bf16 v[120:123], a[24:27], a[112:115], v[120:123]
    ds_read_b64_tr_b16 a[72:73], v1 offset:64
    ds_read_b64_tr_b16 a[74:75], v1 offset:576
    v_mfma_f32_16x16x32_bf16 v[120:123], a[168:171], a[116:119], v[120:123]
    ds_read_b64_tr_b16 a[76:77], v1 offset:96
    ds_read_b64_tr_b16 a[78:79], v1 offset:608
    v_mfma_f32_16x16x32_bf16 v[124:127], a[172:175], a[116:119], v[124:127]
    s_xor_b32 s98, s53, 270336
    v_mfma_f32_16x16x32_bf16 v[124:127], a[28:31], a[112:115], v[124:127]
    s_waitcnt vmcnt(8)
    v_mfma_f32_16x16x32_bf16 v[128:131], a[16:19], a[120:123], v[128:131]
    buffer_load_dwordx4 a[112:115], v2, s[20:23], s98 offen offset:0 sc1
    v_mfma_f32_16x16x32_bf16 v[128:131], a[160:163], a[124:127], v[128:131]
    v_mfma_f32_16x16x32_bf16 v[132:135], a[164:167], a[124:127], v[132:135]
    buffer_load_dwordx4 a[116:119], v2, s[20:23], s98 offen offset:1024 sc1
    v_mfma_f32_16x16x32_bf16 v[132:135], a[20:23], a[120:123], v[132:135]
    v_mfma_f32_16x16x32_bf16 v[136:139], a[24:27], a[120:123], v[136:139]
    v_mfma_f32_16x16x32_bf16 v[136:139], a[168:171], a[124:127], v[136:139]
    v_mfma_f32_16x16x32_bf16 v[140:143], a[172:175], a[124:127], v[140:143]
    s_xor_b32 s99, s53, 401408
    v_mfma_f32_16x16x32_bf16 v[140:143], a[28:31], a[120:123], v[140:143]
    s_waitcnt vmcnt(8)
    v_mfma_f32_16x16x32_bf16 v[144:147], a[16:19], a[80:83], v[144:147]
    buffer_load_dwordx4 a[120:123], v2, s[20:23], s99 offen offset:0 sc1
    v_mfma_f32_16x16x32_bf16 v[144:147], a[160:163], a[84:87], v[144:147]
    v_mfma_f32_16x16x32_bf16 v[148:151], a[164:167], a[84:87], v[148:151]
    buffer_load_dwordx4 a[124:127], v2, s[20:23], s99 offen offset:1024 sc1
    v_mfma_f32_16x16x32_bf16 v[148:151], a[20:23], a[80:83], v[148:151]
    v_mfma_f32_16x16x32_bf16 v[152:155], a[24:27], a[80:83], v[152:155]
    v_mfma_f32_16x16x32_bf16 v[152:155], a[168:171], a[84:87], v[152:155]
    v_mfma_f32_16x16x32_bf16 v[156:159], a[172:175], a[84:87], v[156:159]
    s_xor_b32 s100, s51, 8192
    v_mfma_f32_16x16x32_bf16 v[156:159], a[28:31], a[80:83], v[156:159]
    s_waitcnt vmcnt(8)
    v_mfma_f32_16x16x32_bf16 v[160:163], a[16:19], a[88:91], v[160:163]
    buffer_load_dwordx4 a[80:83], v7, s[20:23], s100 offen offset:0 sc1
    v_mfma_f32_16x16x32_bf16 v[160:163], a[160:163], a[92:95], v[160:163]
    v_mfma_f32_16x16x32_bf16 v[164:167], a[164:167], a[92:95], v[164:167]
    buffer_load_dwordx4 a[84:87], v7, s[20:23], s100 offen offset:1024 sc1
    v_mfma_f32_16x16x32_bf16 v[164:167], a[20:23], a[88:91], v[164:167]
    v_mfma_f32_16x16x32_bf16 v[168:171], a[24:27], a[88:91], v[168:171]
    v_mfma_f32_16x16x32_bf16 v[168:171], a[168:171], a[92:95], v[168:171]
    v_mfma_f32_16x16x32_bf16 v[172:175], a[172:175], a[92:95], v[172:175]
    v_mfma_f32_16x16x32_bf16 v[172:175], a[28:31], a[88:91], v[172:175]
    s_waitcnt vmcnt(8)
    v_mfma_f32_16x16x32_bf16 v[96:99], a[176:179], a[96:99], v[96:99]
    buffer_load_dwordx4 a[88:91], v2, s[20:23], s96 offen offset:2048 sc1
    v_mfma_f32_16x16x32_bf16 v[96:99], a[192:195], a[100:103], v[96:99]
    ds_read_b64_tr_b16 a[16:17], v1 offset:16896
    ds_read_b64_tr_b16 a[18:19], v1 offset:17408
    v_mfma_f32_16x16x32_bf16 v[100:103], a[196:199], a[100:103], v[100:103]
    buffer_load_dwordx4 a[92:95], v2, s[20:23], s96 offen offset:3072 sc1
    v_mfma_f32_16x16x32_bf16 v[100:103], a[180:183], a[96:99], v[100:103]
    ds_read_b64_tr_b16 a[20:21], v1 offset:16928
    ds_read_b64_tr_b16 a[22:23], v1 offset:17440
    v_mfma_f32_16x16x32_bf16 v[104:107], a[184:187], a[96:99], v[104:107]
    ds_read_b64_tr_b16 a[24:25], v1 offset:16960
    ds_read_b64_tr_b16 a[26:27], v1 offset:17472
    v_mfma_f32_16x16x32_bf16 v[104:107], a[200:203], a[100:103], v[104:107]
    ds_read_b64_tr_b16 a[28:29], v1 offset:16992
    ds_read_b64_tr_b16 a[30:31], v1 offset:17504
    v_mfma_f32_16x16x32_bf16 v[108:111], a[204:207], a[100:103], v[108:111]
    ds_read_b64_tr_b16 a[160:161], v1 offset:50688
    ds_read_b64_tr_b16 a[162:163], v1 offset:51200
    v_mfma_f32_16x16x32_bf16 v[108:111], a[188:191], a[96:99], v[108:111]
    s_waitcnt vmcnt(8)
    ds_read_b64_tr_b16 a[164:165], v1 offset:50720
    ds_read_b64_tr_b16 a[166:167], v1 offset:51232
    v_mfma_f32_16x16x32_bf16 v[112:115], a[176:179], a[104:107], v[112:115]
    buffer_load_dwordx4 a[96:99], v2, s[20:23], s97 offen offset:2048 sc1
    v_mfma_f32_16x16x32_bf16 v[112:115], a[192:195], a[108:111], v[112:115]
    ds_read_b64_tr_b16 a[168:169], v1 offset:50752
    ds_read_b64_tr_b16 a[170:171], v1 offset:51264
    v_mfma_f32_16x16x32_bf16 v[116:119], a[196:199], a[108:111], v[116:119]
    buffer_load_dwordx4 a[100:103], v2, s[20:23], s97 offen offset:3072 sc1
    v_mfma_f32_16x16x32_bf16 v[116:119], a[180:183], a[104:107], v[116:119]
    ds_read_b64_tr_b16 a[172:173], v1 offset:50784
    ds_read_b64_tr_b16 a[174:175], v1 offset:51296
    v_mfma_f32_16x16x32_bf16 v[120:123], a[184:187], a[104:107], v[120:123]
    v_mfma_f32_16x16x32_bf16 v[120:123], a[200:203], a[108:111], v[120:123]
    v_mfma_f32_16x16x32_bf16 v[124:127], a[204:207], a[108:111], v[124:127]
    v_mfma_f32_16x16x32_bf16 v[124:127], a[188:191], a[104:107], v[124:127]
    s_waitcnt vmcnt(8)
    v_mfma_f32_16x16x32_bf16 v[128:131], a[176:179], a[112:115], v[128:131]
    buffer_load_dwordx4 a[104:107], v2, s[20:23], s98 offen offset:2048 sc1
    v_mfma_f32_16x16x32_bf16 v[128:131], a[192:195], a[116:119], v[128:131]
    v_mfma_f32_16x16x32_bf16 v[132:135], a[196:199], a[116:119], v[132:135]
    buffer_load_dwordx4 a[108:111], v2, s[20:23], s98 offen offset:3072 sc1
    v_mfma_f32_16x16x32_bf16 v[132:135], a[180:183], a[112:115], v[132:135]
    v_mfma_f32_16x16x32_bf16 v[136:139], a[184:187], a[112:115], v[136:139]
    v_mfma_f32_16x16x32_bf16 v[136:139], a[200:203], a[116:119], v[136:139]
    v_mfma_f32_16x16x32_bf16 v[140:143], a[204:207], a[116:119], v[140:143]
    v_mfma_f32_16x16x32_bf16 v[140:143], a[188:191], a[112:115], v[140:143]
    s_waitcnt vmcnt(8)
    v_mfma_f32_16x16x32_bf16 v[144:147], a[176:179], a[120:123], v[144:147]
    buffer_load_dwordx4 a[112:115], v2, s[20:23], s99 offen offset:2048 sc1
    v_mfma_f32_16x16x32_bf16 v[144:147], a[192:195], a[124:127], v[144:147]
    v_mfma_f32_16x16x32_bf16 v[148:151], a[196:199], a[124:127], v[148:151]
    buffer_load_dwordx4 a[116:119], v2, s[20:23], s99 offen offset:3072 sc1
    v_mfma_f32_16x16x32_bf16 v[148:151], a[180:183], a[120:123], v[148:151]
    v_mfma_f32_16x16x32_bf16 v[152:155], a[184:187], a[120:123], v[152:155]
    v_mfma_f32_16x16x32_bf16 v[152:155], a[200:203], a[124:127], v[152:155]
    v_mfma_f32_16x16x32_bf16 v[156:159], a[204:207], a[124:127], v[156:159]
    v_mfma_f32_16x16x32_bf16 v[156:159], a[188:191], a[120:123], v[156:159]
    s_waitcnt vmcnt(8)
    v_mfma_f32_16x16x32_bf16 v[160:163], a[176:179], a[80:83], v[160:163]
    buffer_load_dwordx4 a[120:123], v7, s[20:23], s100 offen offset:2048 sc1
    v_mfma_f32_16x16x32_bf16 v[160:163], a[192:195], a[84:87], v[160:163]
    v_mfma_f32_16x16x32_bf16 v[164:167], a[196:199], a[84:87], v[164:167]
    buffer_load_dwordx4 a[124:127], v7, s[20:23], s100 offen offset:3072 sc1
    v_mfma_f32_16x16x32_bf16 v[164:167], a[180:183], a[80:83], v[164:167]
    v_mfma_f32_16x16x32_bf16 v[168:171], a[184:187], a[80:83], v[168:171]
    v_mfma_f32_16x16x32_bf16 v[168:171], a[200:203], a[84:87], v[168:171]
    v_mfma_f32_16x16x32_bf16 v[172:175], a[204:207], a[84:87], v[172:175]
    s_xor_b32 s96, s53, 12288
    v_mfma_f32_16x16x32_bf16 v[172:175], a[188:191], a[80:83], v[172:175]
    s_waitcnt vmcnt(8)
    v_mfma_f32_16x16x32_bf16 v[96:99], a[240:243], a[88:91], v[96:99]
    buffer_load_dwordx4 a[80:83], v2, s[20:23], s96 offen offset:0 sc1
    v_mfma_f32_16x16x32_bf16 v[96:99], a[144:147], a[92:95], v[96:99]
    s_branch L_pg12
    .p2align 12
L_stub12:
    s_branch L_warm_ret
L_pg12:
    ds_read_b64_tr_b16 a[176:177], v5 offset:33792
    ds_read_b64_tr_b16 a[178:179], v5 offset:34304
    v_mfma_f32_16x16x32_bf16 v[100:103], a[148:151], a[92:95], v[100:103]
    buffer_load_dwordx4 a[84:87], v2, s[20:23], s96 offen offset:1024 sc1
    v_mfma_f32_16x16x32_bf16 v[100:103], a[244:247], a[88:91], v[100:103]
    ds_read_b64_tr_b16 a[180:181], v5 offset:33824
    ds_read_b64_tr_b16 a[182:183], v5 offset:34336
    v_mfma_f32_16x16x32_bf16 v[104:107], a[248:251], a[88:91], v[104:107]
    ds_read_b64_tr_b16 a[184:185], v5 offset:33856
    ds_read_b64_tr_b16 a[186:187], v5 offset:34368
    v_mfma_f32_16x16x32_bf16 v[104:107], a[152:155], a[92:95], v[104:107]
    ds_read_b64_tr_b16 a[188:189], v5 offset:33888
    ds_read_b64_tr_b16 a[190:191], v5 offset:34400
    v_mfma_f32_16x16x32_bf16 v[108:111], a[156:159], a[92:95], v[108:111]
    s_xor_b32 s97, s53, 143360
    v_mfma_f32_16x16x32_bf16 v[108:111], a[252:255], a[88:91], v[108:111]
    s_waitcnt vmcnt(8)
    v_mfma_f32_16x16x32_bf16 v[112:115], a[240:243], a[96:99], v[112:115]
    buffer_load_dwordx4 a[88:91], v2, s[20:23], s97 offen offset:0 sc1
    v_mfma_f32_16x16x32_bf16 v[112:115], a[144:147], a[100:103], v[112:115]
    v_mfma_f32_16x16x32_bf16 v[116:119], a[148:151], a[100:103], v[116:119]
    buffer_load_dwordx4 a[92:95], v2, s[20:23], s97 offen offset:1024 sc1
    v_mfma_f32_16x16x32_bf16 v[116:119], a[244:247], a[96:99], v[116:119]
    v_mfma_f32_16x16x32_bf16 v[120:123], a[248:251], a[96:99], v[120:123]
    v_mfma_f32_16x16x32_bf16 v[120:123], a[152:155], a[100:103], v[120:123]
    v_mfma_f32_16x16x32_bf16 v[124:127], a[156:159], a[100:103], v[124:127]
    s_xor_b32 s98, s53, 274432
    v_mfma_f32_16x16x32_bf16 v[124:127], a[252:255], a[96:99], v[124:127]
    s_waitcnt vmcnt(8)
    v_mfma_f32_16x16x32_bf16 v[128:131], a[240:243], a[104:107], v[128:131]
    buffer_load_dwordx4 a[96:99], v2, s[20:23], s98 offen offset:0 sc1
    v_mfma_f32_16x16x32_bf16 v[128:131], a[144:147], a[108:111], v[128:131]
    v_mfma_f32_16x16x32_bf16 v[132:135], a[148:151], a[108:111], v[132:135]
    buffer_load_dwordx4 a[100:103], v2, s[20:23], s98 offen offset:1024 sc1
    v_mfma_f32_16x16x32_bf16 v[132:135], a[244:247], a[104:107], v[132:135]
    v_mfma_f32_16x16x32_bf16 v[136:139], a[248:251], a[104:107], v[136:139]
    v_mfma_f32_16x16x32_bf16 v[136:139], a[152:155], a[108:111], v[136:139]
    v_mfma_f32_16x16x32_bf16 v[140:143], a[156:159], a[108:111], v[140:143]
    s_xor_b32 s99, s53, 405504
    v_mfma_f32_16x16x32_bf16 v[140:143], a[252:255], a[104:107], v[140:143]
    s_waitcnt vmcnt(8)
    v_mfma_f32_16x16x32_bf16 v[144:147], a[240:243], a[112:115], v[144:147]
    buffer_load_dwordx4 a[104:107], v2, s[20:23], s99 offen offset:0 sc1
    v_mfma_f32_16x16x32_bf16 v[144:147], a[144:147], a[116:119], v[144:147]
    v_mfma_f32_16x16x32_bf16 v[148:151], a[148:151], a[116:119], v[148:151]
    buffer_load_dwordx4 a[108:111], v2, s[20:23], s99 offen offset:1024 sc1
    v_mfma_f32_16x16x32_bf16 v[148:151], a[244:247], a[112:115], v[148:151]
    v_mfma_f32_16x16x32_bf16 v[152:155], a[248:251], a[112:115], v[152:155]
    v_mfma_f32_16x16x32_bf16 v[152:155], a[152:155], a[116:119], v[152:155]
    v_mfma_f32_16x16x32_bf16 v[156:159], a[156:159], a[116:119], v[156:159]
    s_xor_b32 s100, s51, 12288
    v_mfma_f32_16x16x32_bf16 v[156:159], a[252:255], a[112:115], v[156:159]
    s_waitcnt vmcnt(8)
    v_mfma_f32_16x16x32_bf16 v[160:163], a[240:243], a[120:123], v[160:163]
    buffer_load_dwordx4 a[112:115], v7, s[20:23], s100 offen offset:0 sc1
    v_mfma_f32_16x16x32_bf16 v[160:163], a[144:147], a[124:127], v[160:163]
    v_mfma_f32_16x16x32_bf16 v[164:167], a[148:151], a[124:127], v[164:167]
    buffer_load_dwordx4 a[116:119], v7, s[20:23], s100 offen offset:1024 sc1
    v_mfma_f32_16x16x32_bf16 v[164:167], a[244:247], a[120:123], v[164:167]
    v_mfma_f32_16x16x32_bf16 v[168:171], a[248:251], a[120:123], v[168:171]
    v_mfma_f32_16x16x32_bf16 v[168:171], a[152:155], a[124:127], v[168:171]
    v_mfma_f32_16x16x32_bf16 v[172:175], a[156:159], a[124:127], v[172:175]
    v_mfma_f32_16x16x32_bf16 v[172:175], a[252:255], a[120:123], v[172:175]
    s_waitcnt vmcnt(8)
    v_mfma_f32_16x16x32_bf16 v[96:99], a[128:131], a[80:83], v[96:99]
    buffer_load_dwordx4 a[120:123], v2, s[20:23], s96 offen offset:2048 sc1
    v_mfma_f32_16x16x32_bf16 v[96:99], v[224:227], a[84:87], v[96:99]
    v_mfma_f32_16x16x32_bf16 v[100:103], v[228:231], a[84:87], v[100:103]
    buffer_load_dwordx4 a[124:127], v2, s[20:23], s96 offen offset:3072 sc1
    v_mfma_f32_16x16x32_bf16 v[100:103], a[132:135], a[80:83], v[100:103]
    v_mfma_f32_16x16x32_bf16 v[104:107], a[136:139], a[80:83], v[104:107]
    v_mfma_f32_16x16x32_bf16 v[104:107], v[232:235], a[84:87], v[104:107]
    v_mfma_f32_16x16x32_bf16 v[108:111], v[236:239], a[84:87], v[108:111]
    v_mfma_f32_16x16x32_bf16 v[108:111], a[140:143], a[80:83], v[108:111]
    s_waitcnt vmcnt(8)
    v_mfma_f32_16x16x32_bf16 v[112:115], a[128:131], a[88:91], v[112:115]
    buffer_load_dwordx4 a[80:83], v2, s[20:23], s97 offen offset:2048 sc1
    v_mfma_f32_16x16x32_bf16 v[112:115], v[224:227], a[92:95], v[112:115]
    v_mfma_f32_16x16x32_bf16 v[116:119], v[228:231], a[92:95], v[116:119]
    buffer_load_dwordx4 a[84:87], v2, s[20:23], s97 offen offset:3072 sc1
    v_mfma_f32_16x16x32_bf16 v[116:119], a[132:135], a[88:91], v[116:119]
    v_mfma_f32_16x16x32_bf16 v[120:123], a[136:139], a[88:91], v[120:123]
    v_mfma_f32_16x16x32_bf16 v[120:123], v[232:235], a[92:95], v[120:123]
    v_mfma_f32_16x16x32_bf16 v[124:127], v[236:239], a[92:95], v[124:127]
    v_mfma_f32_16x16x32_bf16 v[124:127], a[140:143], a[88:91], v[124:127]
    s_waitcnt vmcnt(8)
    v_mfma_f32_16x16x32_bf16 v[128:131], a[128:131], a[96:99], v[128:131]
    buffer_load_dwordx4 a[88:91], v2, s[20:23], s98 offen offset:2048 sc1
    v_mfma_f32_16x16x32_bf16 v[128:131], v[224:227], a[100:103], v[128:131]
    v_mfma_f32_16x16x32_bf16 v[132:135], v[228:231], a[100:103], v[132:135]
    buffer_load_dwordx4 a[92:95], v2, s[20:23], s98 offen offset:3072 sc1
    v_mfma_f32_16x16x32_bf16 v[132:135], a[132:135], a[96:99], v[132:135]
    v_mfma_f32_16x16x32_bf16 v[136:139], a[136:139], a[96:99], v[136:139]
    v_mfma_f32_16x16x32_bf16 v[136:139], v[232:235], a[100:103], v[136:139]
    v_mfma_f32_16x16x32_bf16 v[140:143], v[236:239], a[100:103], v[140:143]
    v_mfma_f32_16x16x32_bf16 v[140:143], a[140:143], a[96:99], v[140:143]
    s_waitcnt vmcnt(8)
    v_mfma_f32_16x16x32_bf16 v[144:147], a[128:131], a[104:107], v[144:147]
    buffer_load_dwordx4 a[96:99], v2, s[20:23], s99 offen offset:2048 sc1
    v_mfma_f32_16x16x32_bf16 v[144:147], v[224:227], a[108:111], v[144:147]
    v_mfma_f32_16x16x32_bf16 v[148:151], v[228:231], a[108:111], v[148:151]
    buffer_load_dwordx4 a[100:103], v2, s[20:23], s99 offen offset:3072 sc1
    v_mfma_f32_16x16x32_bf16 v[148:151], a[132:135], a[104:107], v[148:151]
    v_mfma_f32_16x16x32_bf16 v[152:155], a[136:139], a[104:107], v[152:155]
    v_mfma_f32_16x16x32_bf16 v[152:155], v[232:235], a[108:111], v[152:155]
    v_mfma_f32_16x16x32_bf16 v[156:159], v[236:239], a[108:111], v[156:159]
    v_mfma_f32_16x16x32_bf16 v[156:159], a[140:143], a[104:107], v[156:159]
    s_waitcnt vmcnt(8)
    v_mfma_f32_16x16x32_bf16 v[160:163], a[128:131], a[112:115], v[160:163]
    buffer_load_dwordx4 a[104:107], v7, s[20:23], s100 offen offset:2048 sc1
    v_mfma_f32_16x16x32_bf16 v[160:163], v[224:227], a[116:119], v[160:163]
    v_mfma_f32_16x16x32_bf16 v[164:167], v[228:231], a[116:119], v[164:167]
    buffer_load_dwordx4 a[108:111], v7, s[20:23], s100 offen offset:3072 sc1
    v_mfma_f32_16x16x32_bf16 v[164:167], a[132:135], a[112:115], v[164:167]
    v_mfma_f32_16x16x32_bf16 v[168:171], a[136:139], a[112:115], v[168:171]
    v_mfma_f32_16x16x32_bf16 v[168:171], v[232:235], a[116:119], v[168:171]
    v_mfma_f32_16x16x32_bf16 v[172:175], v[236:239], a[116:119], v[172:175]
    s_xor_b32 s96, s53, 16384
    v_mfma_f32_16x16x32_bf16 v[172:175], a[140:143], a[112:115], v[172:175]
    s_waitcnt vmcnt(8)
    v_mfma_f32_16x16x32_bf16 v[96:99], v[240:243], a[120:123], v[96:99]
    buffer_load_dwordx4 a[112:115], v2, s[20:23], s96 offen offset:0 sc1
    v_mfma_f32_16x16x32_bf16 v[96:99], v[16:19], a[124:127], v[96:99]
    v_mfma_f32_16x16x32_bf16 v[100:103], v[20:23], a[124:127], v[100:103]
    buffer_load_dwordx4 a[116:119], v2, s[20:23], s96 offen offset:1024 sc1
    v_mfma_f32_16x16x32_bf16 v[100:103], v[244:247], a[120:123], v[100:103]
    v_mfma_f32_16x16x32_bf16 v[104:107], v[248:251], a[120:123], v[104:107]
    v_mfma_f32_16x16x32_bf16 v[104:107], v[24:27], a[124:127], v[104:107]
    v_mfma_f32_16x16x32_bf16 v[108:111], v[28:31], a[124:127], v[108:111]
    s_xor_b32 s97, s53, 147456
    v_mfma_f32_16x16x32_bf16 v[108:111], v[252:255], a[120:123], v[108:111]
    s_waitcnt vmcnt(8)
    v_mfma_f32_16x16x32_bf16 v[112:115], v[240:243], a[80:83], v[112:115]
    buffer_load_dwordx4 a[120:123], v2, s[20:23], s97 offen offset:0 sc1
    v_mfma_f32_16x16x32_bf16 v[112:115], v[16:19], a[84:87], v[112:115]
    v_mfma_f32_16x16x32_bf16 v[116:119], v[20:23], a[84:87], v[116:119]
    buffer_load_dwordx4 a[124:127], v2, s[20:23], s97 offen offset:1024 sc1
    v_mfma_f32_16x16x32_bf16 v[116:119], v[244:247], a[80:83], v[116:119]
    v_mfma_f32_16x16x32_bf16 v[120:123], v[248:251], a[80:83], v[120:123]
    v_mfma_f32_16x16x32_bf16 v[120:123], v[24:27], a[84:87], v[120:123]
    v_mfma_f32_16x16x32_bf16 v[124:127], v[28:31], a[84:87], v[124:127]
    s_xor_b32 s98, s53, 278528
    v_mfma_f32_16x16x32_bf16 v[124:127], v[252:255], a[80:83], v[124:127]
    s_waitcnt vmcnt(8)
    v_mfma_f32_16x16x32_bf16 v[128:131], v[240:243], a[88:91], v[128:131]
    buffer_load_dwordx4 a[80:83], v2, s[20:23], s98 offen offset:0 sc1
    v_mfma_f32_16x16x32_bf16 v[128:131], v[16:19], a[92:95], v[128:131]
    v_mfma_f32_16x16x32_bf16 v[132:135], v[20:23], a[92:95], v[132:135]
    buffer_load_dwordx4 a[84:87], v2, s[20:23], s98 offen offset:1024 sc1
    v_mfma_f32_16x16x32_bf16 v[132:135], v[244:247], a[88:91], v[132:135]
    v_mfma_f32_16x16x32_bf16 v[136:139], v[248:251], a[88:91], v[136:139]
    v_mfma_f32_16x16x32_bf16 v[136:139], v[24:27], a[92:95], v[136:139]
    v_mfma_f32_16x16x32_bf16 v[140:143], v[28:31], a[92:95], v[140:143]
    s_xor_b32 s99, s53, 409600
    v_mfma_f32_16x16x32_bf16 v[140:143], v[252:255], a[88:91], v[140:143]
    s_waitcnt vmcnt(8)
    v_mfma_f32_16x16x32_bf16 v[144:147], v[240:243], a[96:99], v[144:147]
    buffer_load_dwordx4 a[88:91], v2, s[20:23], s99 offen offset:0 sc1
    v_mfma_f32_16x16x32_bf16 v[144:147], v[16:19], a[100:103], v[144:147]
    v_mfma_f32_16x16x32_bf16 v[148:151], v[20:23], a[100:103], v[148:151]
    buffer_load_dwordx4 a[92:95], v2, s[20:23], s99 offen offset:1024 sc1
    v_mfma_f32_16x16x32_bf16 v[148:151], v[244:247], a[96:99], v[148:151]
    v_mfma_f32_16x16x32_bf16 v[152:155], v[248:251], a[96:99], v[152:155]
    v_mfma_f32_16x16x32_bf16 v[152:155], v[24:27], a[100:103], v[152:155]
    v_mfma_f32_16x16x32_bf16 v[156:159], v[28:31], a[100:103], v[156:159]
    s_xor_b32 s100, s51, 16384
    v_mfma_f32_16x16x32_bf16 v[156:159], v[252:255], a[96:99], v[156:159]
    s_waitcnt vmcnt(8)
    v_mfma_f32_16x16x32_bf16 v[160:163], v[240:243], a[104:107], v[160:163]
    buffer_load_dwordx4 a[96:99], v7, s[20:23], s100 offen offset:0 sc1
    v_mfma_f32_16x16x32_bf16 v[160:163], v[16:19], a[108:111], v[160:163]
    v_mfma_f32_16x16x32_bf16 v[164:167], v[20:23], a[108:111], v[164:167]
    buffer_load_dwordx4 a[100:103], v7, s[20:23], s100 offen offset:1024 sc1
    v_mfma_f32_16x16x32_bf16 v[164:167], v[244:247], a[104:107], v[164:167]
    v_mfma_f32_16x16x32_bf16 v[168:171], v[248:251], a[104:107], v[168:171]
    v_mfma_f32_16x16x32_bf16 v[168:171], v[24:27], a[108:111], v[168:171]
    v_mfma_f32_16x16x32_bf16 v[172:175], v[28:31], a[108:111], v[172:175]
    v_mfma_f32_16x16x32_bf16 v[172:175], v[252:255], a[104:107], v[172:175]
    s_waitcnt vmcnt(8)
    v_mfma_f32_16x16x32_bf16 v[96:99], v[48:51], a[112:115], v[96:99]
    buffer_load_dwordx4 a[104:107], v2, s[20:23], s96 offen offset:2048 sc1
    v_mfma_f32_16x16x32_bf16 v[96:99], v[64:67], a[116:119], v[96:99]
    v_mfma_f32_16x16x32_bf16 v[100:103], v[68:71], a[116:119], v[100:103]
    buffer_load_dwordx4 a[108:111], v2, s[20:23], s96 offen offset:3072 sc1
    v_mfma_f32_16x16x32_bf16 v[100:103], v[52:55], a[112:115], v[100:103]
    v_mfma_f32_16x16x32_bf16 v[104:107], v[56:59], a[112:115], v[104:107]
    v_mfma_f32_16x16x32_bf16 v[104:107], v[72:75], a[116:119], v[104:107]
    v_mfma_f32_16x16x32_bf16 v[108:111], v[76:79], a[116:119], v[108:111]
    v_mfma_f32_16x16x32_bf16 v[108:111], v[60:63], a[112:115], v[108:111]
    s_waitcnt vmcnt(8)
    v_mfma_f32_16x16x32_bf16 v[112:115], v[48:51], a[120:123], v[112:115]
    buffer_load_dwordx4 a[112:115], v2, s[20:23], s97 offen offset:2048 sc1
    v_mfma_f32_16x16x32_bf16 v[112:115], v[64:67], a[124:127], v[112:115]
    v_mfma_f32_16x16x32_bf16 v[116:119], v[68:71], a[124:127], v[116:119]
    buffer_load_dwordx4 a[116:119], v2, s[20:23], s97 offen offset:3072 sc1
    v_mfma_f32_16x16x32_bf16 v[116:119], v[52:55], a[120:123], v[116:119]
    v_mfma_f32_16x16x32_bf16 v[120:123], v[56:59], a[120:123], v[120:123]
    v_mfma_f32_16x16x32_bf16 v[120:123], v[72:75], a[124:127], v[120:123]
    v_mfma_f32_16x16x32_bf16 v[124:127], v[76:79], a[124:127], v[124:127]
    v_mfma_f32_16x16x32_bf16 v[124:127], v[60:63], a[120:123], v[124:127]
    s_waitcnt vmcnt(8)
    v_mfma_f32_16x16x32_bf16 v[128:131], v[48:51], a[80:83], v[128:131]
    buffer_load_dwordx4 a[120:123], v2, s[20:23], s98 offen offset:2048 sc1
    v_mfma_f32_16x16x32_bf16 v[128:131], v[64:67], a[84:87], v[128:131]
    v_mfma_f32_16x16x32_bf16 v[132:135], v[68:71], a[84:87], v[132:135]
    buffer_load_dwordx4 a[124:127], v2, s[20:23], s98 offen offset:3072 sc1
    v_mfma_f32_16x16x32_bf16 v[132:135], v[52:55], a[80:83], v[132:135]
    v_mfma_f32_16x16x32_bf16 v[136:139], v[56:59], a[80:83], v[136:139]
    v_mfma_f32_16x16x32_bf16 v[136:139], v[72:75], a[84:87], v[136:139]
    v_mfma_f32_16x16x32_bf16 v[140:143], v[76:79], a[84:87], v[140:143]
    v_mfma_f32_16x16x32_bf16 v[140:143], v[60:63], a[80:83], v[140:143]
    s_waitcnt vmcnt(8)
    v_mfma_f32_16x16x32_bf16 v[144:147], v[48:51], a[88:91], v[144:147]
    buffer_load_dwordx4 a[80:83], v2, s[20:23], s99 offen offset:2048 sc1
    v_mfma_f32_16x16x32_bf16 v[144:147], v[64:67], a[92:95], v[144:147]
    v_mfma_f32_16x16x32_bf16 v[148:151], v[68:71], a[92:95], v[148:151]
    buffer_load_dwordx4 a[84:87], v2, s[20:23], s99 offen offset:3072 sc1
    v_mfma_f32_16x16x32_bf16 v[148:151], v[52:55], a[88:91], v[148:151]
    v_mfma_f32_16x16x32_bf16 v[152:155], v[56:59], a[88:91], v[152:155]
    v_mfma_f32_16x16x32_bf16 v[152:155], v[72:75], a[92:95], v[152:155]
    v_mfma_f32_16x16x32_bf16 v[156:159], v[76:79], a[92:95], v[156:159]
    v_mfma_f32_16x16x32_bf16 v[156:159], v[60:63], a[88:91], v[156:159]
    s_waitcnt vmcnt(8)
    v_mfma_f32_16x16x32_bf16 v[160:163], v[48:51], a[96:99], v[160:163]
    buffer_load_dwordx4 a[88:91], v7, s[20:23], s100 offen offset:2048 sc1
    v_mfma_f32_16x16x32_bf16 v[160:163], v[64:67], a[100:103], v[160:163]
    v_mfma_f32_16x16x32_bf16 v[164:167], v[68:71], a[100:103], v[164:167]
    buffer_load_dwordx4 a[92:95], v7, s[20:23], s100 offen offset:3072 sc1
    v_mfma_f32_16x16x32_bf16 v[164:167], v[52:55], a[96:99], v[164:167]
    v_mfma_f32_16x16x32_bf16 v[168:171], v[56:59], a[96:99], v[168:171]
    v_mfma_f32_16x16x32_bf16 v[168:171], v[72:75], a[100:103], v[168:171]
    v_mfma_f32_16x16x32_bf16 v[172:175], v[76:79], a[100:103], v[172:175]
    s_xor_b32 s96, s53, 20480
    v_mfma_f32_16x16x32_bf16 v[172:175], v[60:63], a[96:99], v[172:175]
    s_waitcnt vmcnt(8)
    v_mfma_f32_16x16x32_bf16 v[96:99], v[32:35], a[104:107], v[96:99]
    buffer_load_dwordx4 a[96:99], v2, s[20:23], s96 offen offset:0 sc1
    v_mfma_f32_16x16x32_bf16 v[96:99], v[80:83], a[108:111], v[96:99]
    v_mfma_f32_16x16x32_bf16 v[100:103], v[84:87], a[108:111], v[100:103]
    buffer_load_dwordx4 a[100:103], v2, s[20:23], s96 offen offset:1024 sc1
    v_mfma_f32_16x16x32_bf16 v[100:103], v[36:39], a[104:107], v[100:103]
    v_mfma_f32_16x16x32_bf16 v[104:107], v[40:43], a[104:107], v[104:107]
    v_mfma_f32_16x16x32_bf16 v[104:107], v[88:91], a[108:111], v[104:107]
    v_mfma_f32_16x16x32_bf16 v[108:111], v[92:95], a[108:111], v[108:111]
    s_xor_b32 s97, s53, 151552
    v_mfma_f32_16x16x32_bf16 v[108:111], v[44:47], a[104:107], v[108:111]
    s_waitcnt vmcnt(8)
    v_mfma_f32_16x16x32_bf16 v[112:115], v[32:35], a[112:115], v[112:115]
    buffer_load_dwordx4 a[104:107], v2, s[20:23], s97 offen offset:0 sc1
    v_mfma_f32_16x16x32_bf16 v[112:115], v[80:83], a[116:119], v[112:115]
    v_mfma_f32_16x16x32_bf16 v[116:119], v[84:87], a[116:119], v[116:119]
    buffer_load_dwordx4 a[108:111], v2, s[20:23], s97 offen offset:1024 sc1
    v_mfma_f32_16x16x32_bf16 v[116:119], v[36:39], a[112:115], v[116:119]
    v_mfma_f32_16x16x32_bf16 v[120:123], v[40:43], a[112:115], v[120:123]
    v_mfma_f32_16x16x32_bf16 v[120:123], v[88:91], a[116:119], v[120:123]
    v_mfma_f32_16x16x32_bf16 v[124:127], v[92:95], a[116:119], v[124:127]
    s_xor_b32 s98, s53, 282624
    v_mfma_f32_16x16x32_bf16 v[124:127], v[44:47], a[112:115], v[124:127]
    s_waitcnt vmcnt(8)
    v_mfma_f32_16x16x32_bf16 v[128:131], v[32:35], a[120:123], v[128:131]
    buffer_load_dwordx4 a[112:115], v2, s[20:23], s98 offen offset:0 sc1
    v_mfma_f32_16x16x32_bf16 v[128:131], v[80:83], a[124:127], v[128:131]
    v_mfma_f32_16x16x32_bf16 v[132:135], v[84:87], a[124:127], v[132:135]
    buffer_load_dwordx4 a[116:119], v2, s[20:23], s98 offen offset:1024 sc1
    v_mfma_f32_16x16x32_bf16 v[132:135], v[36:39], a[120:123], v[132:135]
    v_mfma_f32_16x16x32_bf16 v[136:139], v[40:43], a[120:123], v[136:139]
    v_mfma_f32_16x16x32_bf16 v[136:139], v[88:91], a[124:127], v[136:139]
    v_mfma_f32_16x16x32_bf16 v[140:143], v[92:95], a[124:127], v[140:143]
    s_xor_b32 s99, s53, 413696
    v_mfma_f32_16x16x32_bf16 v[140:143], v[44:47], a[120:123], v[140:143]
    s_waitcnt vmcnt(8)
    v_mfma_f32_16x16x32_bf16 v[144:147], v[32:35], a[80:83], v[144:147]
    buffer_load_dwordx4 a[120:123], v2, s[20:23], s99 offen offset:0 sc1
    v_mfma_f32_16x16x32_bf16 v[144:147], v[80:83], a[84:87], v[144:147]
    v_mfma_f32_16x16x32_bf16 v[148:151], v[84:87], a[84:87], v[148:151]
    buffer_load_dwordx4 a[124:127], v2, s[20:23], s99 offen offset:1024 sc1
    v_mfma_f32_16x16x32_bf16 v[148:151], v[36:39], a[80:83], v[148:151]
    v_mfma_f32_16x16x32_bf16 v[152:155], v[40:43], a[80:83], v[152:155]
    v_mfma_f32_16x16x32_bf16 v[152:155], v[88:91], a[84:87], v[152:155]
    v_mfma_f32_16x16x32_bf16 v[156:159], v[92:95], a[84:87], v[156:159]
    s_xor_b32 s100, s51, 20480
    v_mfma_f32_16x16x32_bf16 v[156:159], v[44:47], a[80:83], v[156:159]
    s_waitcnt vmcnt(8)
    v_mfma_f32_16x16x32_bf16 v[160:163], v[32:35], a[88:91], v[160:163]
    buffer_load_dwordx4 a[80:83], v7, s[20:23], s100 offen offset:0 sc1
    v_mfma_f32_16x16x32_bf16 v[160:163], v[80:83], a[92:95], v[160:163]
    v_mfma_f32_16x16x32_bf16 v[164:167], v[84:87], a[92:95], v[164:167]
    buffer_load_dwordx4 a[84:87], v7, s[20:23], s100 offen offset:1024 sc1
    v_mfma_f32_16x16x32_bf16 v[164:167], v[36:39], a[88:91], v[164:167]
    v_mfma_f32_16x16x32_bf16 v[168:171], v[40:43], a[88:91], v[168:171]
    v_mfma_f32_16x16x32_bf16 v[168:171], v[88:91], a[92:95], v[168:171]
    v_mfma_f32_16x16x32_bf16 v[172:175], v[92:95], a[92:95], v[172:175]
    v_mfma_f32_16x16x32_bf16 v[172:175], v[44:47], a[88:91], v[172:175]
    s_waitcnt vmcnt(8)
    v_mfma_f32_16x16x32_bf16 v[96:99], v[176:179], a[96:99], v[96:99]
    buffer_load_dwordx4 a[88:91], v2, s[20:23], s96 offen offset:2048 sc1
    v_mfma_f32_16x16x32_bf16 v[96:99], v[192:195], a[100:103], v[96:99]
    v_mfma_f32_16x16x32_bf16 v[100:103], v[196:199], a[100:103], v[100:103]
    buffer_load_dwordx4 a[92:95], v2, s[20:23], s96 offen offset:3072 sc1
    v_mfma_f32_16x16x32_bf16 v[100:103], v[180:183], a[96:99], v[100:103]
    v_mfma_f32_16x16x32_bf16 v[104:107], v[184:187], a[96:99], v[104:107]
    v_mfma_f32_16x16x32_bf16 v[104:107], v[200:203], a[100:103], v[104:107]
    v_mfma_f32_16x16x32_bf16 v[108:111], v[204:207], a[100:103], v[108:111]
    v_mfma_f32_16x16x32_bf16 v[108:111], v[188:191], a[96:99], v[108:111]
    s_waitcnt vmcnt(8)
    v_mfma_f32_16x16x32_bf16 v[112:115], v[176:179], a[104:107], v[112:115]
    buffer_load_dwordx4 a[96:99], v2, s[20:23], s97 offen offset:2048 sc1
    v_mfma_f32_16x16x32_bf16 v[112:115], v[192:195], a[108:111], v[112:115]
    v_mfma_f32_16x16x32_bf16 v[116:119], v[196:199], a[108:111], v[116:119]
    buffer_load_dwordx4 a[100:103], v2, s[20:23], s97 offen offset:3072 sc1
    v_mfma_f32_16x16x32_bf16 v[116:119], v[180:183], a[104:107], v[116:119]
    v_mfma_f32_16x16x32_bf16 v[120:123], v[184:187], a[104:107], v[120:123]
    v_mfma_f32_16x16x32_bf16 v[120:123], v[200:203], a[108:111], v[120:123]
    v_mfma_f32_16x16x32_bf16 v[124:127], v[204:207], a[108:111], v[124:127]
    v_mfma_f32_16x16x32_bf16 v[124:127], v[188:191], a[104:107], v[124:127]
    s_waitcnt vmcnt(8)
    v_mfma_f32_16x16x32_bf16 v[128:131], v[176:179], a[112:115], v[128:131]
    buffer_load_dwordx4 a[104:107], v2, s[20:23], s98 offen offset:2048 sc1
    v_mfma_f32_16x16x32_bf16 v[128:131], v[192:195], a[116:119], v[128:131]
    v_mfma_f32_16x16x32_bf16 v[132:135], v[196:199], a[116:119], v[132:135]
    buffer_load_dwordx4 a[108:111], v2, s[20:23], s98 offen offset:3072 sc1
    v_mfma_f32_16x16x32_bf16 v[132:135], v[180:183], a[112:115], v[132:135]
    v_mfma_f32_16x16x32_bf16 v[136:139], v[184:187], a[112:115], v[136:139]
    v_mfma_f32_16x16x32_bf16 v[136:139], v[200:203], a[116:119], v[136:139]
    v_mfma_f32_16x16x32_bf16 v[140:143], v[204:207], a[116:119], v[140:143]
    v_mfma_f32_16x16x32_bf16 v[140:143], v[188:191], a[112:115], v[140:143]
    s_waitcnt vmcnt(8)
    v_mfma_f32_16x16x32_bf16 v[144:147], v[176:179], a[120:123], v[144:147]
    buffer_load_dwordx4 a[112:115], v2, s[20:23], s99 offen offset:2048 sc1
    v_mfma_f32_16x16x32_bf16 v[144:147], v[192:195], a[124:127], v[144:147]
    v_mfma_f32_16x16x32_bf16 v[148:151], v[196:199], a[124:127], v[148:151]
    buffer_load_dwordx4 a[116:119], v2, s[20:23], s99 offen offset:3072 sc1
    v_mfma_f32_16x16x32_bf16 v[148:151], v[180:183], a[120:123], v[148:151]
    v_mfma_f32_16x16x32_bf16 v[152:155], v[184:187], a[120:123], v[152:155]
    v_mfma_f32_16x16x32_bf16 v[152:155], v[200:203], a[124:127], v[152:155]
    v_mfma_f32_16x16x32_bf16 v[156:159], v[204:207], a[124:127], v[156:159]
    v_mfma_f32_16x16x32_bf16 v[156:159], v[188:191], a[120:123], v[156:159]
    s_waitcnt vmcnt(8)
    v_mfma_f32_16x16x32_bf16 v[160:163], v[176:179], a[80:83], v[160:163]
    buffer_load_dwordx4 a[120:123], v7, s[20:23], s100 offen offset:2048 sc1
    v_mfma_f32_16x16x32_bf16 v[160:163], v[192:195], a[84:87], v[160:163]
    v_mfma_f32_16x16x32_bf16 v[164:167], v[196:199], a[84:87], v[164:167]
    buffer_load_dwordx4 a[124:127], v7, s[20:23], s100 offen offset:3072 sc1
    v_mfma_f32_16x16x32_bf16 v[164:167], v[180:183], a[80:83], v[164:167]
    v_mfma_f32_16x16x32_bf16 v[168:171], v[184:187], a[80:83], v[168:171]
    v_mfma_f32_16x16x32_bf16 v[168:171], v[200:203], a[84:87], v[168:171]
    v_mfma_f32_16x16x32_bf16 v[172:175], v[204:207], a[84:87], v[172:175]
    s_xor_b32 s96, s53, 24576
    v_mfma_f32_16x16x32_bf16 v[172:175], v[188:191], a[80:83], v[172:175]
    s_waitcnt vmcnt(8)
    v_mfma_f32_16x16x32_bf16 v[96:99], v[208:211], a[88:91], v[96:99]
    s_waitcnt lgkmcnt(0)
    buffer_load_dwordx4 a[80:83], v2, s[20:23], s96 offen offset:0 sc1
    v_mfma_f32_16x16x32_bf16 v[96:99], a[32:35], a[92:95], v[96:99]
    v_mfma_f32_16x16x32_bf16 v[100:103], a[36:39], a[92:95], v[100:103]
    buffer_load_dwordx4 a[84:87], v2, s[20:23], s96 offen offset:1024 sc1
    v_mfma_f32_16x16x32_bf16 v[100:103], v[212:215], a[88:91], v[100:103]
    v_mfma_f32_16x16x32_bf16 v[104:107], v[216:219], a[88:91], v[104:107]
    v_mfma_f32_16x16x32_bf16 v[104:107], a[40:43], a[92:95], v[104:107]
    v_mfma_f32_16x16x32_bf16 v[108:111], a[44:47], a[92:95], v[108:111]
    s_xor_b32 s97, s53, 155648
    v_mfma_f32_16x16x32_bf16 v[108:111], v[220:223], a[88:91], v[108:111]
    s_waitcnt vmcnt(8)
    v_mfma_f32_16x16x32_bf16 v[112:115], v[208:211], a[96:99], v[112:115]
    buffer_load_dwordx4 a[88:91], v2, s[20:23], s97 offen offset:0 sc1
    v_mfma_f32_16x16x32_bf16 v[112:115], a[32:35], a[100:103], v[112:115]
    v_mfma_f32_16x16x32_bf16 v[116:119], a[36:39], a[100:103], v[116:119]
    buffer_load_dwordx4 a[92:95], v2, s[20:23], s97 offen offset:1024 sc1
    v_mfma_f32_16x16x32_bf16 v[116:119], v[212:215], a[96:99], v[116:119]
    v_mfma_f32_16x16x32_bf16 v[120:123], v[216:219], a[96:99], v[120:123]
    v_mfma_f32_16x16x32_bf16 v[120:123], a[40:43], a[100:103], v[120:123]
    v_mfma_f32_16x16x32_bf16 v[124:127], a[44:47], a[100:103], v[124:127]
    s_xor_b32 s98, s53, 286720
    v_mfma_f32_16x16x32_bf16 v[124:127], v[220:223], a[96:99], v[124:127]
    s_waitcnt vmcnt(8)
    v_mfma_f32_16x16x32_bf16 v[128:131], v[208:211], a[104:107], v[128:131]
    buffer_load_dwordx4 a[96:99], v2, s[20:23], s98 offen offset:0 sc1
    v_mfma_f32_16x16x32_bf16 v[128:131], a[32:35], a[108:111], v[128:131]
    v_mfma_f32_16x16x32_bf16 v[132:135], a[36:39], a[108:111], v[132:135]
    buffer_load_dwordx4 a[100:103], v2, s[20:23], s98 offen offset:1024 sc1
    v_mfma_f32_16x16x32_bf16 v[132:135], v[212:215], a[104:107], v[132:135]
    v_mfma_f32_16x16x32_bf16 v[136:139], v[216:219], a[104:107], v[136:139]
    v_mfma_f32_16x16x32_bf16 v[136:139], a[40:43], a[108:111], v[136:139]
    v_mfma_f32_16x16x32_bf16 v[140:143], a[44:47], a[108:111], v[140:143]
    s_xor_b32 s99, s53, 417792
    v_mfma_f32_16x16x32_bf16 v[140:143], v[220:223], a[104:107], v[140:143]
    s_waitcnt vmcnt(8)
    v_mfma_f32_16x16x32_bf16 v[144:147], v[208:211], a[112:115], v[144:147]
    buffer_load_dwordx4 a[104:107], v2, s[20:23], s99 offen offset:0 sc1
    v_mfma_f32_16x16x32_bf16 v[144:147], a[32:35], a[116:119], v[144:147]
    v_mfma_f32_16x16x32_bf16 v[148:151], a[36:39], a[116:119], v[148:151]
    buffer_load_dwordx4 a[108:111], v2, s[20:23], s99 offen offset:1024 sc1
    v_mfma_f32_16x16x32_bf16 v[148:151], v[212:215], a[112:115], v[148:151]
    v_mfma_f32_16x16x32_bf16 v[152:155], v[216:219], a[112:115], v[152:155]
    v_mfma_f32_16x16x32_bf16 v[152:155], a[40:43], a[116:119], v[152:155]
    v_mfma_f32_16x16x32_bf16 v[156:159], a[44:47], a[116:119], v[156:159]
    s_xor_b32 s100, s51, 24576
    v_mfma_f32_16x16x32_bf16 v[156:159], v[220:223], a[112:115], v[156:159]
    s_waitcnt vmcnt(8)
    v_mfma_f32_16x16x32_bf16 v[160:163], v[208:211], a[120:123], v[160:163]
    buffer_load_dwordx4 a[112:115], v7, s[20:23], s100 offen offset:0 sc1
    v_mfma_f32_16x16x32_bf16 v[160:163], a[32:35], a[124:127], v[160:163]
    v_mfma_f32_16x16x32_bf16 v[164:167], a[36:39], a[124:127], v[164:167]
    buffer_load_dwordx4 a[116:119], v7, s[20:23], s100 offen offset:1024 sc1
    v_mfma_f32_16x16x32_bf16 v[164:167], v[212:215], a[120:123], v[164:167]
    v_mfma_f32_16x16x32_bf16 v[168:171], v[216:219], a[120:123], v[168:171]
    v_mfma_f32_16x16x32_bf16 v[168:171], a[40:43], a[124:127], v[168:171]
    v_mfma_f32_16x16x32_bf16 v[172:175], a[44:47], a[124:127], v[172:175]
    v_mfma_f32_16x16x32_bf16 v[172:175], v[220:223], a[120:123], v[172:175]
    s_waitcnt vmcnt(8)
    v_mfma_f32_16x16x32_bf16 v[96:99], a[48:51], a[80:83], v[96:99]
    buffer_load_dwordx4 a[120:123], v2, s[20:23], s96 offen offset:2048 sc1
    v_mfma_f32_16x16x32_bf16 v[96:99], a[208:211], a[84:87], v[96:99]
    v_mfma_f32_16x16x32_bf16 v[100:103], a[212:215], a[84:87], v[100:103]
    buffer_load_dwordx4 a[124:127], v2, s[20:23], s96 offen offset:3072 sc1
    v_mfma_f32_16x16x32_bf16 v[100:103], a[52:55], a[80:83], v[100:103]
    v_mfma_f32_16x16x32_bf16 v[104:107], a[56:59], a[80:83], v[104:107]
    v_mfma_f32_16x16x32_bf16 v[104:107], a[216:219], a[84:87], v[104:107]
    v_mfma_f32_16x16x32_bf16 v[108:111], a[220:223], a[84:87], v[108:111]
    v_mfma_f32_16x16x32_bf16 v[108:111], a[60:63], a[80:83], v[108:111]
    s_waitcnt vmcnt(8)
    v_mfma_f32_16x16x32_bf16 v[112:115], a[48:51], a[88:91], v[112:115]
    buffer_load_dwordx4 a[80:83], v2, s[20:23], s97 offen offset:2048 sc1
    v_mfma_f32_16x16x32_bf16 v[112:115], a[208:211], a[92:95], v[112:115]
    v_mfma_f32_16x16x32_bf16 v[116:119], a[212:215], a[92:95], v[116:119]
    buffer_load_dwordx4 a[84:87], v2, s[20:23], s97 offen offset:3072 sc1
    v_mfma_f32_16x16x32_bf16 v[116:119], a[52:55], a[88:91], v[116:119]
    v_mfma_f32_16x16x32_bf16 v[120:123], a[56:59], a[88:91], v[120:123]
    v_mfma_f32_16x16x32_bf16 v[120:123], a[216:219], a[92:95], v[120:123]
    v_mfma_f32_16x16x32_bf16 v[124:127], a[220:223], a[92:95], v[124:127]
    v_mfma_f32_16x16x32_bf16 v[124:127], a[60:63], a[88:91], v[124:127]
    s_waitcnt vmcnt(8)
    v_mfma_f32_16x16x32_bf16 v[128:131], a[48:51], a[96:99], v[128:131]
    buffer_load_dwordx4 a[88:91], v2, s[20:23], s98 offen offset:2048 sc1
    v_mfma_f32_16x16x32_bf16 v[128:131], a[208:211], a[100:103], v[128:131]
    v_mfma_f32_16x16x32_bf16 v[132:135], a[212:215], a[100:103], v[132:135]
    buffer_load_dwordx4 a[92:95], v2, s[20:23], s98 offen offset:3072 sc1
    v_mfma_f32_16x16x32_bf16 v[132:135], a[52:55], a[96:99], v[132:135]
    v_mfma_f32_16x16x32_bf16 v[136:139], a[56:59], a[96:99], v[136:139]
    v_mfma_f32_16x16x32_bf16 v[136:139], a[216:219], a[100:103], v[136:139]
    v_mfma_f32_16x16x32_bf16 v[140:143], a[220:223], a[100:103], v[140:143]
    v_mfma_f32_16x16x32_bf16 v[140:143], a[60:63], a[96:99], v[140:143]
    s_waitcnt vmcnt(8)
    v_mfma_f32_16x16x32_bf16 v[144:147], a[48:51], a[104:107], v[144:147]
    buffer_load_dwordx4 a[96:99], v2, s[20:23], s99 offen offset:2048 sc1
    v_mfma_f32_16x16x32_bf16 v[144:147], a[208:211], a[108:111], v[144:147]
    v_mfma_f32_16x16x32_bf16 v[148:151], a[212:215], a[108:111], v[148:151]
    buffer_load_dwordx4 a[100:103], v2, s[20:23], s99 offen offset:3072 sc1
    v_mfma_f32_16x16x32_bf16 v[148:151], a[52:55], a[104:107], v[148:151]
    v_mfma_f32_16x16x32_bf16 v[152:155], a[56:59], a[104:107], v[152:155]
    v_mfma_f32_16x16x32_bf16 v[152:155], a[216:219], a[108:111], v[152:155]
    v_mfma_f32_16x16x32_bf16 v[156:159], a[220:223], a[108:111], v[156:159]
    v_mfma_f32_16x16x32_bf16 v[156:159], a[60:63], a[104:107], v[156:159]
    s_waitcnt vmcnt(8)
    v_mfma_f32_16x16x32_bf16 v[160:163], a[48:51], a[112:115], v[160:163]
    buffer_load_dwordx4 a[104:107], v7, s[20:23], s100 offen offset:2048 sc1
    v_mfma_f32_16x16x32_bf16 v[160:163], a[208:211], a[116:119], v[160:163]
    v_mfma_f32_16x16x32_bf16 v[164:167], a[212:215], a[116:119], v[164:167]
    buffer_load_dwordx4 a[108:111], v7, s[20:23], s100 offen offset:3072 sc1
    v_mfma_f32_16x16x32_bf16 v[164:167], a[52:55], a[112:115], v[164:167]
    v_mfma_f32_16x16x32_bf16 v[168:171], a[56:59], a[112:115], v[168:171]
    v_mfma_f32_16x16x32_bf16 v[168:171], a[216:219], a[116:119], v[168:171]
    v_mfma_f32_16x16x32_bf16 v[172:175], a[220:223], a[116:119], v[172:175]
    s_xor_b32 s96, s53, 28672
    v_mfma_f32_16x16x32_bf16 v[172:175], a[60:63], a[112:115], v[172:175]
    s_waitcnt vmcnt(8)
    v_mfma_f32_16x16x32_bf16 v[96:99], a[224:227], a[120:123], v[96:99]
    buffer_load_dwordx4 a[112:115], v2, s[20:23], s96 offen offset:0 sc1
    v_mfma_f32_16x16x32_bf16 v[96:99], a[0:3], a[124:127], v[96:99]
    v_mfma_f32_16x16x32_bf16 v[100:103], a[4:7], a[124:127], v[100:103]
    buffer_load_dwordx4 a[116:119], v2, s[20:23], s96 offen offset:1024 sc1
    v_mfma_f32_16x16x32_bf16 v[100:103], a[228:231], a[120:123], v[100:103]
    v_mfma_f32_16x16x32_bf16 v[104:107], a[232:235], a[120:123], v[104:107]
    v_mfma_f32_16x16x32_bf16 v[104:107], a[8:11], a[124:127], v[104:107]
    v_mfma_f32_16x16x32_bf16 v[108:111], a[12:15], a[124:127], v[108:111]
    s_xor_b32 s97, s53, 159744
    v_mfma_f32_16x16x32_bf16 v[108:111], a[236:239], a[120:123], v[108:111]
    s_waitcnt vmcnt(8)
    v_mfma_f32_16x16x32_bf16 v[112:115], a[224:227], a[80:83], v[112:115]
    buffer_load_dwordx4 a[120:123], v2, s[20:23], s97 offen offset:0 sc1
    v_mfma_f32_16x16x32_bf16 v[112:115], a[0:3], a[84:87], v[112:115]
    v_mfma_f32_16x16x32_bf16 v[116:119], a[4:7], a[84:87], v[116:119]
    buffer_load_dwordx4 a[124:127], v2, s[20:23], s97 offen offset:1024 sc1
    v_mfma_f32_16x16x32_bf16 v[116:119], a[228:231], a[80:83], v[116:119]
    v_mfma_f32_16x16x32_bf16 v[120:123], a[232:235], a[80:83], v[120:123]
    v_mfma_f32_16x16x32_bf16 v[120:123], a[8:11], a[84:87], v[120:123]
    v_mfma_f32_16x16x32_bf16 v[124:127], a[12:15], a[84:87], v[124:127]
    s_xor_b32 s98, s53, 290816
    v_mfma_f32_16x16x32_bf16 v[124:127], a[236:239], a[80:83], v[124:127]
    s_waitcnt vmcnt(8)
    v_mfma_f32_16x16x32_bf16 v[128:131], a[224:227], a[88:91], v[128:131]
    buffer_load_dwordx4 a[80:83], v2, s[20:23], s98 offen offset:0 sc1
    v_mfma_f32_16x16x32_bf16 v[128:131], a[0:3], a[92:95], v[128:131]
    v_mfma_f32_16x16x32_bf16 v[132:135], a[4:7], a[92:95], v[132:135]
    buffer_load_dwordx4 a[84:87], v2, s[20:23], s98 offen offset:1024 sc1
    v_mfma_f32_16x16x32_bf16 v[132:135], a[228:231], a[88:91], v[132:135]
    v_mfma_f32_16x16x32_bf16 v[136:139], a[232:235], a[88:91], v[136:139]
    v_mfma_f32_16x16x32_bf16 v[136:139], a[8:11], a[92:95], v[136:139]
    v_add_u32 v3, s60, v2
    v_mfma_f32_16x16x32_bf16 v[140:143], a[12:15], a[92:95], v[140:143]
    s_xor_b32 s99, s53, 421888
    v_mfma_f32_16x16x32_bf16 v[140:143], a[236:239], a[88:91], v[140:143]
    s_waitcnt vmcnt(8)
    v_mfma_f32_16x16x32_bf16 v[144:147], a[224:227], a[96:99], v[144:147]
    s_xor_b32 s61, s40, 1
    buffer_load_dwordx4 a[88:91], v2, s[20:23], s99 offen offset:0 sc1
    v_mfma_f32_16x16x32_bf16 v[144:147], a[0:3], a[100:103], v[144:147]
    s_mul_i32 s61, s61, 4224
    v_mfma_f32_16x16x32_bf16 v[148:151], a[4:7], a[100:103], v[148:151]
    buffer_load_dwordx4 a[92:95], v2, s[20:23], s99 offen offset:1024 sc1
    v_add_u32 v11, s61, v2
    v_mfma_f32_16x16x32_bf16 v[148:151], a[228:231], a[96:99], v[148:151]
    s_xor_b32 s61, s40, 2
    v_mfma_f32_16x16x32_bf16 v[152:155], a[232:235], a[96:99], v[152:155]
    s_mul_i32 s61, s61, 4224
    v_mfma_f32_16x16x32_bf16 v[152:155], a[8:11], a[100:103], v[152:155]
    v_add_u32 v12, s61, v2
    v_mfma_f32_16x16x32_bf16 v[156:159], a[12:15], a[100:103], v[156:159]
    s_xor_b32 s100, s51, 28672
    v_mfma_f32_16x16x32_bf16 v[156:159], a[236:239], a[96:99], v[156:159]
    s_waitcnt vmcnt(8)
    v_mfma_f32_16x16x32_bf16 v[160:163], a[224:227], a[104:107], v[160:163]
    s_xor_b32 s61, s40, 3
    buffer_load_dwordx4 a[96:99], v7, s[20:23], s100 offen offset:0 sc1
    v_mfma_f32_16x16x32_bf16 v[160:163], a[0:3], a[108:111], v[160:163]
    s_mul_i32 s61, s61, 4224
    v_mfma_f32_16x16x32_bf16 v[164:167], a[4:7], a[108:111], v[164:167]
    buffer_load_dwordx4 a[100:103], v7, s[20:23], s100 offen offset:1024 sc1
    v_add_u32 v13, s61, v2
    v_mfma_f32_16x16x32_bf16 v[164:167], a[228:231], a[104:107], v[164:167]
    v_mfma_f32_16x16x32_bf16 v[168:171], a[232:235], a[104:107], v[168:171]
    v_mfma_f32_16x16x32_bf16 v[168:171], a[8:11], a[108:111], v[168:171]
    v_mfma_f32_16x16x32_bf16 v[172:175], a[12:15], a[108:111], v[172:175]
    v_mfma_f32_16x16x32_bf16 v[172:175], a[236:239], a[104:107], v[172:175]
    s_waitcnt vmcnt(8)
    v_mfma_f32_16x16x32_bf16 v[96:99], a[64:67], a[112:115], v[96:99]
    buffer_load_dwordx4 a[104:107], v2, s[20:23], s96 offen offset:2048 sc1
    s_branch L_pg13
    .p2align 12
L_stub13:
    s_branch L_warm_ret
L_pg13:
    v_mfma_f32_16x16x32_bf16 v[96:99], a[16:19], a[116:119], v[96:99]
    v_mfma_f32_16x16x32_bf16 v[100:103], a[20:23], a[116:119], v[100:103]
    buffer_load_dwordx4 a[108:111], v2, s[20:23], s96 offen offset:3072 sc1
    v_mfma_f32_16x16x32_bf16 v[100:103], a[68:71], a[112:115], v[100:103]
    v_mfma_f32_16x16x32_bf16 v[104:107], a[72:75], a[112:115], v[104:107]
    v_mfma_f32_16x16x32_bf16 v[104:107], a[24:27], a[116:119], v[104:107]
    v_mfma_f32_16x16x32_bf16 v[108:111], a[28:31], a[116:119], v[108:111]
    v_mfma_f32_16x16x32_bf16 v[108:111], a[76:79], a[112:115], v[108:111]
    s_waitcnt vmcnt(8)
    v_mfma_f32_16x16x32_bf16 v[112:115], a[64:67], a[120:123], v[112:115]
    buffer_load_dwordx4 a[112:115], v2, s[20:23], s97 offen offset:2048 sc1
    v_mfma_f32_16x16x32_bf16 v[112:115], a[16:19], a[124:127], v[112:115]
    v_mfma_f32_16x16x32_bf16 v[116:119], a[20:23], a[124:127], v[116:119]
    buffer_load_dwordx4 a[116:119], v2, s[20:23], s97 offen offset:3072 sc1
    v_mfma_f32_16x16x32_bf16 v[116:119], a[68:71], a[120:123], v[116:119]
    v_mfma_f32_16x16x32_bf16 v[120:123], a[72:75], a[120:123], v[120:123]
    v_mfma_f32_16x16x32_bf16 v[120:123], a[24:27], a[124:127], v[120:123]
    v_mfma_f32_16x16x32_bf16 v[124:127], a[28:31], a[124:127], v[124:127]
    v_mfma_f32_16x16x32_bf16 v[124:127], a[76:79], a[120:123], v[124:127]
    s_waitcnt vmcnt(8)
    v_mfma_f32_16x16x32_bf16 v[128:131], a[64:67], a[80:83], v[128:131]
    buffer_load_dwordx4 a[120:123], v2, s[20:23], s98 offen offset:2048 sc1
    v_mfma_f32_16x16x32_bf16 v[128:131], a[16:19], a[84:87], v[128:131]
    v_mfma_f32_16x16x32_bf16 v[132:135], a[20:23], a[84:87], v[132:135]
    buffer_load_dwordx4 a[124:127], v2, s[20:23], s98 offen offset:3072 sc1
    v_mfma_f32_16x16x32_bf16 v[132:135], a[68:71], a[80:83], v[132:135]
    v_mfma_f32_16x16x32_bf16 v[136:139], a[72:75], a[80:83], v[136:139]
    v_mfma_f32_16x16x32_bf16 v[136:139], a[24:27], a[84:87], v[136:139]
    v_mfma_f32_16x16x32_bf16 v[140:143], a[28:31], a[84:87], v[140:143]
    v_mfma_f32_16x16x32_bf16 v[140:143], a[76:79], a[80:83], v[140:143]
    s_waitcnt vmcnt(8)
    v_mfma_f32_16x16x32_bf16 v[144:147], a[64:67], a[88:91], v[144:147]
    buffer_load_dwordx4 a[80:83], v2, s[20:23], s99 offen offset:2048 sc1
    v_mfma_f32_16x16x32_bf16 v[144:147], a[16:19], a[92:95], v[144:147]
    v_mfma_f32_16x16x32_bf16 v[148:151], a[20:23], a[92:95], v[148:151]
    buffer_load_dwordx4 a[84:87], v2, s[20:23], s99 offen offset:3072 sc1
    v_mfma_f32_16x16x32_bf16 v[148:151], a[68:71], a[88:91], v[148:151]
    v_mfma_f32_16x16x32_bf16 v[152:155], a[72:75], a[88:91], v[152:155]
    v_mfma_f32_16x16x32_bf16 v[152:155], a[24:27], a[92:95], v[152:155]
    v_mfma_f32_16x16x32_bf16 v[156:159], a[28:31], a[92:95], v[156:159]
    v_mfma_f32_16x16x32_bf16 v[156:159], a[76:79], a[88:91], v[156:159]
    s_waitcnt vmcnt(8)
    v_mfma_f32_16x16x32_bf16 v[160:163], a[64:67], a[96:99], v[160:163]
    buffer_load_dwordx4 a[88:91], v7, s[20:23], s100 offen offset:2048 sc1
    v_mfma_f32_16x16x32_bf16 v[160:163], a[16:19], a[100:103], v[160:163]
    v_mfma_f32_16x16x32_bf16 v[164:167], a[20:23], a[100:103], v[164:167]
    buffer_load_dwordx4 a[92:95], v7, s[20:23], s100 offen offset:3072 sc1
    v_mfma_f32_16x16x32_bf16 v[164:167], a[68:71], a[96:99], v[164:167]
    v_mfma_f32_16x16x32_bf16 v[168:171], a[72:75], a[96:99], v[168:171]
    v_mfma_f32_16x16x32_bf16 v[168:171], a[24:27], a[100:103], v[168:171]
    v_mfma_f32_16x16x32_bf16 v[172:175], a[28:31], a[100:103], v[172:175]
    v_mfma_f32_16x16x32_bf16 v[172:175], a[76:79], a[96:99], v[172:175]
    s_waitcnt vmcnt(8)
    v_mfma_f32_16x16x32_bf16 v[100:103], a[180:183], a[108:111], v[100:103]
    v_mfma_f32_16x16x32_bf16 v[100:103], a[164:167], a[104:107], v[100:103]
    v_mfma_f32_16x16x32_bf16 v[104:107], a[168:171], a[104:107], v[104:107]
    v_mfma_f32_16x16x32_bf16 v[104:107], a[184:187], a[108:111], v[104:107]
    v_mfma_f32_16x16x32_bf16 v[108:111], a[188:191], a[108:111], v[108:111]
    v_mfma_f32_16x16x32_bf16 v[108:111], a[172:175], a[104:107], v[108:111]
    s_waitcnt vmcnt(6)
    v_mfma_f32_16x16x32_bf16 v[116:119], a[180:183], a[116:119], v[116:119]
    v_mfma_f32_16x16x32_bf16 v[116:119], a[164:167], a[112:115], v[116:119]
    v_mfma_f32_16x16x32_bf16 v[120:123], a[168:171], a[112:115], v[120:123]
    v_mfma_f32_16x16x32_bf16 v[120:123], a[184:187], a[116:119], v[120:123]
    ds_write_b128 v3, v[100:103] offset:0
    v_mfma_f32_16x16x32_bf16 v[124:127], a[188:191], a[116:119], v[124:127]
    v_mfma_f32_16x16x32_bf16 v[124:127], a[172:175], a[112:115], v[124:127]
    s_waitcnt vmcnt(4)
    ds_write_b128 v3, v[104:107] offset:17920
    v_mfma_f32_16x16x32_bf16 v[132:135], a[180:183], a[124:127], v[132:135]
    v_mfma_f32_16x16x32_bf16 v[132:135], a[164:167], a[120:123], v[132:135]
    ds_write_b128 v3, v[108:111] offset:35840
    v_mfma_f32_16x16x32_bf16 v[136:139], a[168:171], a[120:123], v[136:139]
    v_mfma_f32_16x16x32_bf16 v[136:139], a[184:187], a[124:127], v[136:139]
    ds_write_b128 v3, v[116:119] offset:1024
    v_mfma_f32_16x16x32_bf16 v[140:143], a[188:191], a[124:127], v[140:143]
    v_mfma_f32_16x16x32_bf16 v[140:143], a[172:175], a[120:123], v[140:143]
    s_waitcnt vmcnt(2)
    ds_write_b128 v3, v[120:123] offset:18944
    v_mfma_f32_16x16x32_bf16 v[148:151], a[180:183], a[84:87], v[148:151]
    v_mfma_f32_16x16x32_bf16 v[148:151], a[164:167], a[80:83], v[148:151]
    ds_write_b128 v3, v[124:127] offset:36864
    v_mfma_f32_16x16x32_bf16 v[152:155], a[168:171], a[80:83], v[152:155]
    v_mfma_f32_16x16x32_bf16 v[152:155], a[184:187], a[84:87], v[152:155]
    ds_write_b128 v3, v[132:135] offset:2048
    v_mfma_f32_16x16x32_bf16 v[156:159], a[188:191], a[84:87], v[156:159]
    v_mfma_f32_16x16x32_bf16 v[156:159], a[172:175], a[80:83], v[156:159]
    s_waitcnt vmcnt(0)
    ds_write_b128 v3, v[136:139] offset:19968
    v_mfma_f32_16x16x32_bf16 v[164:167], a[180:183], a[92:95], v[164:167]
    v_mfma_f32_16x16x32_bf16 v[164:167], a[164:167], a[88:91], v[164:167]
    ds_write_b128 v3, v[140:143] offset:50688
    v_mfma_f32_16x16x32_bf16 v[168:171], a[168:171], a[88:91], v[168:171]
    v_mfma_f32_16x16x32_bf16 v[168:171], a[184:187], a[92:95], v[168:171]
    ds_write_b128 v3, v[148:151] offset:3072
    v_mfma_f32_16x16x32_bf16 v[172:175], a[188:191], a[92:95], v[172:175]
    v_mfma_f32_16x16x32_bf16 v[172:175], a[172:175], a[88:91], v[172:175]
    ds_write_b128 v3, v[152:155] offset:33792
    v_mfma_f32_16x16x32_bf16 v[96:99], a[160:163], a[104:107], v[96:99]
    v_mfma_f32_16x16x32_bf16 v[96:99], a[176:179], a[108:111], v[96:99]
    ds_write_b128 v3, v[156:159] offset:51712
    v_mfma_f32_16x16x32_bf16 v[112:115], a[160:163], a[112:115], v[112:115]
    v_mfma_f32_16x16x32_bf16 v[112:115], a[176:179], a[116:119], v[112:115]
    ds_write_b128 v3, v[164:167] offset:16896
    v_mfma_f32_16x16x32_bf16 v[128:131], a[160:163], a[120:123], v[128:131]
    v_mfma_f32_16x16x32_bf16 v[128:131], a[176:179], a[124:127], v[128:131]
    ds_write_b128 v3, v[168:171] offset:34816
    v_mfma_f32_16x16x32_bf16 v[144:147], a[160:163], a[80:83], v[144:147]
    v_mfma_f32_16x16x32_bf16 v[144:147], a[176:179], a[84:87], v[144:147]
    ds_write_b128 v3, v[172:175] offset:52736
    v_mfma_f32_16x16x32_bf16 v[160:163], a[160:163], a[88:91], v[160:163]
    v_mfma_f32_16x16x32_bf16 v[160:163], a[176:179], a[92:95], v[160:163]
    s_waitcnt lgkmcnt(0)
    s_barrier
    ds_read_b128 v[100:103], v11 offset:0
    ds_read_b128 v[104:107], v12 offset:17920
    ds_read_b128 v[108:111], v13 offset:35840
    ds_read_b128 v[116:119], v11 offset:1024
    ds_read_b128 v[120:123], v12 offset:18944
    ds_read_b128 v[124:127], v13 offset:36864
    ds_read_b128 v[132:135], v11 offset:2048
    ds_read_b128 v[136:139], v12 offset:19968
    ds_read_b128 v[140:143], v13 offset:50688
    ds_read_b128 v[148:151], v11 offset:3072
    ds_read_b128 v[152:155], v12 offset:33792
    ds_read_b128 v[156:159], v13 offset:51712
    ds_read_b128 v[164:167], v11 offset:16896
    ds_read_b128 v[168:171], v12 offset:34816
    ds_read_b128 v[172:175], v13 offset:52736
    s_lshl_b32 s76, s76, 14
    s_waitcnt lgkmcnt(12)
    v_add_f32 v104, v104, v108
    v_add_f32 v105, v105, v109
    v_add_f32 v106, v106, v110
    v_add_f32 v107, v107, v111
    v_add_f32 v100, v100, v104
    v_add_f32 v101, v101, v105
    v_add_f32 v102, v102, v106
    v_add_f32 v103, v103, v107
    v_add_f32 v96, v96, v100
    v_add_f32 v97, v97, v101
    v_add_f32 v98, v98, v102
    v_add_f32 v99, v99, v103
    v_cvt_pk_bf16_f32 v96, v96, v97
    v_cvt_pk_bf16_f32 v97, v98, v99
    s_mov_b32 s61, 0
    buffer_store_dwordx2 v[96:97], v14, s[24:27], s61 offen
    s_waitcnt lgkmcnt(9)
    v_add_f32 v120, v120, v124
    v_add_f32 v121, v121, v125
    v_add_f32 v122, v122, v126
    v_add_f32 v123, v123, v127
    v_add_f32 v116, v116, v120
    v_add_f32 v117, v117, v121
    v_add_f32 v118, v118, v122
    v_add_f32 v119, v119, v123
    v_add_f32 v112, v112, v116
    v_add_f32 v113, v113, v117
    v_add_f32 v114, v114, v118
    v_add_f32 v115, v115, v119
    v_cvt_pk_bf16_f32 v112, v112, v113
    v_cvt_pk_bf16_f32 v113, v114, v115
    s_mov_b32 s61, 16384
    buffer_store_dwordx2 v[112:113], v14, s[24:27], s61 offen
    s_waitcnt lgkmcnt(6)
    v_add_f32 v136, v136, v140
    v_add_f32 v137, v137, v141
    v_add_f32 v138, v138, v142
    v_add_f32 v139, v139, v143
    v_add_f32 v132, v132, v136
    v_add_f32 v133, v133, v137
    v_add_f32 v134, v134, v138
    v_add_f32 v135, v135, v139
    v_add_f32 v128, v128, v132
    v_add_f32 v129, v129, v133
    v_add_f32 v130, v130, v134
    v_add_f32 v131, v131, v135
    v_cvt_pk_bf16_f32 v128, v128, v129
    v_cvt_pk_bf16_f32 v129, v130, v131
    s_mov_b32 s61, 32768
    buffer_store_dwordx2 v[128:129], v14, s[24:27], s61 offen
    s_waitcnt lgkmcnt(3)
    v_add_f32 v152, v152, v156
    v_add_f32 v153, v153, v157
    v_add_f32 v154, v154, v158
    v_add_f32 v155, v155, v159
    v_add_f32 v148, v148, v152
    v_add_f32 v149, v149, v153
    v_add_f32 v150, v150, v154
    v_add_f32 v151, v151, v155
    v_add_f32 v144, v144, v148
    v_add_f32 v145, v145, v149
    v_add_f32 v146, v146, v150
    v_add_f32 v147, v147, v151
    v_cvt_pk_bf16_f32 v144, v144, v145
    v_cvt_pk_bf16_f32 v145, v146, v147
    s_mov_b32 s61, 49152
    buffer_store_dwordx2 v[144:145], v14, s[24:27], s61 offen
    s_waitcnt lgkmcnt(0)
    v_add_f32 v168, v168, v172
    v_add_f32 v169, v169, v173
    v_add_f32 v170, v170, v174
    v_add_f32 v171, v171, v175
    v_add_f32 v164, v164, v168
    v_add_f32 v165, v165, v169
    v_add_f32 v166, v166, v170
    v_add_f32 v167, v167, v171
    v_add_f32 v160, v160, v164
    v_add_f32 v161, v161, v165
    v_add_f32 v162, v162, v166
    v_add_f32 v163, v163, v167
    v_cvt_pk_bf16_f32 v160, v160, v161
    v_cvt_pk_bf16_f32 v161, v162, v163
    buffer_store_dwordx2 v[160:161], v15, s[24:27], s76 offen
L_k1_end:
    s_endpgm
    .p2align 8
L_restart:
    s_waitcnt vmcnt(0) lgkmcnt(0)
    s_barrier
    s_mov_b32 s101, 1
    s_branch L_again
L_slow:
    s_waitcnt vmcnt(0) lgkmcnt(0)
    s_mov_b32 s63, 0
    v_mov_b32 v96, 0xff800000
    v_mov_b32 v97, 0xff800000
    v_mov_b32 v98, 0xff800000
    v_mov_b32 v99, 0xff800000
    v_mov_b32 v100, 0xff800000
L_maxloop:
    s_barrier
    s_add_u32 m0, s60, 0
    s_nop 0
    buffer_load_dwordx4 v88, s[28:31], s63 offen offset:0 nt lds
    s_add_u32 m0, s60, 32
    s_nop 0
    buffer_load_dwordx4 v88, s[28:31], s63 offen offset:1024 nt lds
    s_add_u32 m0, s60, 64
    s_nop 0
    buffer_load_dwordx4 v88, s[28:31], s63 offen offset:2048 nt lds
    s_add_u32 m0, s60, 96
    s_nop 0
    buffer_load_dwordx4 v88, s[28:31], s63 offen offset:3072 nt lds
    s_waitcnt vmcnt(0)
    s_barrier
    ds_read_b128 a[80:83], v10 offset:0
    ds_read_b128 a[84:87], v10 offset:64
    ds_read_b128 a[88:91], v10 offset:128
    ds_read_b128 a[92:95], v10 offset:192
    ds_read_b128 a[96:99], v10 offset:256
    ds_read_b128 a[100:103], v10 offset:320
    ds_read_b128 a[104:107], v10 offset:384
    ds_read_b128 a[108:111], v10 offset:448
    ds_read_b128 a[144:147], v11 offset:0
    ds_read_b128 a[148:151], v11 offset:64
    ds_read_b128 a[152:155], v11 offset:128
    ds_read_b128 a[156:159], v11 offset:192
    ds_read_b128 a[160:163], v11 offset:256
    ds_read_b128 a[164:167], v11 offset:320
    ds_read_b128 a[168:171], v11 offset:384
    ds_read_b128 a[172:175], v11 offset:448
    s_waitcnt lgkmcnt(0)
    v_mfma_f32_16x16x32_bf16 v[64:67], a[80:83], a[0:3], 0
    v_mfma_f32_16x16x32_bf16 v[64:67], a[84:87], a[4:7], v[64:67]
    v_mfma_f32_16x16x32_bf16 v[64:67], a[88:91], a[8:11], v[64:67]
    v_mfma_f32_16x16x32_bf16 v[64:67], a[92:95], a[12:15], v[64:67]
    v_mfma_f32_16x16x32_bf16 v[68:71], a[108:111], a[12:15], 0
    v_mfma_f32_16x16x32_bf16 v[68:71], a[104:107], a[8:11], v[68:71]
    v_mfma_f32_16x16x32_bf16 v[68:71], a[100:103], a[4:7], v[68:71]
    v_mfma_f32_16x16x32_bf16 v[68:71], a[96:99], a[0:3], v[68:71]
    s_nop 7
    v_max3_f32 v96, v96, v64, v65
    v_max3_f32 v96, v96, v66, v67
    v_max3_f32 v96, v96, v68, v69
    v_max3_f32 v96, v96, v70, v71
    v_mfma_f32_16x16x32_bf16 v[72:75], a[144:147], a[0:3], 0
    v_mfma_f32_16x16x32_bf16 v[72:75], a[148:151], a[4:7], v[72:75]
    v_mfma_f32_16x16x32_bf16 v[72:75], a[152:155], a[8:11], v[72:75]
    v_mfma_f32_16x16x32_bf16 v[72:75], a[156:159], a[12:15], v[72:75]
    v_mfma_f32_16x16x32_bf16 v[76:79], a[172:175], a[12:15], 0
    v_mfma_f32_16x16x32_bf16 v[76:79], a[168:171], a[8:11], v[76:79]
    v_mfma_f32_16x16x32_bf16 v[76:79], a[164:167], a[4:7], v[76:79]
    v_mfma_f32_16x16x32_bf16 v[76:79], a[160:163], a[0:3], v[76:79]
    s_nop 7
    v_max3_f32 v96, v96, v72, v73
    v_max3_f32 v96, v96, v74, v75
    v_max3_f32 v96, v96, v76, v77
    v_max3_f32 v96, v96, v78, v79
    v_mfma_f32_16x16x32_bf16 v[80:83], a[80:83], a[16:19], 0
    v_mfma_f32_16x16x32_bf16 v[80:83], a[84:87], a[20:23], v[80:83]
    v_mfma_f32_16x16x32_bf16 v[80:83], a[88:91], a[24:27], v[80:83]
    v_mfma_f32_16x16x32_bf16 v[80:83], a[92:95], a[28:31], v[80:83]
    v_mfma_f32_16x16x32_bf16 v[84:87], a[108:111], a[28:31], 0
    v_mfma_f32_16x16x32_bf16 v[84:87], a[104:107], a[24:27], v[84:87]
    v_mfma_f32_16x16x32_bf16 v[84:87], a[100:103], a[20:23], v[84:87]
    v_mfma_f32_16x16x32_bf16 v[84:87], a[96:99], a[16:19], v[84:87]
    s_nop 7
    v_max3_f32 v97, v97, v80, v81
    v_max3_f32 v97, v97, v82, v83
    v_max3_f32 v97, v97, v84, v85
    v_max3_f32 v97, v97, v86, v87
    v_mfma_f32_16x16x32_bf16 v[64:67], a[144:147], a[16:19], 0
    v_mfma_f32_16x16x32_bf16 v[64:67], a[148:151], a[20:23], v[64:67]
    v_mfma_f32_16x16x32_bf16 v[64:67], a[152:155], a[24:27], v[64:67]
    v_mfma_f32_16x16x32_bf16 v[64:67], a[156:159], a[28:31], v[64:67]
    v_mfma_f32_16x16x32_bf16 v[68:71], a[172:175], a[28:31], 0
    v_mfma_f32_16x16x32_bf16 v[68:71], a[168:171], a[24:27], v[68:71]
    v_mfma_f32_16x16x32_bf16 v[68:71], a[164:167], a[20:23], v[68:71]
    v_mfma_f32_16x16x32_bf16 v[68:71], a[160:163], a[16:19], v[68:71]
    s_nop 7
    v_max3_f32 v97, v97, v64, v65
    v_max3_f32 v97, v97, v66, v67
    v_max3_f32 v97, v97, v68, v69
    v_max3_f32 v97, v97, v70, v71
    v_mfma_f32_16x16x32_bf16 v[72:75], a[80:83], v[20:23], 0
    v_mfma_f32_16x16x32_bf16 v[72:75], a[84:87], v[24:27], v[72:75]
    v_mfma_f32_16x16x32_bf16 v[72:75], a[88:91], v[28:31], v[72:75]
    v_mfma_f32_16x16x32_bf16 v[72:75], a[92:95], v[32:35], v[72:75]
    v_mfma_f32_16x16x32_bf16 v[76:79], a[108:111], v[32:35], 0
    v_mfma_f32_16x16x32_bf16 v[76:79], a[104:107], v[28:31], v[76:79]
    v_mfma_f32_16x16x32_bf16 v[76:79], a[100:103], v[24:27], v[76:79]
    v_mfma_f32_16x16x32_bf16 v[76:79], a[96:99], v[20:23], v[76:79]
    s_nop 7
    v_max3_f32 v98, v98, v72, v73
    v_max3_f32 v98, v98, v74, v75
    v_max3_f32 v98, v98, v76, v77
    v_max3_f32 v98, v98, v78, v79
    v_mfma_f32_16x16x32_bf16 v[80:83], a[144:147], v[20:23], 0
    v_mfma_f32_16x16x32_bf16 v[80:83], a[148:151], v[24:27], v[80:83]
    v_mfma_f32_16x16x32_bf16 v[80:83], a[152:155], v[28:31], v[80:83]
    v_mfma_f32_16x16x32_bf16 v[80:83], a[156:159], v[32:35], v[80:83]
    v_mfma_f32_16x16x32_bf16 v[84:87], a[172:175], v[32:35], 0
    v_mfma_f32_16x16x32_bf16 v[84:87], a[168:171], v[28:31], v[84:87]
    v_mfma_f32_16x16x32_bf16 v[84:87], a[164:167], v[24:27], v[84:87]
    v_mfma_f32_16x16x32_bf16 v[84:87], a[160:163], v[20:23], v[84:87]
    s_nop 7
    v_max3_f32 v98, v98, v80, v81
    v_max3_f32 v98, v98, v82, v83
    v_max3_f32 v98, v98, v84, v85
    v_max3_f32 v98, v98, v86, v87
    v_mfma_f32_16x16x32_bf16 v[64:67], a[80:83], v[36:39], 0
    v_mfma_f32_16x16x32_bf16 v[64:67], a[84:87], v[40:43], v[64:67]
    v_mfma_f32_16x16x32_bf16 v[64:67], a[88:91], v[44:47], v[64:67]
    v_mfma_f32_16x16x32_bf16 v[64:67], a[92:95], v[48:51], v[64:67]
    v_mfma_f32_16x16x32_bf16 v[68:71], a[108:111], v[48:51], 0
    v_mfma_f32_16x16x32_bf16 v[68:71], a[104:107], v[44:47], v[68:71]
    v_mfma_f32_16x16x32_bf16 v[68:71], a[100:103], v[40:43], v[68:71]
    v_mfma_f32_16x16x32_bf16 v[68:71], a[96:99], v[36:39], v[68:71]
    s_nop 7
    v_max3_f32 v99, v99, v64, v65
    v_max3_f32 v99, v99, v66, v67
    v_max3_f32 v99, v99, v68, v69
    v_max3_f32 v99, v99, v70, v71
    v_mfma_f32_16x16x32_bf16 v[72:75], a[144:147], v[36:39], 0
    v_mfma_f32_16x16x32_bf16 v[72:75], a[148:151], v[40:43], v[72:75]
    v_mfma_f32_16x16x32_bf16 v[72:75], a[152:155], v[44:47], v[72:75]
    v_mfma_f32_16x16x32_bf16 v[72:75], a[156:159], v[48:51], v[72:75]
    v_mfma_f32_16x16x32_bf16 v[76:79], a[172:175], v[48:51], 0
    v_mfma_f32_16x16x32_bf16 v[76:79], a[168:171], v[44:47], v[76:79]
    v_mfma_f32_16x16x32_bf16 v[76:79], a[164:167], v[40:43], v[76:79]
    v_mfma_f32_16x16x32_bf16 v[76:79], a[160:163], v[36:39], v[76:79]
    s_nop 7
    v_max3_f32 v99, v99, v72, v73
    v_max3_f32 v99, v99, v74, v75
    v_max3_f32 v99, v99, v76, v77
    v_max3_f32 v99, v99, v78, v79
    v_mfma_f32_16x16x32_bf16 v[80:83], a[80:83], a[64:67], 0
    v_mfma_f32_16x16x32_bf16 v[80:83], a[84:87], a[68:71], v[80:83]
    v_mfma_f32_16x16x32_bf16 v[80:83], a[88:91], a[72:75], v[80:83]
    v_mfma_f32_16x16x32_bf16 v[80:83], a[92:95], a[76:79], v[80:83]
    v_mfma_f32_16x16x32_bf16 v[84:87], a[108:111], a[76:79], 0
    v_mfma_f32_16x16x32_bf16 v[84:87], a[104:107], a[72:75], v[84:87]
    v_mfma_f32_16x16x32_bf16 v[84:87], a[100:103], a[68:71], v[84:87]
    v_mfma_f32_16x16x32_bf16 v[84:87], a[96:99], a[64:67], v[84:87]
    s_nop 7
    v_max3_f32 v100, v100, v80, v81
    v_max3_f32 v100, v100, v82, v83
    v_max3_f32 v100, v100, v84, v85
    v_max3_f32 v100, v100, v86, v87
    s_add_u32 s63, s63, 16384
    s_cmp_lt_u32 s63, 0x40000
    s_cbranch_scc1 L_maxloop
    v_mov_b32 v64, v96
    v_mov_b32 v65, v97
    v_mov_b32 v66, v98
    v_mov_b32 v67, v99
    v_mov_b32 v68, v100
    s_nop 1
    v_permlane32_swap_b32 v64, v96
    v_permlane32_swap_b32 v65, v97
    v_permlane32_swap_b32 v66, v98
    v_permlane32_swap_b32 v67, v99
    v_permlane32_swap_b32 v68, v100
    v_max_f32 v96, v96, v64
    v_max_f32 v97, v97, v65
    v_max_f32 v98, v98, v66
    v_max_f32 v99, v99, v67
    v_max_f32 v100, v100, v68
    v_mov_b32 v64, v96
    v_mov_b32 v65, v97
    v_mov_b32 v66, v98
    v_mov_b32 v67, v99
    v_mov_b32 v68, v100
    s_nop 1
    v_permlane16_swap_b32 v64, v96
    v_permlane16_swap_b32 v65, v97
    v_permlane16_swap_b32 v66, v98
    v_permlane16_swap_b32 v67, v99
    v_permlane16_swap_b32 v68, v100
    v_max_f32 v96, v96, v64
    v_max_f32 v97, v97, v65
    v_max_f32 v98, v98, v66
    v_max_f32 v99, v99, v67
    v_max_f32 v100, v100, v68
    ds_write_b32 v6, v100
    s_waitcnt lgkmcnt(0)
    s_barrier
    ds_read_b32 v64, v7
    s_waitcnt lgkmcnt(0)
    v_max_f32 v9, v100, v64
    v_accvgpr_write_b32 a252, v96
    v_accvgpr_write_b32 a253, v97
    v_accvgpr_write_b32 a254, v98
    v_accvgpr_write_b32 a255, v99
    s_add_u32 s63, s71, 0
    s_and_b32 s63, s63, 0x3ffff
    s_add_u32 m0, s60, 0
    s_nop 0
    buffer_load_dwordx4 v88, s[28:31], s63 offen offset:0 nt lds
    s_add_u32 m0, s60, 32
    s_nop 0
    buffer_load_dwordx4 v88, s[28:31], s63 offen offset:1024 nt lds
    s_add_u32 m0, s60, 64
    s_nop 0
    buffer_load_dwordx4 v88, s[28:31], s63 offen offset:2048 nt lds
    s_add_u32 m0, s60, 96
    s_nop 0
    buffer_load_dwordx4 v88, s[28:31], s63 offen offset:3072 nt lds
    s_add_u32 s63, s71, 0
    s_and_b32 s63, s63, 0x3ffff
    s_add_u32 m0, s60, 16896
    s_nop 0
    buffer_load_dwordx4 v88, s[32:35], s63 offen offset:0 nt lds
    s_add_u32 m0, s60, 16928
    s_nop 0
    buffer_load_dwordx4 v88, s[32:35], s63 offen offset:1024 nt lds
    s_add_u32 m0, s60, 16960
    s_nop 0
    buffer_load_dwordx4 v88, s[32:35], s63 offen offset:2048 nt lds
    s_add_u32 m0, s60, 16992
    s_nop 0
    buffer_load_dwordx4 v88, s[32:35], s63 offen offset:3072 nt lds
    s_add_u32 s63, s71, 16384
    s_and_b32 s63, s63, 0x3ffff
    s_add_u32 m0, s60, 33792
    s_nop 0
    buffer_load_dwordx4 v88, s[28:31], s63 offen offset:0 nt lds
    s_add_u32 m0, s60, 33824
    s_nop 0
    buffer_load_dwordx4 v88, s[28:31], s63 offen offset:1024 nt lds
    s_add_u32 m0, s60, 33856
    s_nop 0
    buffer_load_dwordx4 v88, s[28:31], s63 offen offset:2048 nt lds
    s_add_u32 m0, s60, 33888
    s_nop 0
    buffer_load_dwordx4 v88, s[28:31], s63 offen offset:3072 nt lds
    s_add_u32 s63, s71, 16384
    s_and_b32 s63, s63, 0x3ffff
    s_add_u32 m0, s60, 50688
    s_nop 0
    buffer_load_dwordx4 v88, s[32:35], s63 offen offset:0 nt lds
    s_add_u32 m0, s60, 50720
    s_nop 0
    buffer_load_dwordx4 v88, s[32:35], s63 offen offset:1024 nt lds
    s_add_u32 m0, s60, 50752
    s_nop 0
    buffer_load_dwordx4 v88, s[32:35], s63 offen offset:2048 nt lds
    s_add_u32 m0, s60, 50784
    s_nop 0
    buffer_load_dwordx4 v88, s[32:35], s63 offen offset:3072 nt lds
    s_waitcnt vmcnt(0)
    s_barrier
    ds_read_b128 a[80:83], v10 offset:0
    ds_read_b128 a[84:87], v10 offset:64
    ds_read_b128 a[88:91], v10 offset:128
    ds_read_b128 a[92:95], v10 offset:192
    ds_read_b128 a[96:99], v10 offset:256
    ds_read_b128 a[100:103], v10 offset:320
    ds_read_b128 a[104:107], v10 offset:384
    ds_read_b128 a[108:111], v10 offset:448
    ds_read_b128 a[144:147], v11 offset:0
    ds_read_b128 a[148:151], v11 offset:64
    ds_read_b128 a[152:155], v11 offset:128
    ds_read_b128 a[156:159], v11 offset:192
    ds_read_b128 a[160:163], v11 offset:256
    ds_read_b128 a[164:167], v11 offset:320
    ds_read_b128 a[168:171], v11 offset:384
    ds_read_b128 a[172:175], v11 offset:448
    s_waitcnt lgkmcnt(0)
    v_mfma_f32_16x16x32_bf16 v[64:67], a[80:83], a[0:3], 0
    v_mfma_f32_16x16x32_bf16 v[64:67], a[84:87], a[4:7], v[64:67]
    v_mfma_f32_16x16x32_bf16 v[64:67], a[88:91], a[8:11], v[64:67]
    v_mfma_f32_16x16x32_bf16 v[64:67], a[92:95], a[12:15], v[64:67]
    v_mfma_f32_16x16x32_bf16 v[68:71], a[108:111], a[12:15], 0
    v_mfma_f32_16x16x32_bf16 v[68:71], a[104:107], a[8:11], v[68:71]
    v_mfma_f32_16x16x32_bf16 v[68:71], a[100:103], a[4:7], v[68:71]
    v_mfma_f32_16x16x32_bf16 v[68:71], a[96:99], a[0:3], v[68:71]
    s_nop 7
    v_mfma_f32_16x16x32_bf16 v[72:75], a[144:147], a[0:3], 0
    s_cmp_eq_u32 s47, 67584
    v_accvgpr_read_b32 v92, a252
    v_sub_f32 v64, v64, v92
    v_exp_f32 v64, v64
    v_mfma_f32_16x16x32_bf16 v[72:75], a[148:151], a[4:7], v[72:75]
    s_cselect_b32 s65, -67584, s77
    ds_read_b64_tr_b16 a[124:125], v12 offset:96
    v_mov_b32 v16, 0
    v_mov_b32 v17, 0
    v_mfma_f32_16x16x32_bf16 v[72:75], a[152:155], a[8:11], v[72:75]
    s_add_u32 s57, s47, s60
    v_sub_f32 v65, v65, v92
    v_exp_f32 v65, v65
    v_mfma_f32_16x16x32_bf16 v[72:75], a[156:159], a[12:15], v[72:75]
    ds_read_b64_tr_b16 a[126:127], v12 offset:352
    v_mov_b32 v18, 0
    v_mov_b32 v19, 0
    v_mfma_f32_16x16x32_bf16 v[76:79], a[172:175], a[12:15], 0
    s_add_u32 m0, s60, 67584
    v_sub_f32 v66, v66, v92
    v_exp_f32 v66, v66
    v_mfma_f32_16x16x32_bf16 v[76:79], a[168:171], a[8:11], v[76:79]
    buffer_load_dwordx4 v88, s[28:31], s48 offen offset:0 nt lds
    v_mfma_f32_16x16x32_bf16 v[76:79], a[164:167], a[4:7], v[76:79]
    v_sub_f32 v67, v67, v92
    v_exp_f32 v67, v67
    v_mfma_f32_16x16x32_bf16 v[76:79], a[160:163], a[0:3], v[76:79]
    ds_read_b64_tr_b16 a[198:199], v13 offset:416
    v_cvt_pk_bf16_f32 v53, v66, v67
    v_cvt_pk_bf16_f32 v52, v64, v65
    v_mfma_f32_16x16x32_bf16 v[208:211], a[248:251], v[16:19], 0
    v_sub_f32 v68, v68, v92
    v_exp_f32 v68, v68
    v_mfma_f32_16x16x32_bf16 v[212:215], a[248:251], v[16:19], 0
    ds_read_b64_tr_b16 a[112:113], v12 offset:0
    ds_read_b64_tr_b16 a[114:115], v12 offset:256
    ds_read_b64_tr_b16 a[132:133], v12 offset:160
    v_mfma_f32_16x16x32_bf16 v[216:219], a[248:251], v[16:19], 0
    v_sub_f32 v69, v69, v92
    v_exp_f32 v69, v69
    v_mfma_f32_16x16x32_bf16 v[220:223], a[248:251], v[16:19], 0
    ds_read_b64_tr_b16 a[176:177], v13 offset:0
    ds_read_b64_tr_b16 a[134:135], v12 offset:416
    v_cvt_pk_bf16_f32 v54, v68, v69
    v_mfma_f32_16x16x32_bf16 v[224:227], a[248:251], v[16:19], 0
    s_add_u32 m0, s60, 67616
    v_sub_f32 v70, v70, v92
    v_exp_f32 v70, v70
    v_mfma_f32_16x16x32_bf16 v[228:231], a[248:251], v[16:19], 0
    buffer_load_dwordx4 v88, s[28:31], s48 offen offset:1024 nt lds
    v_mfma_f32_16x16x32_bf16 v[232:235], a[248:251], v[16:19], 0
    v_sub_f32 v71, v71, v92
    v_exp_f32 v71, v71
    v_mfma_f32_16x16x32_bf16 v[236:239], a[248:251], v[16:19], 0
    ds_read_b64_tr_b16 a[178:179], v13 offset:256
    ds_read_b64_tr_b16 a[136:137], v12 offset:192
    v_cvt_pk_bf16_f32 v55, v70, v71
    v_mfma_f32_16x16x32_bf16 v[80:83], a[80:83], a[16:19], 0
    v_accvgpr_read_b32 v92, a252
    v_sub_f32 v72, v72, v92
    v_exp_f32 v72, v72
    v_mfma_f32_16x16x32_bf16 v[80:83], a[84:87], a[20:23], v[80:83]
    ds_read_b64_tr_b16 a[180:181], v13 offset:32
    ds_read_b64_tr_b16 a[182:183], v13 offset:288
    ds_read_b64_tr_b16 a[138:139], v12 offset:448
    v_mfma_f32_16x16x32_bf16 v[80:83], a[88:91], a[24:27], v[80:83]
    s_mul_i32 s63, s42, 9
    v_sub_f32 v73, v73, v92
    v_exp_f32 v73, v73
    v_mfma_f32_16x16x32_bf16 v[80:83], a[92:95], a[28:31], v[80:83]
    s_lshl_b32 s84, s41, 2
    ds_read_b64_tr_b16 a[116:117], v12 offset:32
    ds_read_b64_tr_b16 a[202:203], v13 offset:448
    v_cvt_pk_bf16_f32 v56, v72, v73
    v_mfma_f32_16x16x32_bf16 v[84:87], a[108:111], a[28:31], 0
    s_add_u32 s84, s84, s63
    v_sub_f32 v74, v74, v92
    v_exp_f32 v74, v74
    v_mfma_f32_16x16x32_bf16 v[84:87], a[104:107], a[24:27], v[84:87]
    s_lshl_b32 s84, s84, 17
    ds_read_b64_tr_b16 a[118:119], v12 offset:288
    ds_read_b64_tr_b16 a[120:121], v12 offset:64
    ds_read_b64_tr_b16 a[204:205], v13 offset:224
    v_mfma_f32_16x16x32_bf16 v[84:87], a[100:103], a[20:23], v[84:87]
    s_add_u32 m0, s60, 67648
    v_sub_f32 v75, v75, v92
    v_exp_f32 v75, v75
    v_mfma_f32_16x16x32_bf16 v[84:87], a[96:99], a[16:19], v[84:87]
    buffer_load_dwordx4 v88, s[28:31], s48 offen offset:2048 nt lds
    v_mfma_f32_16x16x32_bf16 v[240:243], a[248:251], v[16:19], 0
    s_add_u32 s85, s84, 131072
    v_sub_f32 v76, v76, v92
    v_exp_f32 v76, v76
    v_mfma_f32_16x16x32_bf16 v[244:247], a[248:251], v[16:19], 0
    s_add_u32 s86, s84, 262144
    ds_read_b64_tr_b16 a[122:123], v12 offset:320
    ds_read_b64_tr_b16 a[206:207], v13 offset:480
    v_cvt_pk_bf16_f32 v57, v74, v75
    v_mfma_f32_16x16x32_bf16 v[248:251], a[248:251], v[16:19], 0
    s_add_u32 s87, s84, 393216
    v_sub_f32 v77, v77, v92
    v_exp_f32 v77, v77
    v_mfma_f32_16x16x32_bf16 v[252:255], a[248:251], v[16:19], 0
    s_add_u32 s63, s63, 8
    ds_read_b64_tr_b16 a[184:185], v13 offset:64
    ds_read_b64_tr_b16 a[140:141], v12 offset:224
    v_cvt_pk_bf16_f32 v58, v76, v77
    v_mfma_f32_16x16x32_bf16 a[244:247], a[248:251], v[16:19], 0
    s_lshl_b32 s63, s63, 17
    v_sub_f32 v78, v78, v92
    v_exp_f32 v78, v78
    s_nop 0
    s_lshl_b32 s88, s41, 11
    ds_read_b64_tr_b16 a[186:187], v13 offset:320
    ds_read_b64_tr_b16 a[188:189], v13 offset:96
    ds_read_b64_tr_b16 a[142:143], v12 offset:480
    s_nop 0
    s_add_u32 s88, s88, s63
    v_sub_f32 v79, v79, v92
    v_exp_f32 v79, v79
    s_nop 0
    s_lshr_b32 s63, s89, 1
    ds_read_b64_tr_b16 a[190:191], v13 offset:352
    v_cvt_pk_bf16_f32 v59, v78, v79
    v_mfma_f32_16x16x32_bf16 v[64:67], a[144:147], a[16:19], 0
    s_add_u32 m0, s60, 67680
    v_accvgpr_read_b32 v92, a253
    v_sub_f32 v80, v80, v92
    v_exp_f32 v80, v80
    v_mfma_f32_16x16x32_bf16 v[64:67], a[148:151], a[20:23], v[64:67]
    buffer_load_dwordx4 v88, s[28:31], s48 offen offset:3072 nt lds
    v_mfma_f32_16x16x32_bf16 v[64:67], a[152:155], a[24:27], v[64:67]
    s_mul_i32 s63, s63, 9
    v_sub_f32 v81, v81, v92
    v_exp_f32 v81, v81
    v_mfma_f32_16x16x32_bf16 v[64:67], a[156:159], a[28:31], v[64:67]
    s_and_b32 s64, s89, 1
    v_add_f32 v14, v14, v81
    v_cvt_pk_bf16_f32 v60, v80, v81
    v_mfma_f32_16x16x32_bf16 v[68:71], a[172:175], a[28:31], 0
    s_lshl_b32 s76, s64, 2
    v_sub_f32 v82, v82, v92
    v_exp_f32 v82, v82
    v_mfma_f32_16x16x32_bf16 v[68:71], a[168:171], a[24:27], v[68:71]
    s_add_u32 s63, s63, s76
    v_add_f32 v14, v14, v82
    v_add_f32 v14, v14, v80
    v_mfma_f32_16x16x32_bf16 v[68:71], a[164:167], a[20:23], v[68:71]
    s_sub_u32 s76, 8, s76
    v_sub_f32 v83, v83, v92
    v_exp_f32 v83, v83
    v_mfma_f32_16x16x32_bf16 v[68:71], a[160:163], a[16:19], v[68:71]
    s_waitcnt lgkmcnt(0)
    v_add_f32 v14, v14, v83
    v_cvt_pk_bf16_f32 v61, v82, v83
    v_mfma_f32_16x16x32_bf16 v[96:99], a[112:115], v[52:55], 0
    s_mul_i32 s64, s91, 18
    v_sub_f32 v84, v84, v92
    v_exp_f32 v84, v84
    v_mfma_f32_16x16x32_bf16 v[96:99], a[176:179], v[56:59], v[96:99]
    s_add_u32 s63, s63, s64
    ds_read_b64_tr_b16 a[128:129], v12 offset:128
    v_add_f32 v14, v14, v84
    v_mfma_f32_16x16x32_bf16 v[100:103], a[180:183], v[56:59], 0
    s_add_u32 m0, s58, 0
    v_sub_f32 v85, v85, v92
    v_exp_f32 v85, v85
    v_mfma_f32_16x16x32_bf16 v[100:103], a[116:119], v[52:55], v[100:103]
    buffer_load_dwordx4 v88, s[32:35], s56 offen offset:0 nt lds
    v_mfma_f32_16x16x32_bf16 v[104:107], a[120:123], v[52:55], 0
    s_lshl_b32 s64, s63, 17
    v_sub_f32 v86, v86, v92
    v_exp_f32 v86, v86
    v_mfma_f32_16x16x32_bf16 v[104:107], a[184:187], v[56:59], v[104:107]
    s_lshl_b32 s51, s40, 15
    v_add_f32 v14, v14, v86
    v_add_f32 v14, v14, v85
    v_mfma_f32_16x16x32_bf16 v[108:111], a[188:191], v[56:59], 0
    s_add_u32 s64, s64, s51
    v_sub_f32 v87, v87, v92
    v_exp_f32 v87, v87
    v_mfma_f32_16x16x32_bf16 v[108:111], a[124:127], v[52:55], v[108:111]
    s_add_u32 s20, s18, s64
    v_add_f32 v14, v14, v87
    v_cvt_pk_bf16_f32 v63, v86, v87
    v_mfma_f32_16x16x32_bf16 a[240:243], a[248:251], v[52:55], 0
    s_addc_u32 s21, s19, 0
    ds_read_b64_tr_b16 a[130:131], v12 offset:384
    v_cvt_pk_bf16_f32 v62, v84, v85
    v_mfma_f32_16x16x32_bf16 a[240:243], a[248:251], v[56:59], a[240:243]
    s_sub_u32 s22, 18874368, s64
    ds_read_b64_tr_b16 a[192:193], v13 offset:128
    ds_read_b64_tr_b16 a[194:195], v13 offset:384
    v_mfma_f32_16x16x32_bf16 v[72:75], a[80:83], v[20:23], 0
    s_mov_b32 s23, 0x20000
    v_accvgpr_read_b32 v92, a253
    v_sub_f32 v64, v64, v92
    v_exp_f32 v64, v64
    v_mfma_f32_16x16x32_bf16 v[72:75], a[84:87], v[24:27], v[72:75]
    s_lshl_b32 s64, s63, 14
    ds_read_b64_tr_b16 a[196:197], v13 offset:160
    v_add_f32 v14, v14, v64
    v_mfma_f32_16x16x32_bf16 v[72:75], a[88:91], v[28:31], v[72:75]
    s_add_u32 s24, s14, s64
    v_sub_f32 v65, v65, v92
    v_exp_f32 v65, v65
    v_mfma_f32_16x16x32_bf16 v[72:75], a[92:95], v[32:35], v[72:75]
    s_addc_u32 s25, s15, 0
    v_cvt_pk_bf16_f32 v16, v64, v65
    v_add_f32 v14, v14, v65
    v_mfma_f32_16x16x32_bf16 v[76:79], a[108:111], v[32:35], 0
    s_sub_u32 s26, 2359296, s64
    v_sub_f32 v66, v66, v92
    v_exp_f32 v66, v66
    v_mfma_f32_16x16x32_bf16 v[76:79], a[104:107], v[28:31], v[76:79]
    s_mov_b32 s27, 0x20000
    ds_read_b64_tr_b16 a[200:201], v13 offset:192
    v_add_f32 v14, v14, v66
    v_mfma_f32_16x16x32_bf16 v[76:79], a[100:103], v[24:27], v[76:79]
    s_lshl_b32 s51, s76, 17
    v_sub_f32 v67, v67, v92
    v_exp_f32 v67, v67
    v_mfma_f32_16x16x32_bf16 v[76:79], a[96:99], v[20:23], v[76:79]
    s_waitcnt lgkmcnt(1)
    v_cvt_pk_bf16_f32 v17, v66, v67
    v_add_f32 v14, v14, v67
    v_mfma_f32_16x16x32_bf16 v[112:115], a[128:131], v[52:55], 0
    s_and_b32 s53, s90, 0
    v_sub_f32 v68, v68, v92
    v_exp_f32 v68, v68
    v_mfma_f32_16x16x32_bf16 v[112:115], a[192:195], v[56:59], v[112:115]
    s_lshl_b32 s52, s53, 17
    v_add_f32 v14, v14, v68
    v_add_u32 v10, s65, v10
    v_mfma_f32_16x16x32_bf16 v[116:119], a[196:199], v[56:59], 0
    s_add_u32 m0, s58, 32
    v_sub_f32 v69, v69, v92
    v_exp_f32 v69, v69
    v_mfma_f32_16x16x32_bf16 v[116:119], a[132:135], v[52:55], v[116:119]
    buffer_load_dwordx4 v88, s[32:35], s56 offen offset:1024 nt lds
    v_mfma_f32_16x16x32_bf16 v[120:123], a[136:139], v[52:55], 0
    s_waitcnt lgkmcnt(0)
    v_sub_f32 v70, v70, v92
    v_exp_f32 v70, v70
    v_mfma_f32_16x16x32_bf16 v[120:123], a[200:203], v[56:59], v[120:123]
    s_lshl_b32 s53, s53, 12
    v_cvt_pk_bf16_f32 v18, v68, v69
    v_add_f32 v14, v14, v70
    v_mfma_f32_16x16x32_bf16 v[124:127], a[204:207], v[56:59], 0
    s_or_b32 s51, s51, s53
    v_sub_f32 v71, v71, v92
    v_exp_f32 v71, v71
    v_mfma_f32_16x16x32_bf16 v[124:127], a[140:143], v[52:55], v[124:127]
    s_lshl_b32 s54, s43, 2
    v_cvt_pk_bf16_f32 v19, v70, v71
    v_add_f32 v14, v14, v71
    v_mfma_f32_16x16x32_bf16 v[80:83], a[144:147], v[20:23], 0
    s_lshr_b32 s64, s44, 3
    v_accvgpr_read_b32 v92, a254
    v_sub_f32 v72, v72, v92
    v_exp_f32 v72, v72
    v_mfma_f32_16x16x32_bf16 v[80:83], a[148:151], v[24:27], v[80:83]
    s_add_u32 s54, s54, s64
    v_add_f32 v14, v14, v69
    v_add_f32 v15, v15, v72
    v_mfma_f32_16x16x32_bf16 v[80:83], a[152:155], v[28:31], v[80:83]
    s_lshl_b32 s54, s54, 3
    v_sub_f32 v73, v73, v92
    v_exp_f32 v73, v73
    v_mfma_f32_16x16x32_bf16 v[80:83], a[156:159], v[32:35], v[80:83]
    s_lshl_b32 s50, s91, 2
    v_add_f32 v15, v15, v73
    v_cvt_pk_bf16_f32 v52, v72, v73
    v_mfma_f32_16x16x32_bf16 v[84:87], a[172:175], v[32:35], 0
    s_add_u32 m0, s58, 64
    v_sub_f32 v74, v74, v92
    v_exp_f32 v74, v74
    v_mfma_f32_16x16x32_bf16 v[84:87], a[168:171], v[28:31], v[84:87]
    buffer_load_dwordx4 v88, s[32:35], s56 offen offset:2048 nt lds
    v_mfma_f32_16x16x32_bf16 v[84:87], a[164:167], v[24:27], v[84:87]
    s_add_u32 s50, s50, s40
    v_sub_f32 v75, v75, v92
    v_exp_f32 v75, v75
    v_mfma_f32_16x16x32_bf16 v[84:87], a[160:163], v[20:23], v[84:87]
    s_lshl_b32 s50, s50, 3
    v_add_f32 v15, v15, v75
    v_cvt_pk_bf16_f32 v53, v74, v75
    v_mfma_f32_16x16x32_bf16 v[128:131], a[112:115], v[60:63], 0
    v_sub_f32 v76, v76, v92
    v_exp_f32 v76, v76
    v_mfma_f32_16x16x32_bf16 v[128:131], a[176:179], v[16:19], v[128:131]
    v_add_f32 v15, v15, v76
    v_add_f32 v15, v15, v74
    v_mfma_f32_16x16x32_bf16 v[132:135], a[180:183], v[16:19], 0
    v_sub_f32 v77, v77, v92
    v_exp_f32 v77, v77
    v_mfma_f32_16x16x32_bf16 v[132:135], a[116:119], v[60:63], v[132:135]
    v_add_f32 v15, v15, v77
    v_cvt_pk_bf16_f32 v54, v76, v77
    v_mfma_f32_16x16x32_bf16 v[136:139], a[120:123], v[60:63], 0
    v_sub_f32 v78, v78, v92
    v_exp_f32 v78, v78
    v_mfma_f32_16x16x32_bf16 v[136:139], a[184:187], v[16:19], v[136:139]
    v_add_f32 v15, v15, v78
    v_add_u32 v12, s65, v12
    v_mfma_f32_16x16x32_bf16 v[140:143], a[188:191], v[16:19], 0
    v_sub_f32 v79, v79, v92
    v_exp_f32 v79, v79
    v_mfma_f32_16x16x32_bf16 v[140:143], a[124:127], v[60:63], v[140:143]
    v_add_f32 v15, v15, v79
    v_cvt_pk_bf16_f32 v55, v78, v79
    v_mfma_f32_16x16x32_bf16 v[64:67], a[80:83], v[36:39], 0
    v_accvgpr_read_b32 v92, a254
    v_sub_f32 v80, v80, v92
    v_exp_f32 v80, v80
    v_mfma_f32_16x16x32_bf16 v[64:67], a[84:87], v[40:43], v[64:67]
    v_add_f32 v15, v15, v80
    v_add_u32 v13, s65, v13
    v_mfma_f32_16x16x32_bf16 v[64:67], a[88:91], v[44:47], v[64:67]
    v_sub_f32 v81, v81, v92
    v_exp_f32 v81, v81
    v_mfma_f32_16x16x32_bf16 v[64:67], a[92:95], v[48:51], v[64:67]
    v_cvt_pk_bf16_f32 v56, v80, v81
    v_add_f32 v15, v15, v81
    v_mfma_f32_16x16x32_bf16 v[68:71], a[108:111], v[48:51], 0
    s_add_u32 m0, s58, 96
    v_sub_f32 v82, v82, v92
    v_exp_f32 v82, v82
    v_mfma_f32_16x16x32_bf16 v[68:71], a[104:107], v[44:47], v[68:71]
    buffer_load_dwordx4 v88, s[32:35], s56 offen offset:3072 nt lds
    v_mfma_f32_16x16x32_bf16 v[68:71], a[100:103], v[40:43], v[68:71]
    v_sub_f32 v83, v83, v92
    v_exp_f32 v83, v83
    v_mfma_f32_16x16x32_bf16 v[68:71], a[96:99], v[36:39], v[68:71]
    v_cvt_pk_bf16_f32 v57, v82, v83
    v_add_f32 v15, v15, v83
    v_mfma_f32_16x16x32_bf16 v[144:147], a[128:131], v[60:63], 0
    v_sub_f32 v84, v84, v92
    v_exp_f32 v84, v84
    v_mfma_f32_16x16x32_bf16 v[144:147], a[192:195], v[16:19], v[144:147]
    v_add_f32 v15, v15, v84
    v_add_f32 v15, v15, v82
    v_mfma_f32_16x16x32_bf16 v[148:151], a[196:199], v[16:19], 0
    v_sub_f32 v85, v85, v92
    v_exp_f32 v85, v85
    v_mfma_f32_16x16x32_bf16 v[148:151], a[132:135], v[60:63], v[148:151]
    v_cvt_pk_bf16_f32 v58, v84, v85
    v_add_f32 v15, v15, v85
    v_mfma_f32_16x16x32_bf16 v[152:155], a[136:139], v[60:63], 0
    v_sub_f32 v86, v86, v92
    v_exp_f32 v86, v86
    v_mfma_f32_16x16x32_bf16 v[152:155], a[200:203], v[16:19], v[152:155]
    v_add_f32 v15, v15, v86
    v_add_u32 v11, s65, v11
    v_mfma_f32_16x16x32_bf16 v[156:159], a[204:207], v[16:19], 0
    v_sub_f32 v87, v87, v92
    v_exp_f32 v87, v87
    v_mfma_f32_16x16x32_bf16 v[156:159], a[140:143], v[60:63], v[156:159]
    s_waitcnt vmcnt(8)
    v_cvt_pk_bf16_f32 v59, v86, v87
    v_add_f32 v15, v15, v87
    v_mfma_f32_16x16x32_bf16 v[72:75], a[144:147], v[36:39], 0
    s_barrier
    v_accvgpr_read_b32 v92, a255
    v_sub_f32 v64, v64, v92
    v_exp_f32 v64, v64
    v_mfma_f32_16x16x32_bf16 v[72:75], a[148:151], v[40:43], v[72:75]
    ds_read_b128 a[144:147], v11 offset:0
    v_add_f32 v89, v89, v64
    v_mfma_f32_16x16x32_bf16 v[72:75], a[152:155], v[44:47], v[72:75]
    v_sub_f32 v65, v65, v92
    v_exp_f32 v65, v65
    v_mfma_f32_16x16x32_bf16 v[72:75], a[156:159], v[48:51], v[72:75]
    ds_read_b128 a[152:155], v11 offset:128
    v_add_f32 v89, v89, v65
    v_cvt_pk_bf16_f32 v60, v64, v65
    v_mfma_f32_16x16x32_bf16 v[76:79], a[172:175], v[48:51], 0
    s_add_u32 m0, s57, 0
    v_sub_f32 v66, v66, v92
    v_exp_f32 v66, v66
    v_mfma_f32_16x16x32_bf16 v[76:79], a[168:171], v[44:47], v[76:79]
    buffer_load_dwordx4 v88, s[28:31], s55 offen offset:0 nt lds
    v_mfma_f32_16x16x32_bf16 v[76:79], a[164:167], v[40:43], v[76:79]
    s_add_u32 s56, s56, 16384
    v_sub_f32 v67, v67, v92
    v_exp_f32 v67, v67
    v_mfma_f32_16x16x32_bf16 v[76:79], a[160:163], v[36:39], v[76:79]
    s_and_b32 s56, s56, 0x3ffff
    ds_read_b128 a[156:159], v11 offset:192
    v_add_f32 v89, v89, v67
    v_cvt_pk_bf16_f32 v61, v66, v67
    v_mfma_f32_16x16x32_bf16 v[160:163], a[112:115], v[52:55], 0
    s_add_u32 s58, s57, 16896
    v_sub_f32 v68, v68, v92
    v_exp_f32 v68, v68
    v_mfma_f32_16x16x32_bf16 v[160:163], a[176:179], v[56:59], v[160:163]
    s_add_u32 s47, s47, s65
    ds_read_b128 a[172:175], v11 offset:448
    v_add_f32 v89, v89, v68
    v_add_f32 v89, v89, v66
    v_mfma_f32_16x16x32_bf16 v[164:167], a[180:183], v[56:59], 0
    v_sub_f32 v69, v69, v92
    v_exp_f32 v69, v69
    v_mfma_f32_16x16x32_bf16 v[164:167], a[116:119], v[52:55], v[164:167]
    ds_read_b128 a[164:167], v11 offset:320
    v_add_f32 v89, v89, v69
    v_cvt_pk_bf16_f32 v62, v68, v69
    v_mfma_f32_16x16x32_bf16 v[168:171], a[120:123], v[52:55], 0
    v_sub_f32 v70, v70, v92
    v_exp_f32 v70, v70
    v_mfma_f32_16x16x32_bf16 v[168:171], a[184:187], v[56:59], v[168:171]
    ds_read_b128 a[148:151], v11 offset:64
    v_add_f32 v89, v89, v70
    v_mfma_f32_16x16x32_bf16 v[172:175], a[188:191], v[56:59], 0
    v_sub_f32 v71, v71, v92
    v_exp_f32 v71, v71
    v_mfma_f32_16x16x32_bf16 v[172:175], a[124:127], v[52:55], v[172:175]
    v_add_f32 v89, v89, v71
    v_cvt_pk_bf16_f32 v63, v70, v71
    v_mfma_f32_16x16x32_bf16 v[80:83], a[80:83], a[64:67], 0
    v_accvgpr_read_b32 v92, a255
    v_sub_f32 v72, v72, v92
    v_exp_f32 v72, v72
    v_mfma_f32_16x16x32_bf16 v[80:83], a[84:87], a[68:71], v[80:83]
    ds_read_b128 a[80:83], v10 offset:0
    ds_read_b128 a[84:87], v10 offset:64
    v_mfma_f32_16x16x32_bf16 v[80:83], a[88:91], a[72:75], v[80:83]
    v_sub_f32 v73, v73, v92
    v_exp_f32 v73, v73
    v_mfma_f32_16x16x32_bf16 v[80:83], a[92:95], a[76:79], v[80:83]
    ds_read_b128 a[88:91], v10 offset:128
    ds_read_b128 a[92:95], v10 offset:192
    v_mfma_f32_16x16x32_bf16 v[84:87], a[108:111], a[76:79], 0
    v_sub_f32 v74, v74, v92
    v_exp_f32 v74, v74
    v_mfma_f32_16x16x32_bf16 v[84:87], a[104:107], a[72:75], v[84:87]
    ds_read_b128 a[108:111], v10 offset:448
    ds_read_b128 a[104:107], v10 offset:384
    v_mfma_f32_16x16x32_bf16 v[84:87], a[100:103], a[68:71], v[84:87]
    v_sub_f32 v75, v75, v92
    v_exp_f32 v75, v75
    v_mfma_f32_16x16x32_bf16 v[84:87], a[96:99], a[64:67], v[84:87]
    ds_read_b128 a[100:103], v10 offset:320
    ds_read_b128 a[96:99], v10 offset:256
    v_mfma_f32_16x16x32_bf16 v[176:179], a[128:131], v[52:55], 0
    s_add_u32 m0, s57, 32
    v_sub_f32 v76, v76, v92
    v_exp_f32 v76, v76
    v_mfma_f32_16x16x32_bf16 v[176:179], a[192:195], v[56:59], v[176:179]
    buffer_load_dwordx4 v88, s[28:31], s55 offen offset:1024 nt lds
    v_mfma_f32_16x16x32_bf16 v[180:183], a[196:199], v[56:59], 0
    v_sub_f32 v77, v77, v92
    v_exp_f32 v77, v77
    v_mfma_f32_16x16x32_bf16 v[180:183], a[132:135], v[52:55], v[180:183]
    v_cvt_pk_bf16_f32 v18, v76, v77
    v_cvt_pk_bf16_f32 v17, v74, v75
    v_mfma_f32_16x16x32_bf16 v[184:187], a[136:139], v[52:55], 0
    v_sub_f32 v78, v78, v92
    v_exp_f32 v78, v78
    v_mfma_f32_16x16x32_bf16 v[184:187], a[200:203], v[56:59], v[184:187]
    v_add_f32 v89, v89, v78
    v_cvt_pk_bf16_f32 v16, v72, v73
    v_mfma_f32_16x16x32_bf16 v[188:191], a[204:207], v[56:59], 0
    v_sub_f32 v79, v79, v92
    v_exp_f32 v79, v79
    v_mfma_f32_16x16x32_bf16 v[188:191], a[140:143], v[52:55], v[188:191]
    s_waitcnt lgkmcnt(0)
    v_cvt_pk_bf16_f32 v19, v78, v79
    v_add_f32 v89, v89, v79
    v_mfma_f32_16x16x32_bf16 v[64:67], a[80:83], a[0:3], 0
    v_sub_f32 v80, v80, v9
    v_exp_f32 v80, v80
    v_mfma_f32_16x16x32_bf16 v[64:67], a[84:87], a[4:7], v[64:67]
    v_add_f32 v89, v89, v77
    v_add_f32 v89, v89, v76
    v_mfma_f32_16x16x32_bf16 v[64:67], a[88:91], a[8:11], v[64:67]
    s_add_u32 m0, s57, 64
    v_sub_f32 v81, v81, v9
    v_exp_f32 v81, v81
    v_mfma_f32_16x16x32_bf16 v[64:67], a[92:95], a[12:15], v[64:67]
    buffer_load_dwordx4 v88, s[28:31], s55 offen offset:2048 nt lds
    v_mfma_f32_16x16x32_bf16 v[68:71], a[108:111], a[12:15], 0
    v_sub_f32 v82, v82, v9
    v_exp_f32 v82, v82
    v_mfma_f32_16x16x32_bf16 v[68:71], a[104:107], a[8:11], v[68:71]
    v_cvt_pk_bf16_f32 v56, v80, v81
    v_add_f32 v89, v89, v75
    v_mfma_f32_16x16x32_bf16 v[68:71], a[100:103], a[4:7], v[68:71]
    v_sub_f32 v83, v83, v9
    v_exp_f32 v83, v83
    v_mfma_f32_16x16x32_bf16 v[68:71], a[96:99], a[0:3], v[68:71]
    v_cvt_pk_bf16_f32 v57, v82, v83
    v_add_f32 v89, v89, v74
    v_mfma_f32_16x16x32_bf16 v[192:195], a[112:115], v[60:63], 0
    v_sub_f32 v84, v84, v9
    v_exp_f32 v84, v84
    v_mfma_f32_16x16x32_bf16 v[192:195], a[176:179], v[16:19], v[192:195]
    v_add_f32 v89, v89, v73
    v_add_f32 v89, v89, v72
    v_mfma_f32_16x16x32_bf16 v[196:199], a[180:183], v[16:19], 0
    s_add_u32 m0, s57, 96
    v_sub_f32 v85, v85, v9
    v_exp_f32 v85, v85
    v_mfma_f32_16x16x32_bf16 v[196:199], a[116:119], v[60:63], v[196:199]
    buffer_load_dwordx4 v88, s[28:31], s55 offen offset:3072 nt lds
    v_mfma_f32_16x16x32_bf16 v[200:203], a[120:123], v[60:63], 0
    s_add_u32 s55, s55, 16384
    v_sub_f32 v86, v86, v9
    v_exp_f32 v86, v86
    v_mfma_f32_16x16x32_bf16 v[200:203], a[184:187], v[16:19], v[200:203]
    s_and_b32 s55, s55, 0x3ffff
    ds_read_b128 a[168:171], v11 offset:384
    v_cvt_pk_bf16_f32 v58, v84, v85
    v_mfma_f32_16x16x32_bf16 v[204:207], a[188:191], v[16:19], 0
    s_add_u32 s59, s59, 1
    v_sub_f32 v87, v87, v9
    v_exp_f32 v87, v87
    v_mfma_f32_16x16x32_bf16 v[204:207], a[124:127], v[60:63], v[204:207]
    s_cmp_lt_u32 s59, 13
    ds_read_b128 a[160:163], v11 offset:256
    v_cvt_pk_bf16_f32 v59, v86, v87
L_stile:
    v_mfma_f32_16x16x32_bf16 v[72:75], a[144:147], a[0:3], 0
    s_cmp_eq_u32 s47, 67584
    v_accvgpr_read_b32 v92, a252
    v_sub_f32 v64, v64, v92
    v_exp_f32 v64, v64
    v_mfma_f32_16x16x32_bf16 v[72:75], a[148:151], a[4:7], v[72:75]
    s_cselect_b32 s65, -67584, s77
    ds_read_b64_tr_b16 a[176:177], v13 offset:0
    ds_read_b64_tr_b16 a[178:179], v13 offset:256
    v_mfma_f32_16x16x32_bf16 v[72:75], a[152:155], a[8:11], v[72:75]
    s_add_u32 s57, s47, s60
    v_sub_f32 v65, v65, v92
    v_exp_f32 v65, v65
    v_mfma_f32_16x16x32_bf16 v[72:75], a[156:159], a[12:15], v[72:75]
    ds_read_b64_tr_b16 a[180:181], v13 offset:32
    v_cvt_pk_bf16_f32 v52, v64, v65
    v_mfma_f32_16x16x32_bf16 v[76:79], a[172:175], a[12:15], 0
    s_waitcnt lgkmcnt(4)
    v_sub_f32 v66, v66, v92
    v_exp_f32 v66, v66
    v_mfma_f32_16x16x32_bf16 v[76:79], a[168:171], a[8:11], v[76:79]
    ds_read_b64_tr_b16 a[182:183], v13 offset:288
    ds_read_b64_tr_b16 a[184:185], v13 offset:64
    v_mfma_f32_16x16x32_bf16 v[76:79], a[164:167], a[4:7], v[76:79]
    s_waitcnt lgkmcnt(5)
    v_sub_f32 v67, v67, v92
    v_exp_f32 v67, v67
    v_mfma_f32_16x16x32_bf16 v[76:79], a[160:163], a[0:3], v[76:79]
    ds_read_b64_tr_b16 a[186:187], v13 offset:320
    v_cvt_pk_bf16_f32 v53, v66, v67
    v_mfma_f32_16x16x32_bf16 v[224:227], a[112:115], v[56:59], v[224:227]
    v_sub_f32 v68, v68, v92
    v_exp_f32 v68, v68
    v_mfma_f32_16x16x32_bf16 v[228:231], a[116:119], v[56:59], v[228:231]
    ds_read_b64_tr_b16 a[112:113], v12 offset:0
    ds_read_b64_tr_b16 a[114:115], v12 offset:256
    v_mfma_f32_16x16x32_bf16 v[232:235], a[120:123], v[56:59], v[232:235]
    v_sub_f32 v69, v69, v92
    v_exp_f32 v69, v69
    v_mfma_f32_16x16x32_bf16 v[236:239], a[124:127], v[56:59], v[236:239]
    ds_read_b64_tr_b16 a[116:117], v12 offset:32
    v_cvt_pk_bf16_f32 v54, v68, v69
    v_mfma_f32_16x16x32_bf16 v[240:243], a[128:131], v[56:59], v[240:243]
    v_sub_f32 v70, v70, v92
    v_exp_f32 v70, v70
    v_mfma_f32_16x16x32_bf16 v[244:247], a[132:135], v[56:59], v[244:247]
    ds_read_b64_tr_b16 a[118:119], v12 offset:288
    ds_read_b64_tr_b16 a[120:121], v12 offset:64
    v_mfma_f32_16x16x32_bf16 v[248:251], a[136:139], v[56:59], v[248:251]
    v_sub_f32 v71, v71, v92
    v_exp_f32 v71, v71
    v_mfma_f32_16x16x32_bf16 v[252:255], a[140:143], v[56:59], v[252:255]
    ds_read_b64_tr_b16 a[122:123], v12 offset:320
    v_cvt_pk_bf16_f32 v55, v70, v71
    v_mfma_f32_16x16x32_bf16 a[244:247], a[248:251], v[56:59], a[244:247]
    ds_read_b64_tr_b16 a[124:125], v12 offset:96
    ds_read_b64_tr_b16 a[126:127], v12 offset:352
    v_mfma_f32_16x16x32_bf16 v[80:83], a[80:83], a[16:19], 0
    v_accvgpr_read_b32 v92, a252
    v_sub_f32 v72, v72, v92
    v_exp_f32 v72, v72
    v_mfma_f32_16x16x32_bf16 v[80:83], a[84:87], a[20:23], v[80:83]
    ds_read_b64_tr_b16 a[188:189], v13 offset:96
    ds_read_b64_tr_b16 a[190:191], v13 offset:352
    v_mfma_f32_16x16x32_bf16 v[80:83], a[88:91], a[24:27], v[80:83]
    v_sub_f32 v73, v73, v92
    v_exp_f32 v73, v73
    v_mfma_f32_16x16x32_bf16 v[80:83], a[92:95], a[28:31], v[80:83]
    v_cvt_pk_bf16_f32 v56, v72, v73
    v_add_u32 v10, s65, v10
    v_mfma_f32_16x16x32_bf16 v[84:87], a[108:111], a[28:31], 0
    s_add_u32 m0, s58, 0
    v_sub_f32 v74, v74, v92
    v_exp_f32 v74, v74
    v_mfma_f32_16x16x32_bf16 v[84:87], a[104:107], a[24:27], v[84:87]
    buffer_load_dwordx4 v88, s[32:35], s56 offen offset:0 nt lds
    v_mfma_f32_16x16x32_bf16 v[84:87], a[100:103], a[20:23], v[84:87]
    v_sub_f32 v75, v75, v92
    v_exp_f32 v75, v75
    v_mfma_f32_16x16x32_bf16 v[84:87], a[96:99], a[16:19], v[84:87]
    v_cvt_pk_bf16_f32 v57, v74, v75
    v_add_u32 v11, s65, v11
    v_mfma_f32_16x16x32_bf16 v[208:211], a[128:131], v[60:63], v[208:211]
    v_sub_f32 v76, v76, v92
    v_exp_f32 v76, v76
    v_mfma_f32_16x16x32_bf16 v[208:211], a[192:195], v[16:19], v[208:211]
    ds_read_b64_tr_b16 a[128:129], v12 offset:128
    ds_read_b64_tr_b16 a[130:131], v12 offset:384
    v_mfma_f32_16x16x32_bf16 v[212:215], a[196:199], v[16:19], v[212:215]
    v_sub_f32 v77, v77, v92
    v_exp_f32 v77, v77
    v_mfma_f32_16x16x32_bf16 v[212:215], a[132:135], v[60:63], v[212:215]
    ds_read_b64_tr_b16 a[192:193], v13 offset:128
    v_cvt_pk_bf16_f32 v58, v76, v77
    v_mfma_f32_16x16x32_bf16 v[216:219], a[136:139], v[60:63], v[216:219]
    v_sub_f32 v78, v78, v92
    v_exp_f32 v78, v78
    v_mfma_f32_16x16x32_bf16 v[216:219], a[200:203], v[16:19], v[216:219]
    ds_read_b64_tr_b16 a[194:195], v13 offset:384
    ds_read_b64_tr_b16 a[196:197], v13 offset:160
    v_mfma_f32_16x16x32_bf16 v[220:223], a[204:207], v[16:19], v[220:223]
    v_sub_f32 v79, v79, v92
    v_exp_f32 v79, v79
    v_mfma_f32_16x16x32_bf16 v[220:223], a[140:143], v[60:63], v[220:223]
    ds_read_b64_tr_b16 a[198:199], v13 offset:416
    v_cvt_pk_bf16_f32 v59, v78, v79
    v_mfma_f32_16x16x32_bf16 v[64:67], a[144:147], a[16:19], 0
    v_accvgpr_read_b32 v92, a253
    v_sub_f32 v80, v80, v92
    v_exp_f32 v80, v80
    v_mfma_f32_16x16x32_bf16 v[64:67], a[148:151], a[20:23], v[64:67]
    ds_read_b64_tr_b16 a[132:133], v12 offset:160
    ds_read_b64_tr_b16 a[134:135], v12 offset:416
    v_mfma_f32_16x16x32_bf16 v[64:67], a[152:155], a[24:27], v[64:67]
    v_sub_f32 v81, v81, v92
    v_exp_f32 v81, v81
    v_mfma_f32_16x16x32_bf16 v[64:67], a[156:159], a[28:31], v[64:67]
    ds_read_b64_tr_b16 a[136:137], v12 offset:192
    ds_read_b64_tr_b16 a[138:139], v12 offset:448
    v_mfma_f32_16x16x32_bf16 v[68:71], a[172:175], a[28:31], 0
    v_sub_f32 v82, v82, v92
    v_exp_f32 v82, v82
    v_mfma_f32_16x16x32_bf16 v[68:71], a[168:171], a[24:27], v[68:71]
    ds_read_b64_tr_b16 a[200:201], v13 offset:192
    ds_read_b64_tr_b16 a[202:203], v13 offset:448
    v_mfma_f32_16x16x32_bf16 v[68:71], a[164:167], a[20:23], v[68:71]
    v_sub_f32 v83, v83, v92
    v_exp_f32 v83, v83
    v_mfma_f32_16x16x32_bf16 v[68:71], a[160:163], a[16:19], v[68:71]
    s_waitcnt lgkmcnt(4)
    ds_read_b64_tr_b16 a[204:205], v13 offset:224
    ds_read_b64_tr_b16 a[206:207], v13 offset:480
    v_mfma_f32_16x16x32_bf16 v[96:99], a[112:115], v[52:55], v[96:99]
    v_sub_f32 v84, v84, v92
    v_exp_f32 v84, v84
    v_mfma_f32_16x16x32_bf16 v[96:99], a[176:179], v[56:59], v[96:99]
    ds_read_b64_tr_b16 a[140:141], v12 offset:224
    v_add_f32 v14, v14, v84
    v_mfma_f32_16x16x32_bf16 v[100:103], a[180:183], v[56:59], v[100:103]
    v_sub_f32 v85, v85, v92
    v_exp_f32 v85, v85
    v_mfma_f32_16x16x32_bf16 v[100:103], a[116:119], v[52:55], v[100:103]
    v_add_f32 v14, v14, v85
    v_cvt_pk_bf16_f32 v62, v84, v85
    v_mfma_f32_16x16x32_bf16 v[104:107], a[120:123], v[52:55], v[104:107]
    v_sub_f32 v86, v86, v92
    v_exp_f32 v86, v86
    v_mfma_f32_16x16x32_bf16 v[104:107], a[184:187], v[56:59], v[104:107]
    ds_read_b64_tr_b16 a[142:143], v12 offset:480
    v_add_f32 v14, v14, v86
    v_mfma_f32_16x16x32_bf16 v[108:111], a[188:191], v[56:59], v[108:111]
    v_sub_f32 v87, v87, v92
    v_exp_f32 v87, v87
    v_mfma_f32_16x16x32_bf16 v[108:111], a[124:127], v[52:55], v[108:111]
    v_add_f32 v14, v14, v87
    v_cvt_pk_bf16_f32 v63, v86, v87
    v_mfma_f32_16x16x32_bf16 a[240:243], a[248:251], v[52:55], a[240:243]
    v_add_f32 v14, v14, v83
    v_cvt_pk_bf16_f32 v61, v82, v83
    v_mfma_f32_16x16x32_bf16 a[240:243], a[248:251], v[56:59], a[240:243]
    v_add_f32 v14, v14, v82
    v_add_f32 v14, v14, v81
    v_mfma_f32_16x16x32_bf16 v[72:75], a[80:83], v[20:23], 0
    v_accvgpr_read_b32 v92, a253
    v_sub_f32 v64, v64, v92
    v_exp_f32 v64, v64
    v_mfma_f32_16x16x32_bf16 v[72:75], a[84:87], v[24:27], v[72:75]
    v_cvt_pk_bf16_f32 v60, v80, v81
    v_add_f32 v14, v14, v64
    v_mfma_f32_16x16x32_bf16 v[72:75], a[88:91], v[28:31], v[72:75]
    v_sub_f32 v65, v65, v92
    v_exp_f32 v65, v65
    v_mfma_f32_16x16x32_bf16 v[72:75], a[92:95], v[32:35], v[72:75]
    v_cvt_pk_bf16_f32 v16, v64, v65
    v_add_f32 v14, v14, v65
    v_mfma_f32_16x16x32_bf16 v[76:79], a[108:111], v[32:35], 0
    v_sub_f32 v66, v66, v92
    v_exp_f32 v66, v66
    v_mfma_f32_16x16x32_bf16 v[76:79], a[104:107], v[28:31], v[76:79]
    v_add_f32 v14, v14, v66
    v_add_f32 v14, v14, v80
    v_mfma_f32_16x16x32_bf16 v[76:79], a[100:103], v[24:27], v[76:79]
    v_sub_f32 v67, v67, v92
    v_exp_f32 v67, v67
    v_mfma_f32_16x16x32_bf16 v[76:79], a[96:99], v[20:23], v[76:79]
    v_cvt_pk_bf16_f32 v17, v66, v67
    v_add_f32 v14, v14, v67
    v_mfma_f32_16x16x32_bf16 v[112:115], a[128:131], v[52:55], v[112:115]
    v_sub_f32 v68, v68, v92
    v_exp_f32 v68, v68
    v_mfma_f32_16x16x32_bf16 v[112:115], a[192:195], v[56:59], v[112:115]
    v_add_f32 v14, v14, v68
    v_mfma_f32_16x16x32_bf16 v[116:119], a[196:199], v[56:59], v[116:119]
    s_add_u32 m0, s58, 32
    v_sub_f32 v69, v69, v92
    v_exp_f32 v69, v69
    v_mfma_f32_16x16x32_bf16 v[116:119], a[132:135], v[52:55], v[116:119]
    s_waitcnt lgkmcnt(0)
    buffer_load_dwordx4 v88, s[32:35], s56 offen offset:1024 nt lds
    v_mfma_f32_16x16x32_bf16 v[120:123], a[136:139], v[52:55], v[120:123]
    v_sub_f32 v70, v70, v92
    v_exp_f32 v70, v70
    v_mfma_f32_16x16x32_bf16 v[120:123], a[200:203], v[56:59], v[120:123]
    v_cvt_pk_bf16_f32 v18, v68, v69
    v_add_f32 v14, v14, v70
    v_mfma_f32_16x16x32_bf16 v[124:127], a[204:207], v[56:59], v[124:127]
    v_sub_f32 v71, v71, v92
    v_exp_f32 v71, v71
    v_mfma_f32_16x16x32_bf16 v[124:127], a[140:143], v[52:55], v[124:127]
    v_cvt_pk_bf16_f32 v19, v70, v71
    v_add_f32 v14, v14, v71
    v_mfma_f32_16x16x32_bf16 v[80:83], a[144:147], v[20:23], 0
    v_accvgpr_read_b32 v92, a254
    v_sub_f32 v72, v72, v92
    v_exp_f32 v72, v72
    v_mfma_f32_16x16x32_bf16 v[80:83], a[148:151], v[24:27], v[80:83]
    v_add_f32 v14, v14, v69
    v_add_f32 v15, v15, v72
    v_mfma_f32_16x16x32_bf16 v[80:83], a[152:155], v[28:31], v[80:83]
    v_sub_f32 v73, v73, v92
    v_exp_f32 v73, v73
    v_mfma_f32_16x16x32_bf16 v[80:83], a[156:159], v[32:35], v[80:83]
    v_add_f32 v15, v15, v73
    v_cvt_pk_bf16_f32 v52, v72, v73
    v_mfma_f32_16x16x32_bf16 v[84:87], a[172:175], v[32:35], 0
    s_add_u32 m0, s58, 64
    v_sub_f32 v74, v74, v92
    v_exp_f32 v74, v74
    v_mfma_f32_16x16x32_bf16 v[84:87], a[168:171], v[28:31], v[84:87]
    buffer_load_dwordx4 v88, s[32:35], s56 offen offset:2048 nt lds
    v_mfma_f32_16x16x32_bf16 v[84:87], a[164:167], v[24:27], v[84:87]
    v_sub_f32 v75, v75, v92
    v_exp_f32 v75, v75
    v_mfma_f32_16x16x32_bf16 v[84:87], a[160:163], v[20:23], v[84:87]
    v_add_f32 v15, v15, v75
    v_cvt_pk_bf16_f32 v53, v74, v75
    v_mfma_f32_16x16x32_bf16 v[128:131], a[112:115], v[60:63], v[128:131]
    v_sub_f32 v76, v76, v92
    v_exp_f32 v76, v76
    v_mfma_f32_16x16x32_bf16 v[128:131], a[176:179], v[16:19], v[128:131]
    v_add_f32 v15, v15, v76
    v_add_f32 v15, v15, v74
    v_mfma_f32_16x16x32_bf16 v[132:135], a[180:183], v[16:19], v[132:135]
    v_sub_f32 v77, v77, v92
    v_exp_f32 v77, v77
    v_mfma_f32_16x16x32_bf16 v[132:135], a[116:119], v[60:63], v[132:135]
    v_add_f32 v15, v15, v77
    v_cvt_pk_bf16_f32 v54, v76, v77
    v_mfma_f32_16x16x32_bf16 v[136:139], a[120:123], v[60:63], v[136:139]
    v_sub_f32 v78, v78, v92
    v_exp_f32 v78, v78
    v_mfma_f32_16x16x32_bf16 v[136:139], a[184:187], v[16:19], v[136:139]
    v_add_f32 v15, v15, v78
    v_add_u32 v12, s65, v12
    v_mfma_f32_16x16x32_bf16 v[140:143], a[188:191], v[16:19], v[140:143]
    v_sub_f32 v79, v79, v92
    v_exp_f32 v79, v79
    v_mfma_f32_16x16x32_bf16 v[140:143], a[124:127], v[60:63], v[140:143]
    v_add_f32 v15, v15, v79
    v_cvt_pk_bf16_f32 v55, v78, v79
    v_mfma_f32_16x16x32_bf16 v[64:67], a[80:83], v[36:39], 0
    v_accvgpr_read_b32 v92, a254
    v_sub_f32 v80, v80, v92
    v_exp_f32 v80, v80
    v_mfma_f32_16x16x32_bf16 v[64:67], a[84:87], v[40:43], v[64:67]
    v_add_f32 v15, v15, v80
    v_add_u32 v13, s65, v13
    v_mfma_f32_16x16x32_bf16 v[64:67], a[88:91], v[44:47], v[64:67]
    v_sub_f32 v81, v81, v92
    v_exp_f32 v81, v81
    v_mfma_f32_16x16x32_bf16 v[64:67], a[92:95], v[48:51], v[64:67]
    v_cvt_pk_bf16_f32 v56, v80, v81
    v_add_f32 v15, v15, v81
    v_mfma_f32_16x16x32_bf16 v[68:71], a[108:111], v[48:51], 0
    s_add_u32 m0, s58, 96
    v_sub_f32 v82, v82, v92
    v_exp_f32 v82, v82
    v_mfma_f32_16x16x32_bf16 v[68:71], a[104:107], v[44:47], v[68:71]
    buffer_load_dwordx4 v88, s[32:35], s56 offen offset:3072 nt lds
    v_mfma_f32_16x16x32_bf16 v[68:71], a[100:103], v[40:43], v[68:71]
    v_sub_f32 v83, v83, v92
    v_exp_f32 v83, v83
    v_mfma_f32_16x16x32_bf16 v[68:71], a[96:99], v[36:39], v[68:71]
    v_cvt_pk_bf16_f32 v57, v82, v83
    v_add_f32 v15, v15, v83
    v_mfma_f32_16x16x32_bf16 v[144:147], a[128:131], v[60:63], v[144:147]
    v_sub_f32 v84, v84, v92
    v_exp_f32 v84, v84
    v_mfma_f32_16x16x32_bf16 v[144:147], a[192:195], v[16:19], v[144:147]
    v_add_f32 v15, v15, v84
    v_add_f32 v15, v15, v82
    v_mfma_f32_16x16x32_bf16 v[148:151], a[196:199], v[16:19], v[148:151]
    v_sub_f32 v85, v85, v92
    v_exp_f32 v85, v85
    v_mfma_f32_16x16x32_bf16 v[148:151], a[132:135], v[60:63], v[148:151]
    v_cvt_pk_bf16_f32 v58, v84, v85
    v_add_f32 v15, v15, v85
    v_mfma_f32_16x16x32_bf16 v[152:155], a[136:139], v[60:63], v[152:155]
    v_sub_f32 v86, v86, v92
    v_exp_f32 v86, v86
    v_mfma_f32_16x16x32_bf16 v[152:155], a[200:203], v[16:19], v[152:155]
    v_add_f32 v15, v15, v86
    v_mfma_f32_16x16x32_bf16 v[156:159], a[204:207], v[16:19], v[156:159]
    v_sub_f32 v87, v87, v92
    v_exp_f32 v87, v87
    v_mfma_f32_16x16x32_bf16 v[156:159], a[140:143], v[60:63], v[156:159]
    s_waitcnt vmcnt(8)
    v_cvt_pk_bf16_f32 v59, v86, v87
    v_add_f32 v15, v15, v87
    v_mfma_f32_16x16x32_bf16 v[72:75], a[144:147], v[36:39], 0
    s_barrier
    v_accvgpr_read_b32 v92, a255
    v_sub_f32 v64, v64, v92
    v_exp_f32 v64, v64
    v_mfma_f32_16x16x32_bf16 v[72:75], a[148:151], v[40:43], v[72:75]
    ds_read_b128 a[144:147], v11 offset:0
    v_add_f32 v89, v89, v64
    v_mfma_f32_16x16x32_bf16 v[72:75], a[152:155], v[44:47], v[72:75]
    v_sub_f32 v65, v65, v92
    v_exp_f32 v65, v65
    v_mfma_f32_16x16x32_bf16 v[72:75], a[156:159], v[48:51], v[72:75]
    ds_read_b128 a[152:155], v11 offset:128
    v_add_f32 v89, v89, v65
    v_cvt_pk_bf16_f32 v60, v64, v65
    v_mfma_f32_16x16x32_bf16 v[76:79], a[172:175], v[48:51], 0
    s_add_u32 m0, s57, 0
    v_sub_f32 v66, v66, v92
    v_exp_f32 v66, v66
    v_mfma_f32_16x16x32_bf16 v[76:79], a[168:171], v[44:47], v[76:79]
    buffer_load_dwordx4 v88, s[28:31], s55 offen offset:0 nt lds
    v_mfma_f32_16x16x32_bf16 v[76:79], a[164:167], v[40:43], v[76:79]
    s_add_u32 s56, s56, 16384
    v_sub_f32 v67, v67, v92
    v_exp_f32 v67, v67
    v_mfma_f32_16x16x32_bf16 v[76:79], a[160:163], v[36:39], v[76:79]
    s_and_b32 s56, s56, 0x3ffff
    ds_read_b128 a[156:159], v11 offset:192
    v_add_f32 v89, v89, v67
    v_cvt_pk_bf16_f32 v61, v66, v67
    v_mfma_f32_16x16x32_bf16 v[160:163], a[112:115], v[52:55], v[160:163]
    s_add_u32 s58, s57, 16896
    v_sub_f32 v68, v68, v92
    v_exp_f32 v68, v68
    v_mfma_f32_16x16x32_bf16 v[160:163], a[176:179], v[56:59], v[160:163]
    s_add_u32 s47, s47, s65
    ds_read_b128 a[172:175], v11 offset:448
    v_add_f32 v89, v89, v68
    v_add_f32 v89, v89, v66
    v_mfma_f32_16x16x32_bf16 v[164:167], a[180:183], v[56:59], v[164:167]
    v_sub_f32 v69, v69, v92
    v_exp_f32 v69, v69
    v_mfma_f32_16x16x32_bf16 v[164:167], a[116:119], v[52:55], v[164:167]
    ds_read_b128 a[164:167], v11 offset:320
    v_add_f32 v89, v89, v69
    v_cvt_pk_bf16_f32 v62, v68, v69
    v_mfma_f32_16x16x32_bf16 v[168:171], a[120:123], v[52:55], v[168:171]
    v_sub_f32 v70, v70, v92
    v_exp_f32 v70, v70
    v_mfma_f32_16x16x32_bf16 v[168:171], a[184:187], v[56:59], v[168:171]
    ds_read_b128 a[148:151], v11 offset:64
    v_add_f32 v89, v89, v70
    v_mfma_f32_16x16x32_bf16 v[172:175], a[188:191], v[56:59], v[172:175]
    v_sub_f32 v71, v71, v92
    v_exp_f32 v71, v71
    v_mfma_f32_16x16x32_bf16 v[172:175], a[124:127], v[52:55], v[172:175]
    v_add_f32 v89, v89, v71
    v_cvt_pk_bf16_f32 v63, v70, v71
    v_mfma_f32_16x16x32_bf16 v[80:83], a[80:83], a[64:67], 0
    v_accvgpr_read_b32 v92, a255
    v_sub_f32 v72, v72, v92
    v_exp_f32 v72, v72
    v_mfma_f32_16x16x32_bf16 v[80:83], a[84:87], a[68:71], v[80:83]
    ds_read_b128 a[80:83], v10 offset:0
    ds_read_b128 a[84:87], v10 offset:64
    v_mfma_f32_16x16x32_bf16 v[80:83], a[88:91], a[72:75], v[80:83]
    v_sub_f32 v73, v73, v92
    v_exp_f32 v73, v73
    v_mfma_f32_16x16x32_bf16 v[80:83], a[92:95], a[76:79], v[80:83]
    ds_read_b128 a[88:91], v10 offset:128
    ds_read_b128 a[92:95], v10 offset:192
    v_mfma_f32_16x16x32_bf16 v[84:87], a[108:111], a[76:79], 0
    v_sub_f32 v74, v74, v92
    v_exp_f32 v74, v74
    v_mfma_f32_16x16x32_bf16 v[84:87], a[104:107], a[72:75], v[84:87]
    ds_read_b128 a[108:111], v10 offset:448
    ds_read_b128 a[104:107], v10 offset:384
    v_mfma_f32_16x16x32_bf16 v[84:87], a[100:103], a[68:71], v[84:87]
    v_sub_f32 v75, v75, v92
    v_exp_f32 v75, v75
    v_mfma_f32_16x16x32_bf16 v[84:87], a[96:99], a[64:67], v[84:87]
    ds_read_b128 a[100:103], v10 offset:320
    ds_read_b128 a[96:99], v10 offset:256
    v_mfma_f32_16x16x32_bf16 v[176:179], a[128:131], v[52:55], v[176:179]
    s_add_u32 m0, s57, 32
    v_sub_f32 v76, v76, v92
    v_exp_f32 v76, v76
    v_mfma_f32_16x16x32_bf16 v[176:179], a[192:195], v[56:59], v[176:179]
    buffer_load_dwordx4 v88, s[28:31], s55 offen offset:1024 nt lds
    v_mfma_f32_16x16x32_bf16 v[180:183], a[196:199], v[56:59], v[180:183]
    v_sub_f32 v77, v77, v92
    v_exp_f32 v77, v77
    v_mfma_f32_16x16x32_bf16 v[180:183], a[132:135], v[52:55], v[180:183]
    v_cvt_pk_bf16_f32 v18, v76, v77
    v_cvt_pk_bf16_f32 v17, v74, v75
    v_mfma_f32_16x16x32_bf16 v[184:187], a[136:139], v[52:55], v[184:187]
    v_sub_f32 v78, v78, v92
    v_exp_f32 v78, v78
    v_mfma_f32_16x16x32_bf16 v[184:187], a[200:203], v[56:59], v[184:187]
    v_add_f32 v89, v89, v78
    v_cvt_pk_bf16_f32 v16, v72, v73
    v_mfma_f32_16x16x32_bf16 v[188:191], a[204:207], v[56:59], v[188:191]
    v_sub_f32 v79, v79, v92
    v_exp_f32 v79, v79
    v_mfma_f32_16x16x32_bf16 v[188:191], a[140:143], v[52:55], v[188:191]
    s_waitcnt lgkmcnt(0)
    v_cvt_pk_bf16_f32 v19, v78, v79
    v_add_f32 v89, v89, v79
    v_mfma_f32_16x16x32_bf16 v[64:67], a[80:83], a[0:3], 0
    v_sub_f32 v80, v80, v9
    v_exp_f32 v80, v80
    v_mfma_f32_16x16x32_bf16 v[64:67], a[84:87], a[4:7], v[64:67]
    v_add_f32 v89, v89, v77
    v_add_f32 v89, v89, v76
    v_mfma_f32_16x16x32_bf16 v[64:67], a[88:91], a[8:11], v[64:67]
    s_add_u32 m0, s57, 64
    v_sub_f32 v81, v81, v9
    v_exp_f32 v81, v81
    v_mfma_f32_16x16x32_bf16 v[64:67], a[92:95], a[12:15], v[64:67]
    buffer_load_dwordx4 v88, s[28:31], s55 offen offset:2048 nt lds
    v_mfma_f32_16x16x32_bf16 v[68:71], a[108:111], a[12:15], 0
    v_sub_f32 v82, v82, v9
    v_exp_f32 v82, v82
    v_mfma_f32_16x16x32_bf16 v[68:71], a[104:107], a[8:11], v[68:71]
    v_cvt_pk_bf16_f32 v56, v80, v81
    v_add_f32 v89, v89, v75
    v_mfma_f32_16x16x32_bf16 v[68:71], a[100:103], a[4:7], v[68:71]
    v_sub_f32 v83, v83, v9
    v_exp_f32 v83, v83
    v_mfma_f32_16x16x32_bf16 v[68:71], a[96:99], a[0:3], v[68:71]
    v_cvt_pk_bf16_f32 v57, v82, v83
    v_add_f32 v89, v89, v74
    v_mfma_f32_16x16x32_bf16 v[192:195], a[112:115], v[60:63], v[192:195]
    v_sub_f32 v84, v84, v9
    v_exp_f32 v84, v84
    v_mfma_f32_16x16x32_bf16 v[192:195], a[176:179], v[16:19], v[192:195]
    v_add_f32 v89, v89, v73
    v_add_f32 v89, v89, v72
    v_mfma_f32_16x16x32_bf16 v[196:199], a[180:183], v[16:19], v[196:199]
    s_add_u32 m0, s57, 96
    v_sub_f32 v85, v85, v9
    v_exp_f32 v85, v85
    v_mfma_f32_16x16x32_bf16 v[196:199], a[116:119], v[60:63], v[196:199]
    buffer_load_dwordx4 v88, s[28:31], s55 offen offset:3072 nt lds
    v_mfma_f32_16x16x32_bf16 v[200:203], a[120:123], v[60:63], v[200:203]
    s_add_u32 s55, s55, 16384
    v_sub_f32 v86, v86, v9
    v_exp_f32 v86, v86
    v_mfma_f32_16x16x32_bf16 v[200:203], a[184:187], v[16:19], v[200:203]
    s_and_b32 s55, s55, 0x3ffff
    ds_read_b128 a[168:171], v11 offset:384
    v_cvt_pk_bf16_f32 v58, v84, v85
    v_mfma_f32_16x16x32_bf16 v[204:207], a[188:191], v[16:19], v[204:207]
    s_add_u32 s59, s59, 1
    v_sub_f32 v87, v87, v9
    v_exp_f32 v87, v87
    v_mfma_f32_16x16x32_bf16 v[204:207], a[124:127], v[60:63], v[204:207]
    s_cmp_lt_u32 s59, 13
    ds_read_b128 a[160:163], v11 offset:256
    v_cvt_pk_bf16_f32 v59, v86, v87
    s_cbranch_scc1 L_stile
    v_add_u32 v93, 135168, v1
    v_mfma_f32_16x16x32_bf16 v[72:75], a[144:147], a[0:3], 0
    v_accvgpr_read_b32 v92, a252
    v_sub_f32 v64, v64, v92
    v_exp_f32 v64, v64
    v_mfma_f32_16x16x32_bf16 v[72:75], a[148:151], a[4:7], v[72:75]
    ds_read_b64_tr_b16 a[176:177], v13 offset:0
    ds_read_b64_tr_b16 a[178:179], v13 offset:256
    ds_read_b64_tr_b16 a[188:189], v13 offset:96
    v_mfma_f32_16x16x32_bf16 v[72:75], a[152:155], a[8:11], v[72:75]
    v_sub_f32 v65, v65, v92
    v_exp_f32 v65, v65
    v_mfma_f32_16x16x32_bf16 v[72:75], a[156:159], a[12:15], v[72:75]
    s_add_u32 m0, s58, 0
    ds_read_b64_tr_b16 a[180:181], v13 offset:32
    ds_read_b64_tr_b16 a[190:191], v13 offset:352
    v_cvt_pk_bf16_f32 v52, v64, v65
    v_mfma_f32_16x16x32_bf16 v[76:79], a[172:175], a[12:15], 0
    s_waitcnt lgkmcnt(6)
    v_sub_f32 v66, v66, v92
    v_exp_f32 v66, v66
    v_mfma_f32_16x16x32_bf16 v[76:79], a[168:171], a[8:11], v[76:79]
    buffer_load_dwordx4 v88, s[32:35], s56 offen offset:0 nt lds
    v_mfma_f32_16x16x32_bf16 v[76:79], a[164:167], a[4:7], v[76:79]
    s_waitcnt lgkmcnt(5)
    v_sub_f32 v67, v67, v92
    v_exp_f32 v67, v67
    v_mfma_f32_16x16x32_bf16 v[76:79], a[160:163], a[0:3], v[76:79]
    ds_read_b64_tr_b16 a[182:183], v13 offset:288
    v_cvt_pk_bf16_f32 v53, v66, v67
    v_mfma_f32_16x16x32_bf16 v[224:227], a[112:115], v[56:59], v[224:227]
    v_sub_f32 v68, v68, v92
    v_exp_f32 v68, v68
    v_mfma_f32_16x16x32_bf16 v[228:231], a[116:119], v[56:59], v[228:231]
    ds_read_b64_tr_b16 a[112:113], v12 offset:0
    ds_read_b64_tr_b16 a[114:115], v12 offset:256
    v_mfma_f32_16x16x32_bf16 v[232:235], a[120:123], v[56:59], v[232:235]
    s_add_u32 m0, s58, 32
    v_sub_f32 v69, v69, v92
    v_exp_f32 v69, v69
    v_mfma_f32_16x16x32_bf16 v[236:239], a[124:127], v[56:59], v[236:239]
    buffer_load_dwordx4 v88, s[32:35], s56 offen offset:1024 nt lds
    v_mfma_f32_16x16x32_bf16 v[240:243], a[128:131], v[56:59], v[240:243]
    v_sub_f32 v70, v70, v92
    v_exp_f32 v70, v70
    v_mfma_f32_16x16x32_bf16 v[244:247], a[132:135], v[56:59], v[244:247]
    ds_read_b64_tr_b16 a[116:117], v12 offset:32
    v_cvt_pk_bf16_f32 v54, v68, v69
    v_mfma_f32_16x16x32_bf16 v[248:251], a[136:139], v[56:59], v[248:251]
    v_sub_f32 v71, v71, v92
    v_exp_f32 v71, v71
    v_mfma_f32_16x16x32_bf16 v[252:255], a[140:143], v[56:59], v[252:255]
    ds_read_b64_tr_b16 a[118:119], v12 offset:288
    v_cvt_pk_bf16_f32 v55, v70, v71
    v_mfma_f32_16x16x32_bf16 a[244:247], a[248:251], v[56:59], a[244:247]
    ds_read_b64_tr_b16 a[120:121], v12 offset:64
    ds_read_b64_tr_b16 a[122:123], v12 offset:320
    v_mfma_f32_16x16x32_bf16 v[80:83], a[80:83], a[16:19], 0
    v_accvgpr_read_b32 v92, a252
    v_sub_f32 v72, v72, v92
    v_exp_f32 v72, v72
    v_mfma_f32_16x16x32_bf16 v[80:83], a[84:87], a[20:23], v[80:83]
    ds_read_b64_tr_b16 a[124:125], v12 offset:96
    ds_read_b64_tr_b16 a[126:127], v12 offset:352
    v_add_u32 v10, 33792, v10
    v_mfma_f32_16x16x32_bf16 v[80:83], a[88:91], a[24:27], v[80:83]
    v_sub_f32 v73, v73, v92
    v_exp_f32 v73, v73
    v_mfma_f32_16x16x32_bf16 v[80:83], a[92:95], a[28:31], v[80:83]
    ds_read_b64_tr_b16 a[184:185], v13 offset:64
    v_cvt_pk_bf16_f32 v56, v72, v73
    v_add_u32 v11, 33792, v11
    v_mfma_f32_16x16x32_bf16 v[84:87], a[108:111], a[28:31], 0
    s_add_u32 m0, s58, 64
    v_sub_f32 v74, v74, v92
    v_exp_f32 v74, v74
    v_mfma_f32_16x16x32_bf16 v[84:87], a[104:107], a[24:27], v[84:87]
    buffer_load_dwordx4 v88, s[32:35], s56 offen offset:2048 nt lds
    v_mfma_f32_16x16x32_bf16 v[84:87], a[100:103], a[20:23], v[84:87]
    v_sub_f32 v75, v75, v92
    v_exp_f32 v75, v75
    v_mfma_f32_16x16x32_bf16 v[84:87], a[96:99], a[16:19], v[84:87]
    ds_read_b64_tr_b16 a[186:187], v13 offset:320
    v_cvt_pk_bf16_f32 v57, v74, v75
    v_mfma_f32_16x16x32_bf16 v[208:211], a[128:131], v[60:63], v[208:211]
    v_sub_f32 v76, v76, v92
    v_exp_f32 v76, v76
    v_mfma_f32_16x16x32_bf16 v[208:211], a[192:195], v[16:19], v[208:211]
    ds_read_b64_tr_b16 a[128:129], v12 offset:128
    ds_read_b64_tr_b16 a[130:131], v12 offset:384
    v_mfma_f32_16x16x32_bf16 v[212:215], a[196:199], v[16:19], v[212:215]
    s_add_u32 m0, s58, 96
    v_sub_f32 v77, v77, v92
    v_exp_f32 v77, v77
    v_mfma_f32_16x16x32_bf16 v[212:215], a[132:135], v[60:63], v[212:215]
    buffer_load_dwordx4 v88, s[32:35], s56 offen offset:3072 nt lds
    v_mfma_f32_16x16x32_bf16 v[216:219], a[136:139], v[60:63], v[216:219]
    v_sub_f32 v78, v78, v92
    v_exp_f32 v78, v78
    v_mfma_f32_16x16x32_bf16 v[216:219], a[200:203], v[16:19], v[216:219]
    ds_read_b64_tr_b16 a[192:193], v13 offset:128
    v_cvt_pk_bf16_f32 v58, v76, v77
    v_mfma_f32_16x16x32_bf16 v[220:223], a[204:207], v[16:19], v[220:223]
    v_sub_f32 v79, v79, v92
    v_exp_f32 v79, v79
    v_mfma_f32_16x16x32_bf16 v[220:223], a[140:143], v[60:63], v[220:223]
    ds_read_b64_tr_b16 a[194:195], v13 offset:384
    v_cvt_pk_bf16_f32 v59, v78, v79
    v_mfma_f32_16x16x32_bf16 v[64:67], a[144:147], a[16:19], 0
    v_accvgpr_read_b32 v92, a253
    v_sub_f32 v80, v80, v92
    v_exp_f32 v80, v80
    v_mfma_f32_16x16x32_bf16 v[64:67], a[148:151], a[20:23], v[64:67]
    ds_read_b64_tr_b16 a[196:197], v13 offset:160
    ds_read_b64_tr_b16 a[198:199], v13 offset:416
    v_add_f32 v14, v14, v80
    v_mfma_f32_16x16x32_bf16 v[64:67], a[152:155], a[24:27], v[64:67]
    v_sub_f32 v81, v81, v92
    v_exp_f32 v81, v81
    v_mfma_f32_16x16x32_bf16 v[64:67], a[156:159], a[28:31], v[64:67]
    s_xor_b32 s45, s52, 0
    ds_read_b64_tr_b16 a[132:133], v12 offset:160
    ds_read_b64_tr_b16 a[134:135], v12 offset:416
    v_add_f32 v14, v14, v81
    v_mfma_f32_16x16x32_bf16 v[68:71], a[172:175], a[28:31], 0
    s_add_u32 m0, s60, 101376
    v_sub_f32 v82, v82, v92
    v_exp_f32 v82, v82
    v_mfma_f32_16x16x32_bf16 v[68:71], a[168:171], a[24:27], v[68:71]
    buffer_load_dwordx4 v90, s[80:83], s45 offen offset:0 lds
    v_mfma_f32_16x16x32_bf16 v[68:71], a[164:167], a[20:23], v[68:71]
    v_sub_f32 v83, v83, v92
    v_exp_f32 v83, v83
    v_mfma_f32_16x16x32_bf16 v[68:71], a[160:163], a[16:19], v[68:71]
    s_waitcnt lgkmcnt(2)
    ds_read_b64_tr_b16 a[136:137], v12 offset:192
    ds_read_b64_tr_b16 a[138:139], v12 offset:448
    v_add_f32 v14, v14, v82
    v_mfma_f32_16x16x32_bf16 v[96:99], a[112:115], v[52:55], v[96:99]
    v_sub_f32 v84, v84, v92
    v_exp_f32 v84, v84
    v_mfma_f32_16x16x32_bf16 v[96:99], a[176:179], v[56:59], v[96:99]
    ds_read_b64_tr_b16 a[200:201], v13 offset:192
    v_add_f32 v14, v14, v84
    v_cvt_pk_bf16_f32 v60, v80, v81
    v_mfma_f32_16x16x32_bf16 v[100:103], a[180:183], v[56:59], v[100:103]
    s_add_u32 m0, s60, 101408
    v_sub_f32 v85, v85, v92
    v_exp_f32 v85, v85
    v_mfma_f32_16x16x32_bf16 v[100:103], a[116:119], v[52:55], v[100:103]
    buffer_load_dwordx4 v90, s[80:83], s45 offen offset:1024 lds
    v_mfma_f32_16x16x32_bf16 v[104:107], a[120:123], v[52:55], v[104:107]
    v_sub_f32 v86, v86, v92
    v_exp_f32 v86, v86
    v_mfma_f32_16x16x32_bf16 v[104:107], a[184:187], v[56:59], v[104:107]
    v_add_f32 v14, v14, v86
    v_add_f32 v14, v14, v85
    v_mfma_f32_16x16x32_bf16 v[108:111], a[188:191], v[56:59], v[108:111]
    v_sub_f32 v87, v87, v92
    v_exp_f32 v87, v87
    v_mfma_f32_16x16x32_bf16 v[108:111], a[124:127], v[52:55], v[108:111]
    v_add_f32 v14, v14, v87
    v_cvt_pk_bf16_f32 v63, v86, v87
    v_mfma_f32_16x16x32_bf16 a[240:243], a[248:251], v[52:55], a[240:243]
    ds_read_b64_tr_b16 a[202:203], v13 offset:448
    v_cvt_pk_bf16_f32 v62, v84, v85
    v_mfma_f32_16x16x32_bf16 a[240:243], a[248:251], v[56:59], a[240:243]
    ds_read_b64_tr_b16 a[204:205], v13 offset:224
    ds_read_b64_tr_b16 a[206:207], v13 offset:480
    v_mfma_f32_16x16x32_bf16 v[72:75], a[80:83], v[20:23], 0
    v_accvgpr_read_b32 v92, a253
    v_sub_f32 v64, v64, v92
    v_exp_f32 v64, v64
    v_mfma_f32_16x16x32_bf16 v[72:75], a[84:87], v[24:27], v[72:75]
    ds_read_b64_tr_b16 a[140:141], v12 offset:224
    ds_read_b64_tr_b16 a[142:143], v12 offset:480
    v_add_f32 v14, v14, v64
    v_mfma_f32_16x16x32_bf16 v[72:75], a[88:91], v[28:31], v[72:75]
    v_sub_f32 v65, v65, v92
    v_exp_f32 v65, v65
    v_mfma_f32_16x16x32_bf16 v[72:75], a[92:95], v[32:35], v[72:75]
    v_cvt_pk_bf16_f32 v16, v64, v65
    v_add_f32 v14, v14, v83
    v_mfma_f32_16x16x32_bf16 v[76:79], a[108:111], v[32:35], 0
    s_add_u32 m0, s60, 101440
    v_sub_f32 v66, v66, v92
    v_exp_f32 v66, v66
    v_mfma_f32_16x16x32_bf16 v[76:79], a[104:107], v[28:31], v[76:79]
    buffer_load_dwordx4 v90, s[80:83], s45 offen offset:2048 lds
    v_mfma_f32_16x16x32_bf16 v[76:79], a[100:103], v[24:27], v[76:79]
    v_sub_f32 v67, v67, v92
    v_exp_f32 v67, v67
    v_mfma_f32_16x16x32_bf16 v[76:79], a[96:99], v[20:23], v[76:79]
    v_cvt_pk_bf16_f32 v17, v66, v67
    v_add_f32 v14, v14, v67
    v_mfma_f32_16x16x32_bf16 v[112:115], a[128:131], v[52:55], v[112:115]
    v_sub_f32 v68, v68, v92
    v_exp_f32 v68, v68
    v_mfma_f32_16x16x32_bf16 v[112:115], a[192:195], v[56:59], v[112:115]
    s_add_u32 m0, s60, 101472
    v_add_f32 v14, v14, v68
    v_cvt_pk_bf16_f32 v61, v82, v83
    v_mfma_f32_16x16x32_bf16 v[116:119], a[196:199], v[56:59], v[116:119]
    s_waitcnt lgkmcnt(0)
    v_sub_f32 v69, v69, v92
    v_exp_f32 v69, v69
    v_mfma_f32_16x16x32_bf16 v[116:119], a[132:135], v[52:55], v[116:119]
    buffer_load_dwordx4 v90, s[80:83], s45 offen offset:3072 lds
    v_mfma_f32_16x16x32_bf16 v[120:123], a[136:139], v[52:55], v[120:123]
    v_sub_f32 v70, v70, v92
    v_exp_f32 v70, v70
    v_mfma_f32_16x16x32_bf16 v[120:123], a[200:203], v[56:59], v[120:123]
    v_cvt_pk_bf16_f32 v18, v68, v69
    v_add_f32 v14, v14, v70
    v_mfma_f32_16x16x32_bf16 v[124:127], a[204:207], v[56:59], v[124:127]
    v_sub_f32 v71, v71, v92
    v_exp_f32 v71, v71
    v_mfma_f32_16x16x32_bf16 v[124:127], a[140:143], v[52:55], v[124:127]
    v_cvt_pk_bf16_f32 v19, v70, v71
    v_add_f32 v14, v14, v71
    v_mfma_f32_16x16x32_bf16 v[80:83], a[144:147], v[20:23], 0
    v_accvgpr_read_b32 v92, a254
    v_sub_f32 v72, v72, v92
    v_exp_f32 v72, v72
    v_mfma_f32_16x16x32_bf16 v[80:83], a[148:151], v[24:27], v[80:83]
    v_add_f32 v14, v14, v69
    v_add_f32 v14, v14, v66
    v_add_f32 v15, v15, v72
    v_mfma_f32_16x16x32_bf16 v[80:83], a[152:155], v[28:31], v[80:83]
    v_sub_f32 v73, v73, v92
    v_exp_f32 v73, v73
    v_mfma_f32_16x16x32_bf16 v[80:83], a[156:159], v[32:35], v[80:83]
    s_xor_b32 s45, s52, 32768
    v_add_f32 v14, v14, v65
    v_add_f32 v15, v15, v73
    v_add_u32 v12, 33792, v12
    v_mfma_f32_16x16x32_bf16 v[84:87], a[172:175], v[32:35], 0
    s_add_u32 m0, s60, 118272
    v_sub_f32 v74, v74, v92
    v_exp_f32 v74, v74
    v_mfma_f32_16x16x32_bf16 v[84:87], a[168:171], v[28:31], v[84:87]
    buffer_load_dwordx4 v90, s[80:83], s45 offen offset:0 lds
    v_mfma_f32_16x16x32_bf16 v[84:87], a[164:167], v[24:27], v[84:87]
    v_sub_f32 v75, v75, v92
    v_exp_f32 v75, v75
    v_mfma_f32_16x16x32_bf16 v[84:87], a[160:163], v[20:23], v[84:87]
    v_add_f32 v15, v15, v75
    v_cvt_pk_bf16_f32 v53, v74, v75
    v_add_u32 v13, 33792, v13
    v_mfma_f32_16x16x32_bf16 v[128:131], a[112:115], v[60:63], v[128:131]
    v_sub_f32 v76, v76, v92
    v_exp_f32 v76, v76
    v_mfma_f32_16x16x32_bf16 v[128:131], a[176:179], v[16:19], v[128:131]
    v_add_f32 v15, v15, v76
    v_add_f32 v15, v15, v74
    v_mfma_f32_16x16x32_bf16 v[132:135], a[180:183], v[16:19], v[132:135]
    s_add_u32 m0, s60, 118304
    v_sub_f32 v77, v77, v92
    v_exp_f32 v77, v77
    v_mfma_f32_16x16x32_bf16 v[132:135], a[116:119], v[60:63], v[132:135]
    buffer_load_dwordx4 v90, s[80:83], s45 offen offset:1024 lds
    v_mfma_f32_16x16x32_bf16 v[136:139], a[120:123], v[60:63], v[136:139]
    v_sub_f32 v78, v78, v92
    v_exp_f32 v78, v78
    v_mfma_f32_16x16x32_bf16 v[136:139], a[184:187], v[16:19], v[136:139]
    v_add_f32 v15, v15, v78
    v_add_f32 v15, v15, v77
    v_mfma_f32_16x16x32_bf16 v[140:143], a[188:191], v[16:19], v[140:143]
    v_sub_f32 v79, v79, v92
    v_exp_f32 v79, v79
    v_mfma_f32_16x16x32_bf16 v[140:143], a[124:127], v[60:63], v[140:143]
    v_add_f32 v15, v15, v79
    v_cvt_pk_bf16_f32 v55, v78, v79
    v_mfma_f32_16x16x32_bf16 v[64:67], a[80:83], v[36:39], 0
    v_accvgpr_read_b32 v92, a254
    v_sub_f32 v80, v80, v92
    v_exp_f32 v80, v80
    v_mfma_f32_16x16x32_bf16 v[64:67], a[84:87], v[40:43], v[64:67]
    v_cvt_pk_bf16_f32 v54, v76, v77
    v_cvt_pk_bf16_f32 v52, v72, v73
    v_mfma_f32_16x16x32_bf16 v[64:67], a[88:91], v[44:47], v[64:67]
    v_sub_f32 v81, v81, v92
    v_exp_f32 v81, v81
    v_mfma_f32_16x16x32_bf16 v[64:67], a[92:95], v[48:51], v[64:67]
    v_cvt_pk_bf16_f32 v56, v80, v81
    v_add_f32 v15, v15, v81
    v_mfma_f32_16x16x32_bf16 v[68:71], a[108:111], v[48:51], 0
    s_add_u32 m0, s60, 118336
    v_sub_f32 v82, v82, v92
    v_exp_f32 v82, v82
    v_mfma_f32_16x16x32_bf16 v[68:71], a[104:107], v[44:47], v[68:71]
    buffer_load_dwordx4 v90, s[80:83], s45 offen offset:2048 lds
    v_mfma_f32_16x16x32_bf16 v[68:71], a[100:103], v[40:43], v[68:71]
    v_sub_f32 v83, v83, v92
    v_exp_f32 v83, v83
    v_mfma_f32_16x16x32_bf16 v[68:71], a[96:99], v[36:39], v[68:71]
    v_cvt_pk_bf16_f32 v57, v82, v83
    v_add_f32 v15, v15, v83
    v_mfma_f32_16x16x32_bf16 v[144:147], a[128:131], v[60:63], v[144:147]
    v_sub_f32 v84, v84, v92
    v_exp_f32 v84, v84
    v_mfma_f32_16x16x32_bf16 v[144:147], a[192:195], v[16:19], v[144:147]
    v_add_f32 v15, v15, v84
    v_add_f32 v15, v15, v82
    v_mfma_f32_16x16x32_bf16 v[148:151], a[196:199], v[16:19], v[148:151]
    s_add_u32 m0, s60, 118368
    v_sub_f32 v85, v85, v92
    v_exp_f32 v85, v85
    v_mfma_f32_16x16x32_bf16 v[148:151], a[132:135], v[60:63], v[148:151]
    buffer_load_dwordx4 v90, s[80:83], s45 offen offset:3072 lds
    v_mfma_f32_16x16x32_bf16 v[152:155], a[136:139], v[60:63], v[152:155]
    v_sub_f32 v86, v86, v92
    v_exp_f32 v86, v86
    v_mfma_f32_16x16x32_bf16 v[152:155], a[200:203], v[16:19], v[152:155]
    v_cvt_pk_bf16_f32 v58, v84, v85
    v_add_f32 v15, v15, v86
    v_mfma_f32_16x16x32_bf16 v[156:159], a[204:207], v[16:19], v[156:159]
    v_sub_f32 v87, v87, v92
    v_exp_f32 v87, v87
    v_mfma_f32_16x16x32_bf16 v[156:159], a[140:143], v[60:63], v[156:159]
    v_cvt_pk_bf16_f32 v59, v86, v87
    v_add_f32 v15, v15, v87
    s_waitcnt vmcnt(16)
    s_barrier
    v_mfma_f32_16x16x32_bf16 v[72:75], a[144:147], v[36:39], 0
    v_accvgpr_read_b32 v92, a255
    v_sub_f32 v64, v64, v92
    v_exp_f32 v64, v64
    v_mfma_f32_16x16x32_bf16 v[72:75], a[148:151], v[40:43], v[72:75]
    s_xor_b32 s45, s52, 65536
    v_add_f32 v15, v15, v85
    v_add_f32 v15, v15, v80
    v_add_f32 v89, v89, v64
    v_mfma_f32_16x16x32_bf16 v[72:75], a[152:155], v[44:47], v[72:75]
    s_add_u32 m0, s60, 135168
    v_sub_f32 v65, v65, v92
    v_exp_f32 v65, v65
    v_mfma_f32_16x16x32_bf16 v[72:75], a[156:159], v[48:51], v[72:75]
    buffer_load_dwordx4 v90, s[80:83], s45 offen offset:0 lds
    v_mfma_f32_16x16x32_bf16 v[76:79], a[172:175], v[48:51], 0
    v_sub_f32 v66, v66, v92
    v_exp_f32 v66, v66
    v_mfma_f32_16x16x32_bf16 v[76:79], a[168:171], v[44:47], v[76:79]
    v_add_f32 v89, v89, v66
    v_add_f32 v89, v89, v65
    v_cvt_pk_bf16_f32 v60, v64, v65
    v_mfma_f32_16x16x32_bf16 v[76:79], a[164:167], v[40:43], v[76:79]
    v_sub_f32 v67, v67, v92
    v_exp_f32 v67, v67
    v_mfma_f32_16x16x32_bf16 v[76:79], a[160:163], v[36:39], v[76:79]
    ds_read_b128 a[144:147], v11 offset:0
    v_add_f32 v89, v89, v67
    v_cvt_pk_bf16_f32 v61, v66, v67
    v_mfma_f32_16x16x32_bf16 v[160:163], a[112:115], v[52:55], v[160:163]
    s_add_u32 m0, s60, 135200
    v_sub_f32 v68, v68, v92
    v_exp_f32 v68, v68
    v_mfma_f32_16x16x32_bf16 v[160:163], a[176:179], v[56:59], v[160:163]
    buffer_load_dwordx4 v90, s[80:83], s45 offen offset:1024 lds
    v_mfma_f32_16x16x32_bf16 v[164:167], a[180:183], v[56:59], v[164:167]
    v_sub_f32 v69, v69, v92
    v_exp_f32 v69, v69
    v_mfma_f32_16x16x32_bf16 v[164:167], a[116:119], v[52:55], v[164:167]
    ds_read_b128 a[148:151], v11 offset:64
    v_add_f32 v89, v89, v69
    v_cvt_pk_bf16_f32 v62, v68, v69
    v_mfma_f32_16x16x32_bf16 v[168:171], a[120:123], v[52:55], v[168:171]
    v_sub_f32 v70, v70, v92
    v_exp_f32 v70, v70
    v_mfma_f32_16x16x32_bf16 v[168:171], a[184:187], v[56:59], v[168:171]
    ds_read_b128 a[152:155], v11 offset:128
    v_add_f32 v89, v89, v70
    v_add_f32 v89, v89, v68
    v_mfma_f32_16x16x32_bf16 v[172:175], a[188:191], v[56:59], v[172:175]
    v_sub_f32 v71, v71, v92
    v_exp_f32 v71, v71
    v_mfma_f32_16x16x32_bf16 v[172:175], a[124:127], v[52:55], v[172:175]
    ds_read_b128 a[156:159], v11 offset:192
    v_add_f32 v89, v89, v71
    v_cvt_pk_bf16_f32 v63, v70, v71
    v_mfma_f32_16x16x32_bf16 v[80:83], a[80:83], a[64:67], 0
    v_accvgpr_read_b32 v92, a255
    v_sub_f32 v72, v72, v92
    v_exp_f32 v72, v72
    v_mfma_f32_16x16x32_bf16 v[80:83], a[84:87], a[68:71], v[80:83]
    ds_read_b128 a[80:83], v10 offset:0
    ds_read_b128 a[84:87], v10 offset:64
    v_add_f32 v89, v89, v72
    v_mfma_f32_16x16x32_bf16 v[80:83], a[88:91], a[72:75], v[80:83]
    v_sub_f32 v73, v73, v92
    v_exp_f32 v73, v73
    v_mfma_f32_16x16x32_bf16 v[80:83], a[92:95], a[76:79], v[80:83]
    ds_read_b128 a[88:91], v10 offset:128
    ds_read_b128 a[92:95], v10 offset:192
    v_cvt_pk_bf16_f32 v16, v72, v73
    v_mfma_f32_16x16x32_bf16 v[84:87], a[108:111], a[76:79], 0
    v_sub_f32 v74, v74, v92
    v_exp_f32 v74, v74
    v_mfma_f32_16x16x32_bf16 v[84:87], a[104:107], a[72:75], v[84:87]
    ds_read_b128 a[108:111], v10 offset:448
    ds_read_b128 a[104:107], v10 offset:384
    v_add_f32 v89, v89, v74
    v_mfma_f32_16x16x32_bf16 v[84:87], a[100:103], a[68:71], v[84:87]
    v_sub_f32 v75, v75, v92
    v_exp_f32 v75, v75
    v_mfma_f32_16x16x32_bf16 v[84:87], a[96:99], a[64:67], v[84:87]
    ds_read_b128 a[100:103], v10 offset:320
    ds_read_b128 a[96:99], v10 offset:256
    v_add_f32 v89, v89, v73
    v_mfma_f32_16x16x32_bf16 v[176:179], a[128:131], v[52:55], v[176:179]
    s_add_u32 m0, s60, 135232
    v_sub_f32 v76, v76, v92
    v_exp_f32 v76, v76
    v_mfma_f32_16x16x32_bf16 v[176:179], a[192:195], v[56:59], v[176:179]
    buffer_load_dwordx4 v90, s[80:83], s45 offen offset:2048 lds
    v_mfma_f32_16x16x32_bf16 v[180:183], a[196:199], v[56:59], v[180:183]
    v_sub_f32 v77, v77, v92
    v_exp_f32 v77, v77
    v_mfma_f32_16x16x32_bf16 v[180:183], a[132:135], v[52:55], v[180:183]
    ds_read_b128 a[172:175], v11 offset:448
    v_cvt_pk_bf16_f32 v18, v76, v77
    v_cvt_pk_bf16_f32 v17, v74, v75
    v_mfma_f32_16x16x32_bf16 v[184:187], a[136:139], v[52:55], v[184:187]
    s_add_u32 m0, s60, 135264
    v_sub_f32 v78, v78, v92
    v_exp_f32 v78, v78
    v_mfma_f32_16x16x32_bf16 v[184:187], a[200:203], v[56:59], v[184:187]
    buffer_load_dwordx4 v90, s[80:83], s45 offen offset:3072 lds
    v_mfma_f32_16x16x32_bf16 v[188:191], a[204:207], v[56:59], v[188:191]
    s_xor_b32 s45, s52, 98304
    v_sub_f32 v79, v79, v92
    v_exp_f32 v79, v79
    v_mfma_f32_16x16x32_bf16 v[188:191], a[140:143], v[52:55], v[188:191]
    s_waitcnt lgkmcnt(1)
    ds_read_b128 a[168:171], v11 offset:384
    v_cvt_pk_bf16_f32 v19, v78, v79
    v_add_f32 v89, v89, v79
    v_mfma_f32_16x16x32_bf16 v[64:67], a[80:83], a[0:3], 0
    s_add_u32 m0, s60, 33792
    v_sub_f32 v80, v80, v9
    v_exp_f32 v80, v80
    v_mfma_f32_16x16x32_bf16 v[64:67], a[84:87], a[4:7], v[64:67]
    buffer_load_dwordx4 v90, s[80:83], s45 offen offset:0 lds
    v_mfma_f32_16x16x32_bf16 v[64:67], a[88:91], a[8:11], v[64:67]
    v_sub_f32 v81, v81, v9
    v_exp_f32 v81, v81
    v_mfma_f32_16x16x32_bf16 v[64:67], a[92:95], a[12:15], v[64:67]
    ds_read_b128 a[164:167], v11 offset:320
    v_cvt_pk_bf16_f32 v56, v80, v81
    v_add_f32 v89, v89, v78
    v_mfma_f32_16x16x32_bf16 v[68:71], a[108:111], a[12:15], 0
    s_add_u32 m0, s60, 33824
    v_sub_f32 v82, v82, v9
    v_exp_f32 v82, v82
    v_mfma_f32_16x16x32_bf16 v[68:71], a[104:107], a[8:11], v[68:71]
    buffer_load_dwordx4 v90, s[80:83], s45 offen offset:1024 lds
    v_mfma_f32_16x16x32_bf16 v[68:71], a[100:103], a[4:7], v[68:71]
    v_sub_f32 v83, v83, v9
    v_exp_f32 v83, v83
    v_mfma_f32_16x16x32_bf16 v[68:71], a[96:99], a[0:3], v[68:71]
    ds_read_b128 a[160:163], v11 offset:256
    v_cvt_pk_bf16_f32 v57, v82, v83
    v_add_f32 v89, v89, v77
    v_mfma_f32_16x16x32_bf16 v[192:195], a[112:115], v[60:63], v[192:195]
    s_add_u32 m0, s60, 33856
    v_sub_f32 v84, v84, v9
    v_exp_f32 v84, v84
    v_mfma_f32_16x16x32_bf16 v[192:195], a[176:179], v[16:19], v[192:195]
    buffer_load_dwordx4 v90, s[80:83], s45 offen offset:2048 lds
    v_mfma_f32_16x16x32_bf16 v[196:199], a[180:183], v[16:19], v[196:199]
    v_sub_f32 v85, v85, v9
    v_exp_f32 v85, v85
    v_mfma_f32_16x16x32_bf16 v[196:199], a[116:119], v[60:63], v[196:199]
    v_cvt_pk_bf16_f32 v58, v84, v85
    v_add_f32 v89, v89, v76
    v_mfma_f32_16x16x32_bf16 v[200:203], a[120:123], v[60:63], v[200:203]
    s_add_u32 m0, s60, 33888
    v_sub_f32 v86, v86, v9
    v_exp_f32 v86, v86
    v_mfma_f32_16x16x32_bf16 v[200:203], a[184:187], v[16:19], v[200:203]
    buffer_load_dwordx4 v90, s[80:83], s45 offen offset:3072 lds
    v_mfma_f32_16x16x32_bf16 v[204:207], a[188:191], v[16:19], v[204:207]
    v_sub_f32 v87, v87, v9
    v_exp_f32 v87, v87
    v_mfma_f32_16x16x32_bf16 v[204:207], a[124:127], v[60:63], v[204:207]
    v_cvt_pk_bf16_f32 v59, v86, v87
    v_add_f32 v89, v89, v75
    v_mfma_f32_16x16x32_bf16 v[72:75], a[144:147], a[0:3], 0
    v_accvgpr_read_b32 v92, a252
    v_sub_f32 v64, v64, v92
    v_exp_f32 v64, v64
    v_mfma_f32_16x16x32_bf16 v[72:75], a[148:151], a[4:7], v[72:75]
    ds_read_b64_tr_b16 a[176:177], v13 offset:0
    ds_read_b64_tr_b16 a[178:179], v13 offset:256
    ds_read_b64_tr_b16 a[188:189], v13 offset:96
    v_mfma_f32_16x16x32_bf16 v[72:75], a[152:155], a[8:11], v[72:75]
    s_xor_b32 s45, s52, 131072
    v_sub_f32 v65, v65, v92
    v_exp_f32 v65, v65
    v_mfma_f32_16x16x32_bf16 v[72:75], a[156:159], a[12:15], v[72:75]
    s_waitcnt lgkmcnt(3)
    ds_read_b64_tr_b16 a[180:181], v13 offset:32
    ds_read_b64_tr_b16 a[190:191], v13 offset:352
    v_cvt_pk_bf16_f32 v52, v64, v65
    v_mfma_f32_16x16x32_bf16 v[76:79], a[172:175], a[12:15], 0
    s_add_u32 m0, s60, 50688
    v_sub_f32 v66, v66, v92
    v_exp_f32 v66, v66
    v_mfma_f32_16x16x32_bf16 v[76:79], a[168:171], a[8:11], v[76:79]
    buffer_load_dwordx4 v90, s[80:83], s45 offen offset:0 lds
    v_mfma_f32_16x16x32_bf16 v[76:79], a[164:167], a[4:7], v[76:79]
    v_sub_f32 v67, v67, v92
    v_exp_f32 v67, v67
    v_mfma_f32_16x16x32_bf16 v[76:79], a[160:163], a[0:3], v[76:79]
    ds_read_b64_tr_b16 a[182:183], v13 offset:288
    v_cvt_pk_bf16_f32 v53, v66, v67
    v_mfma_f32_16x16x32_bf16 v[224:227], a[112:115], v[56:59], v[224:227]
    v_sub_f32 v68, v68, v92
    v_exp_f32 v68, v68
    v_mfma_f32_16x16x32_bf16 v[228:231], a[116:119], v[56:59], v[228:231]
    ds_read_b64_tr_b16 a[112:113], v12 offset:0
    ds_read_b64_tr_b16 a[114:115], v12 offset:256
    v_mfma_f32_16x16x32_bf16 v[232:235], a[120:123], v[56:59], v[232:235]
    s_add_u32 m0, s60, 50720
    v_sub_f32 v69, v69, v92
    v_exp_f32 v69, v69
    v_mfma_f32_16x16x32_bf16 v[236:239], a[124:127], v[56:59], v[236:239]
    buffer_load_dwordx4 v90, s[80:83], s45 offen offset:1024 lds
    v_mfma_f32_16x16x32_bf16 v[240:243], a[128:131], v[56:59], v[240:243]
    v_sub_f32 v70, v70, v92
    v_exp_f32 v70, v70
    v_mfma_f32_16x16x32_bf16 v[244:247], a[132:135], v[56:59], v[244:247]
    ds_read_b64_tr_b16 a[116:117], v12 offset:32
    v_cvt_pk_bf16_f32 v54, v68, v69
    v_mfma_f32_16x16x32_bf16 v[248:251], a[136:139], v[56:59], v[248:251]
    v_sub_f32 v71, v71, v92
    v_exp_f32 v71, v71
    v_mfma_f32_16x16x32_bf16 v[252:255], a[140:143], v[56:59], v[252:255]
    ds_read_b64_tr_b16 a[118:119], v12 offset:288
    v_cvt_pk_bf16_f32 v55, v70, v71
    v_mfma_f32_16x16x32_bf16 a[244:247], a[248:251], v[56:59], a[244:247]
    ds_read_b64_tr_b16 a[120:121], v12 offset:64
    ds_read_b64_tr_b16 a[122:123], v12 offset:320
    v_mfma_f32_16x16x32_bf16 v[80:83], a[80:83], a[16:19], 0
    v_accvgpr_read_b32 v92, a252
    v_sub_f32 v72, v72, v92
    v_exp_f32 v72, v72
    v_mfma_f32_16x16x32_bf16 v[80:83], a[84:87], a[20:23], v[80:83]
    ds_read_b64_tr_b16 a[124:125], v12 offset:96
    ds_read_b64_tr_b16 a[126:127], v12 offset:352
    v_add_u32 v10, -67584, v10
    v_mfma_f32_16x16x32_bf16 v[80:83], a[88:91], a[24:27], v[80:83]
    v_sub_f32 v73, v73, v92
    v_exp_f32 v73, v73
    v_mfma_f32_16x16x32_bf16 v[80:83], a[92:95], a[28:31], v[80:83]
    ds_read_b64_tr_b16 a[184:185], v13 offset:64
    v_cvt_pk_bf16_f32 v56, v72, v73
    v_add_u32 v11, -67584, v11
    v_mfma_f32_16x16x32_bf16 v[84:87], a[108:111], a[28:31], 0
    s_add_u32 m0, s60, 50752
    v_sub_f32 v74, v74, v92
    v_exp_f32 v74, v74
    v_mfma_f32_16x16x32_bf16 v[84:87], a[104:107], a[24:27], v[84:87]
    buffer_load_dwordx4 v90, s[80:83], s45 offen offset:2048 lds
    v_mfma_f32_16x16x32_bf16 v[84:87], a[100:103], a[20:23], v[84:87]
    v_sub_f32 v75, v75, v92
    v_exp_f32 v75, v75
    v_mfma_f32_16x16x32_bf16 v[84:87], a[96:99], a[16:19], v[84:87]
    ds_read_b64_tr_b16 a[186:187], v13 offset:320
    v_cvt_pk_bf16_f32 v57, v74, v75
    v_mfma_f32_16x16x32_bf16 v[208:211], a[128:131], v[60:63], v[208:211]
    v_sub_f32 v76, v76, v92
    v_exp_f32 v76, v76
    v_mfma_f32_16x16x32_bf16 v[208:211], a[192:195], v[16:19], v[208:211]
    ds_read_b64_tr_b16 a[128:129], v12 offset:128
    ds_read_b64_tr_b16 a[130:131], v12 offset:384
    v_mfma_f32_16x16x32_bf16 v[212:215], a[196:199], v[16:19], v[212:215]
    s_add_u32 m0, s60, 50784
    v_sub_f32 v77, v77, v92
    v_exp_f32 v77, v77
    v_mfma_f32_16x16x32_bf16 v[212:215], a[132:135], v[60:63], v[212:215]
    buffer_load_dwordx4 v90, s[80:83], s45 offen offset:3072 lds
    v_mfma_f32_16x16x32_bf16 v[216:219], a[136:139], v[60:63], v[216:219]
    v_sub_f32 v78, v78, v92
    v_exp_f32 v78, v78
    v_mfma_f32_16x16x32_bf16 v[216:219], a[200:203], v[16:19], v[216:219]
    ds_read_b64_tr_b16 a[192:193], v13 offset:128
    v_cvt_pk_bf16_f32 v58, v76, v77
    v_mfma_f32_16x16x32_bf16 v[220:223], a[204:207], v[16:19], v[220:223]
    v_sub_f32 v79, v79, v92
    v_exp_f32 v79, v79
    v_mfma_f32_16x16x32_bf16 v[220:223], a[140:143], v[60:63], v[220:223]
    ds_read_b64_tr_b16 a[194:195], v13 offset:384
    v_cvt_pk_bf16_f32 v59, v78, v79
    v_mfma_f32_16x16x32_bf16 v[64:67], a[144:147], a[16:19], 0
    v_accvgpr_read_b32 v92, a253
    v_sub_f32 v80, v80, v92
    v_exp_f32 v80, v80
    v_mfma_f32_16x16x32_bf16 v[64:67], a[148:151], a[20:23], v[64:67]
    ds_read_b64_tr_b16 a[196:197], v13 offset:160
    ds_read_b64_tr_b16 a[198:199], v13 offset:416
    v_add_f32 v14, v14, v80
    v_mfma_f32_16x16x32_bf16 v[64:67], a[152:155], a[24:27], v[64:67]
    v_sub_f32 v81, v81, v92
    v_exp_f32 v81, v81
    v_mfma_f32_16x16x32_bf16 v[64:67], a[156:159], a[28:31], v[64:67]
    ds_read_b64_tr_b16 a[132:133], v12 offset:160
    ds_read_b64_tr_b16 a[134:135], v12 offset:416
    v_add_f32 v14, v14, v81
    v_mfma_f32_16x16x32_bf16 v[68:71], a[172:175], a[28:31], 0
    v_sub_f32 v82, v82, v92
    v_exp_f32 v82, v82
    v_mfma_f32_16x16x32_bf16 v[68:71], a[168:171], a[24:27], v[68:71]
    ds_read_b64_tr_b16 a[136:137], v12 offset:192
    ds_read_b64_tr_b16 a[138:139], v12 offset:448
    v_add_f32 v14, v14, v82
    v_mfma_f32_16x16x32_bf16 v[68:71], a[164:167], a[20:23], v[68:71]
    v_sub_f32 v83, v83, v92
    v_exp_f32 v83, v83
    v_mfma_f32_16x16x32_bf16 v[68:71], a[160:163], a[16:19], v[68:71]
    s_waitcnt lgkmcnt(4)
    ds_read_b64_tr_b16 a[200:201], v13 offset:192
    ds_read_b64_tr_b16 a[202:203], v13 offset:448
    v_cvt_pk_bf16_f32 v60, v80, v81
    v_mfma_f32_16x16x32_bf16 v[96:99], a[112:115], v[52:55], v[96:99]
    s_waitcnt vmcnt(16)
    v_sub_f32 v84, v84, v92
    v_exp_f32 v84, v84
    v_mfma_f32_16x16x32_bf16 v[96:99], a[176:179], v[56:59], v[96:99]
    ds_read_b64_tr_b16 a[204:205], v13 offset:224
    ds_read_b64_tr_b16 a[42:43], v5 offset:34368
    v_add_f32 v14, v14, v84
    v_mfma_f32_16x16x32_bf16 v[100:103], a[180:183], v[56:59], v[100:103]
    v_sub_f32 v85, v85, v92
    v_exp_f32 v85, v85
    v_mfma_f32_16x16x32_bf16 v[100:103], a[116:119], v[52:55], v[100:103]
    ds_read_b64_tr_b16 a[44:45], v5 offset:33888
    v_add_f32 v14, v14, v85
    v_cvt_pk_bf16_f32 v62, v84, v85
    v_mfma_f32_16x16x32_bf16 v[104:107], a[120:123], v[52:55], v[104:107]
    v_sub_f32 v86, v86, v92
    v_exp_f32 v86, v86
    v_mfma_f32_16x16x32_bf16 v[104:107], a[184:187], v[56:59], v[104:107]
    ds_read_b64_tr_b16 a[206:207], v13 offset:480
    ds_read_b64_tr_b16 a[46:47], v5 offset:34400
    v_add_f32 v14, v14, v86
    v_mfma_f32_16x16x32_bf16 v[108:111], a[188:191], v[56:59], v[108:111]
    v_sub_f32 v87, v87, v92
    v_exp_f32 v87, v87
    v_mfma_f32_16x16x32_bf16 v[108:111], a[124:127], v[52:55], v[108:111]
    v_add_f32 v14, v14, v87
    v_cvt_pk_bf16_f32 v63, v86, v87
    v_mfma_f32_16x16x32_bf16 a[240:243], a[248:251], v[52:55], a[240:243]
    ds_read_b64_tr_b16 a[140:141], v12 offset:224
    ds_read_b64_tr_b16 a[142:143], v12 offset:480
    v_mfma_f32_16x16x32_bf16 a[240:243], a[248:251], v[56:59], a[240:243]
    v_add_f32 v14, v14, v83
    v_cvt_pk_bf16_f32 v61, v82, v83
    v_mfma_f32_16x16x32_bf16 v[72:75], a[80:83], v[20:23], 0
    v_accvgpr_read_b32 v92, a253
    v_sub_f32 v64, v64, v92
    v_exp_f32 v64, v64
    v_mfma_f32_16x16x32_bf16 v[72:75], a[84:87], v[24:27], v[72:75]
    ds_read_b64_tr_b16 a[32:33], v5 offset:33792
    ds_read_b64_tr_b16 a[34:35], v5 offset:34304
    v_add_f32 v14, v14, v64
    v_mfma_f32_16x16x32_bf16 v[72:75], a[88:91], v[28:31], v[72:75]
    v_sub_f32 v65, v65, v92
    v_exp_f32 v65, v65
    v_mfma_f32_16x16x32_bf16 v[72:75], a[92:95], v[32:35], v[72:75]
    ds_read_b64_tr_b16 a[36:37], v5 offset:33824
    v_cvt_pk_bf16_f32 v16, v64, v65
    v_add_f32 v14, v14, v65
    v_mfma_f32_16x16x32_bf16 v[76:79], a[108:111], v[32:35], 0
    v_sub_f32 v66, v66, v92
    v_exp_f32 v66, v66
    v_mfma_f32_16x16x32_bf16 v[76:79], a[104:107], v[28:31], v[76:79]
    ds_read_b64_tr_b16 a[38:39], v5 offset:34336
    ds_read_b64_tr_b16 a[40:41], v5 offset:33856
    v_add_f32 v14, v14, v66
    v_mfma_f32_16x16x32_bf16 v[76:79], a[100:103], v[24:27], v[76:79]
    v_sub_f32 v67, v67, v92
    v_exp_f32 v67, v67
    v_mfma_f32_16x16x32_bf16 v[76:79], a[96:99], v[20:23], v[76:79]
    v_cvt_pk_bf16_f32 v17, v66, v67
    v_add_f32 v14, v14, v67
    v_mfma_f32_16x16x32_bf16 v[112:115], a[128:131], v[52:55], v[112:115]
    s_waitcnt vmcnt(12)
    v_sub_f32 v68, v68, v92
    v_exp_f32 v68, v68
    v_mfma_f32_16x16x32_bf16 v[112:115], a[192:195], v[56:59], v[112:115]
    ds_read_b64_tr_b16 a[48:49], v5 offset:50688
    v_add_f32 v14, v14, v68
    v_mfma_f32_16x16x32_bf16 v[116:119], a[196:199], v[56:59], v[116:119]
    s_waitcnt lgkmcnt(3)
    v_sub_f32 v69, v69, v92
    v_exp_f32 v69, v69
    v_mfma_f32_16x16x32_bf16 v[116:119], a[132:135], v[52:55], v[116:119]
    v_cvt_pk_bf16_f32 v18, v68, v69
    v_add_f32 v14, v14, v69
    v_mfma_f32_16x16x32_bf16 v[120:123], a[136:139], v[52:55], v[120:123]
    v_sub_f32 v70, v70, v92
    v_exp_f32 v70, v70
    v_mfma_f32_16x16x32_bf16 v[120:123], a[200:203], v[56:59], v[120:123]
    ds_read_b64_tr_b16 a[50:51], v5 offset:51200
    v_add_f32 v14, v14, v70
    v_mfma_f32_16x16x32_bf16 v[124:127], a[204:207], v[56:59], v[124:127]
    v_sub_f32 v71, v71, v92
    v_exp_f32 v71, v71
    v_mfma_f32_16x16x32_bf16 v[124:127], a[140:143], v[52:55], v[124:127]
    v_cvt_pk_bf16_f32 v19, v70, v71
    v_add_f32 v14, v14, v71
    v_mfma_f32_16x16x32_bf16 v[80:83], a[144:147], v[20:23], 0
    v_accvgpr_read_b32 v92, a254
    v_sub_f32 v72, v72, v92
    v_exp_f32 v72, v72
    v_mfma_f32_16x16x32_bf16 v[80:83], a[148:151], v[24:27], v[80:83]
    ds_read_b64_tr_b16 a[52:53], v5 offset:50720
    ds_read_b64_tr_b16 a[54:55], v5 offset:51232
    v_add_f32 v15, v15, v72
    v_mfma_f32_16x16x32_bf16 v[80:83], a[152:155], v[28:31], v[80:83]
    v_sub_f32 v73, v73, v92
    v_exp_f32 v73, v73
    v_mfma_f32_16x16x32_bf16 v[80:83], a[156:159], v[32:35], v[80:83]
    s_xor_b32 s45, s52, 163840
    ds_read_b64_tr_b16 a[56:57], v5 offset:50752
    ds_read_b64_tr_b16 a[58:59], v5 offset:51264
    v_add_f32 v15, v15, v73
    v_mfma_f32_16x16x32_bf16 v[84:87], a[172:175], v[32:35], 0
    s_add_u32 m0, s60, 101376
    v_sub_f32 v74, v74, v92
    v_exp_f32 v74, v74
    v_mfma_f32_16x16x32_bf16 v[84:87], a[168:171], v[28:31], v[84:87]
    s_waitcnt lgkmcnt(4)
    buffer_load_dwordx4 v90, s[80:83], s45 offen offset:0 lds
    v_mfma_f32_16x16x32_bf16 v[84:87], a[164:167], v[24:27], v[84:87]
    v_sub_f32 v75, v75, v92
    v_exp_f32 v75, v75
    v_mfma_f32_16x16x32_bf16 v[84:87], a[160:163], v[20:23], v[84:87]
    ds_read_b64_tr_b16 a[60:61], v5 offset:50784
    ds_read_b64_tr_b16 a[62:63], v5 offset:51296
    v_add_f32 v15, v15, v74
    v_mfma_f32_16x16x32_bf16 v[128:131], a[112:115], v[60:63], v[128:131]
    v_sub_f32 v76, v76, v92
    v_exp_f32 v76, v76
    v_mfma_f32_16x16x32_bf16 v[128:131], a[176:179], v[16:19], v[128:131]
    v_add_f32 v15, v15, v76
    v_add_f32 v15, v15, v75
    v_cvt_pk_bf16_f32 v52, v72, v73
    v_mfma_f32_16x16x32_bf16 v[132:135], a[180:183], v[16:19], v[132:135]
    s_add_u32 m0, s60, 101408
    v_sub_f32 v77, v77, v92
    v_exp_f32 v77, v77
    v_mfma_f32_16x16x32_bf16 v[132:135], a[116:119], v[60:63], v[132:135]
    buffer_load_dwordx4 v90, s[80:83], s45 offen offset:1024 lds
    v_mfma_f32_16x16x32_bf16 v[136:139], a[120:123], v[60:63], v[136:139]
    v_sub_f32 v78, v78, v92
    v_exp_f32 v78, v78
    v_mfma_f32_16x16x32_bf16 v[136:139], a[184:187], v[16:19], v[136:139]
    v_add_f32 v15, v15, v78
    v_add_f32 v15, v15, v77
    v_add_u32 v12, -67584, v12
    v_mfma_f32_16x16x32_bf16 v[140:143], a[188:191], v[16:19], v[140:143]
    v_sub_f32 v79, v79, v92
    v_exp_f32 v79, v79
    v_mfma_f32_16x16x32_bf16 v[140:143], a[124:127], v[60:63], v[140:143]
    s_add_u32 m0, s60, 101440
    v_add_f32 v15, v15, v79
    v_cvt_pk_bf16_f32 v55, v78, v79
    v_add_u32 v13, -67584, v13
    v_mfma_f32_16x16x32_bf16 v[64:67], a[80:83], v[36:39], 0
    s_waitcnt vmcnt(10)
    v_accvgpr_read_b32 v92, a254
    v_sub_f32 v80, v80, v92
    v_exp_f32 v80, v80
    v_mfma_f32_16x16x32_bf16 v[64:67], a[84:87], v[40:43], v[64:67]
    buffer_load_dwordx4 v90, s[80:83], s45 offen offset:2048 lds
    v_mfma_f32_16x16x32_bf16 v[64:67], a[88:91], v[44:47], v[64:67]
    ds_read_b64_tr_b16 a[216:217], v93 offset:64
    v_sub_f32 v81, v81, v92
    v_exp_f32 v81, v81
    v_mfma_f32_16x16x32_bf16 v[64:67], a[92:95], v[48:51], v[64:67]
    ds_read_b64_tr_b16 a[218:219], v93 offset:576
    v_cvt_pk_bf16_f32 v56, v80, v81
    v_cvt_pk_bf16_f32 v54, v76, v77
    v_add_f32 v15, v15, v81
    v_mfma_f32_16x16x32_bf16 v[68:71], a[108:111], v[48:51], 0
    s_add_u32 m0, s60, 101472
    ds_read_b64_tr_b16 a[220:221], v93 offset:96
    v_sub_f32 v82, v82, v92
    v_exp_f32 v82, v82
    v_mfma_f32_16x16x32_bf16 v[68:71], a[104:107], v[44:47], v[68:71]
    buffer_load_dwordx4 v90, s[80:83], s45 offen offset:3072 lds
    v_mfma_f32_16x16x32_bf16 v[68:71], a[100:103], v[40:43], v[68:71]
    ds_read_b64_tr_b16 a[222:223], v93 offset:608
    v_sub_f32 v83, v83, v92
    v_exp_f32 v83, v83
    v_mfma_f32_16x16x32_bf16 v[68:71], a[96:99], v[36:39], v[68:71]
    s_xor_b32 s45, s52, 196608
    v_cvt_pk_bf16_f32 v57, v82, v83
    v_cvt_pk_bf16_f32 v53, v74, v75
    v_add_f32 v15, v15, v80
    v_mfma_f32_16x16x32_bf16 v[144:147], a[128:131], v[60:63], v[144:147]
    s_add_u32 m0, s60, 118272
    v_sub_f32 v84, v84, v92
    v_exp_f32 v84, v84
    v_mfma_f32_16x16x32_bf16 v[144:147], a[192:195], v[16:19], v[144:147]
    s_waitcnt lgkmcnt(2)
    buffer_load_dwordx4 v90, s[80:83], s45 offen offset:0 lds
    v_mfma_f32_16x16x32_bf16 v[148:151], a[196:199], v[16:19], v[148:151]
    v_sub_f32 v85, v85, v92
    v_exp_f32 v85, v85
    v_mfma_f32_16x16x32_bf16 v[148:151], a[132:135], v[60:63], v[148:151]
    ds_read_b64_tr_b16 a[208:209], v93 offset:0
    v_cvt_pk_bf16_f32 v58, v84, v85
    v_add_f32 v15, v15, v85
    v_mfma_f32_16x16x32_bf16 v[152:155], a[136:139], v[60:63], v[152:155]
    s_add_u32 m0, s60, 118304
    v_sub_f32 v86, v86, v92
    v_exp_f32 v86, v86
    v_mfma_f32_16x16x32_bf16 v[152:155], a[200:203], v[16:19], v[152:155]
    buffer_load_dwordx4 v90, s[80:83], s45 offen offset:1024 lds
    v_mfma_f32_16x16x32_bf16 v[156:159], a[204:207], v[16:19], v[156:159]
    v_sub_f32 v87, v87, v92
    v_exp_f32 v87, v87
    v_mfma_f32_16x16x32_bf16 v[156:159], a[140:143], v[60:63], v[156:159]
    ds_read_b64_tr_b16 a[210:211], v93 offset:512
    v_cvt_pk_bf16_f32 v59, v86, v87
    v_add_f32 v15, v15, v87
    s_barrier
    v_mfma_f32_16x16x32_bf16 v[72:75], a[144:147], v[36:39], 0
    v_accvgpr_read_b32 v92, a255
    v_sub_f32 v64, v64, v92
    v_exp_f32 v64, v64
    v_mfma_f32_16x16x32_bf16 v[72:75], a[148:151], v[40:43], v[72:75]
    ds_read_b128 a[144:147], v11 offset:0
    v_add_f32 v15, v15, v86
    v_add_f32 v15, v15, v84
    v_add_f32 v89, v89, v64
    v_mfma_f32_16x16x32_bf16 v[72:75], a[152:155], v[44:47], v[72:75]
    s_add_u32 m0, s60, 118336
    ds_read_b128 a[152:155], v11 offset:128
    v_sub_f32 v65, v65, v92
    v_exp_f32 v65, v65
    v_mfma_f32_16x16x32_bf16 v[72:75], a[156:159], v[48:51], v[72:75]
    buffer_load_dwordx4 v90, s[80:83], s45 offen offset:2048 lds
    v_mfma_f32_16x16x32_bf16 v[76:79], a[172:175], v[48:51], 0
    ds_read_b128 a[172:175], v11 offset:448
    v_sub_f32 v66, v66, v92
    v_exp_f32 v66, v66
    v_mfma_f32_16x16x32_bf16 v[76:79], a[168:171], v[44:47], v[76:79]
    v_add_f32 v15, v15, v83
    v_add_f32 v15, v15, v82
    v_add_f32 v89, v89, v66
    v_mfma_f32_16x16x32_bf16 v[76:79], a[164:167], v[40:43], v[76:79]
    ds_read_b128 a[164:167], v11 offset:320
    v_sub_f32 v67, v67, v92
    v_exp_f32 v67, v67
    v_mfma_f32_16x16x32_bf16 v[76:79], a[160:163], v[36:39], v[76:79]
    v_add_f32 v89, v89, v67
    v_cvt_pk_bf16_f32 v61, v66, v67
    v_add_f32 v89, v89, v65
    v_mfma_f32_16x16x32_bf16 v[160:163], a[112:115], v[52:55], v[160:163]
    s_add_u32 m0, s60, 118368
    v_sub_f32 v68, v68, v92
    v_exp_f32 v68, v68
    v_mfma_f32_16x16x32_bf16 v[160:163], a[176:179], v[56:59], v[160:163]
    buffer_load_dwordx4 v90, s[80:83], s45 offen offset:3072 lds
    v_mfma_f32_16x16x32_bf16 v[164:167], a[180:183], v[56:59], v[164:167]
    v_sub_f32 v69, v69, v92
    v_exp_f32 v69, v69
    v_mfma_f32_16x16x32_bf16 v[164:167], a[116:119], v[52:55], v[164:167]
    v_add_f32 v89, v89, v69
    v_cvt_pk_bf16_f32 v62, v68, v69
    v_cvt_pk_bf16_f32 v60, v64, v65
    v_mfma_f32_16x16x32_bf16 v[168:171], a[120:123], v[52:55], v[168:171]
    v_sub_f32 v70, v70, v92
    v_exp_f32 v70, v70
    v_mfma_f32_16x16x32_bf16 v[168:171], a[184:187], v[56:59], v[168:171]
    ds_read_b64_tr_b16 a[212:213], v93 offset:32
    v_add_f32 v89, v89, v70
    v_add_f32 v89, v89, v68
    v_mfma_f32_16x16x32_bf16 v[172:175], a[188:191], v[56:59], v[172:175]
    v_sub_f32 v71, v71, v92
    v_exp_f32 v71, v71
    v_mfma_f32_16x16x32_bf16 v[172:175], a[124:127], v[52:55], v[172:175]
    ds_read_b64_tr_b16 a[214:215], v93 offset:544
    v_add_f32 v89, v89, v71
    v_cvt_pk_bf16_f32 v63, v70, v71
    v_mfma_f32_16x16x32_bf16 v[80:83], a[80:83], a[64:67], 0
    v_accvgpr_read_b32 v92, a255
    v_sub_f32 v72, v72, v92
    v_exp_f32 v72, v72
    v_mfma_f32_16x16x32_bf16 v[80:83], a[84:87], a[68:71], v[80:83]
    ds_read_b128 a[80:83], v10 offset:0
    ds_read_b128 a[84:87], v10 offset:64
    v_add_f32 v89, v89, v72
    v_mfma_f32_16x16x32_bf16 v[80:83], a[88:91], a[72:75], v[80:83]
    v_sub_f32 v73, v73, v92
    v_exp_f32 v73, v73
    v_mfma_f32_16x16x32_bf16 v[80:83], a[92:95], a[76:79], v[80:83]
    ds_read_b128 a[88:91], v10 offset:128
    ds_read_b128 a[92:95], v10 offset:192
    v_cvt_pk_bf16_f32 v16, v72, v73
    v_mfma_f32_16x16x32_bf16 v[84:87], a[108:111], a[76:79], 0
    v_sub_f32 v74, v74, v92
    v_exp_f32 v74, v74
    v_mfma_f32_16x16x32_bf16 v[84:87], a[104:107], a[72:75], v[84:87]
    ds_read_b128 a[108:111], v10 offset:448
    ds_read_b128 a[104:107], v10 offset:384
    v_add_f32 v89, v89, v74
    v_mfma_f32_16x16x32_bf16 v[84:87], a[100:103], a[68:71], v[84:87]
    s_xor_b32 s45, s52, 229376
    v_sub_f32 v75, v75, v92
    v_exp_f32 v75, v75
    v_mfma_f32_16x16x32_bf16 v[84:87], a[96:99], a[64:67], v[84:87]
    s_add_u32 m0, s60, 67584
    ds_read_b128 a[100:103], v10 offset:320
    ds_read_b128 a[96:99], v10 offset:256
    v_add_f32 v89, v89, v75
    v_mfma_f32_16x16x32_bf16 v[176:179], a[128:131], v[52:55], v[176:179]
    s_waitcnt vmcnt(12)
    v_sub_f32 v76, v76, v92
    v_exp_f32 v76, v76
    v_mfma_f32_16x16x32_bf16 v[176:179], a[192:195], v[56:59], v[176:179]
    buffer_load_dwordx4 v90, s[80:83], s45 offen offset:0 lds
    v_mfma_f32_16x16x32_bf16 v[180:183], a[196:199], v[56:59], v[180:183]
    v_sub_f32 v77, v77, v92
    v_exp_f32 v77, v77
    v_mfma_f32_16x16x32_bf16 v[180:183], a[132:135], v[52:55], v[180:183]
    ds_read_b64_tr_b16 a[234:235], v1 offset:34368
    v_cvt_pk_bf16_f32 v18, v76, v77
    v_cvt_pk_bf16_f32 v17, v74, v75
    v_mfma_f32_16x16x32_bf16 v[184:187], a[136:139], v[52:55], v[184:187]
    s_add_u32 m0, s60, 67616
    v_sub_f32 v78, v78, v92
    v_exp_f32 v78, v78
    v_mfma_f32_16x16x32_bf16 v[184:187], a[200:203], v[56:59], v[184:187]
    buffer_load_dwordx4 v90, s[80:83], s45 offen offset:1024 lds
    v_mfma_f32_16x16x32_bf16 v[188:191], a[204:207], v[56:59], v[188:191]
    v_sub_f32 v79, v79, v92
    v_exp_f32 v79, v79
    v_mfma_f32_16x16x32_bf16 v[188:191], a[140:143], v[52:55], v[188:191]
    s_waitcnt lgkmcnt(1)
    ds_read_b64_tr_b16 a[236:237], v1 offset:33888
    v_cvt_pk_bf16_f32 v19, v78, v79
    v_add_f32 v89, v89, v79
    v_mfma_f32_16x16x32_bf16 v[64:67], a[80:83], a[0:3], 0
    s_add_u32 m0, s60, 67648
    v_sub_f32 v80, v80, v9
    v_exp_f32 v80, v80
    v_mfma_f32_16x16x32_bf16 v[64:67], a[84:87], a[4:7], v[64:67]
    buffer_load_dwordx4 v90, s[80:83], s45 offen offset:2048 lds
    v_mfma_f32_16x16x32_bf16 v[64:67], a[88:91], a[8:11], v[64:67]
    v_sub_f32 v81, v81, v9
    v_exp_f32 v81, v81
    v_mfma_f32_16x16x32_bf16 v[64:67], a[92:95], a[12:15], v[64:67]
    ds_read_b64_tr_b16 a[238:239], v1 offset:34400
    v_cvt_pk_bf16_f32 v56, v80, v81
    v_add_f32 v89, v89, v78
    v_mfma_f32_16x16x32_bf16 v[68:71], a[108:111], a[12:15], 0
    s_add_u32 m0, s60, 67680
    v_sub_f32 v82, v82, v9
    v_exp_f32 v82, v82
    v_mfma_f32_16x16x32_bf16 v[68:71], a[104:107], a[8:11], v[68:71]
    buffer_load_dwordx4 v90, s[80:83], s45 offen offset:3072 lds
    v_mfma_f32_16x16x32_bf16 v[68:71], a[100:103], a[4:7], v[68:71]
    v_sub_f32 v83, v83, v9
    v_exp_f32 v83, v83
    v_mfma_f32_16x16x32_bf16 v[68:71], a[96:99], a[0:3], v[68:71]
    v_cvt_pk_bf16_f32 v57, v82, v83
    v_add_f32 v89, v89, v77
    v_add_f32 v89, v89, v73
    v_mfma_f32_16x16x32_bf16 v[192:195], a[112:115], v[60:63], v[192:195]
    v_sub_f32 v84, v84, v9
    v_exp_f32 v84, v84
    v_mfma_f32_16x16x32_bf16 v[192:195], a[176:179], v[16:19], v[192:195]
    ds_read_b64_tr_b16 a[224:225], v1 offset:33792
    ds_read_b128 a[148:151], v11 offset:64
    v_add_f32 v89, v89, v76
    v_mfma_f32_16x16x32_bf16 v[196:199], a[180:183], v[16:19], v[196:199]
    v_sub_f32 v85, v85, v9
    v_exp_f32 v85, v85
    v_mfma_f32_16x16x32_bf16 v[196:199], a[116:119], v[60:63], v[196:199]
    ds_read_b64_tr_b16 a[226:227], v1 offset:34304
    ds_read_b128 a[156:159], v11 offset:192
    v_cvt_pk_bf16_f32 v58, v84, v85
    v_mfma_f32_16x16x32_bf16 v[200:203], a[120:123], v[60:63], v[200:203]
    v_sub_f32 v86, v86, v9
    v_exp_f32 v86, v86
    v_mfma_f32_16x16x32_bf16 v[200:203], a[184:187], v[16:19], v[200:203]
    ds_read_b64_tr_b16 a[228:229], v1 offset:33824
    ds_read_b64_tr_b16 a[230:231], v1 offset:34336
    ds_read_b128 a[168:171], v11 offset:384
    v_mfma_f32_16x16x32_bf16 v[204:207], a[188:191], v[16:19], v[204:207]
    v_sub_f32 v87, v87, v9
    v_exp_f32 v87, v87
    v_mfma_f32_16x16x32_bf16 v[204:207], a[124:127], v[60:63], v[204:207]
    ds_read_b64_tr_b16 a[232:233], v1 offset:33856
    ds_read_b128 a[160:163], v11 offset:256
    v_cvt_pk_bf16_f32 v59, v86, v87
    v_mfma_f32_16x16x32_bf16 v[72:75], a[144:147], a[0:3], 0
    s_waitcnt lgkmcnt(7)
    v_accvgpr_read_b32 v92, a252
    v_sub_f32 v64, v64, v92
    v_exp_f32 v64, v64
    v_mfma_f32_16x16x32_bf16 v[72:75], a[148:151], a[4:7], v[72:75]
    s_xor_b32 s45, s52, 262144
    ds_read_b64_tr_b16 a[176:177], v13 offset:0
    ds_read_b64_tr_b16 a[178:179], v13 offset:256
    ds_read_b64_tr_b16 a[188:189], v13 offset:96
    v_mfma_f32_16x16x32_bf16 v[72:75], a[152:155], a[8:11], v[72:75]
    s_waitcnt lgkmcnt(8)
    v_sub_f32 v65, v65, v92
    v_exp_f32 v65, v65
    v_mfma_f32_16x16x32_bf16 v[72:75], a[156:159], a[12:15], v[72:75]
    s_add_u32 m0, s60, 135168
    ds_read_b64_tr_b16 a[180:181], v13 offset:32
    ds_read_b64_tr_b16 a[190:191], v13 offset:352
    v_cvt_pk_bf16_f32 v52, v64, v65
    v_mfma_f32_16x16x32_bf16 v[76:79], a[172:175], a[12:15], 0
    s_waitcnt lgkmcnt(7)
    v_sub_f32 v66, v66, v92
    v_exp_f32 v66, v66
    v_mfma_f32_16x16x32_bf16 v[76:79], a[168:171], a[8:11], v[76:79]
    buffer_load_dwordx4 v90, s[80:83], s45 offen offset:0 lds
    v_mfma_f32_16x16x32_bf16 v[76:79], a[164:167], a[4:7], v[76:79]
    s_waitcnt lgkmcnt(5)
    v_sub_f32 v67, v67, v92
    v_exp_f32 v67, v67
    v_mfma_f32_16x16x32_bf16 v[76:79], a[160:163], a[0:3], v[76:79]
    ds_read_b64_tr_b16 a[182:183], v13 offset:288
    v_cvt_pk_bf16_f32 v53, v66, v67
    v_mfma_f32_16x16x32_bf16 v[224:227], a[112:115], v[56:59], v[224:227]
    v_sub_f32 v68, v68, v92
    v_exp_f32 v68, v68
    v_mfma_f32_16x16x32_bf16 v[228:231], a[116:119], v[56:59], v[228:231]
    ds_read_b64_tr_b16 a[112:113], v12 offset:0
    ds_read_b64_tr_b16 a[114:115], v12 offset:256
    v_mfma_f32_16x16x32_bf16 v[232:235], a[120:123], v[56:59], v[232:235]
    s_add_u32 m0, s60, 135200
    v_sub_f32 v69, v69, v92
    v_exp_f32 v69, v69
    v_mfma_f32_16x16x32_bf16 v[236:239], a[124:127], v[56:59], v[236:239]
    buffer_load_dwordx4 v90, s[80:83], s45 offen offset:1024 lds
    v_mfma_f32_16x16x32_bf16 v[240:243], a[128:131], v[56:59], v[240:243]
    v_sub_f32 v70, v70, v92
    v_exp_f32 v70, v70
    v_mfma_f32_16x16x32_bf16 v[244:247], a[132:135], v[56:59], v[244:247]
    ds_read_b64_tr_b16 a[116:117], v12 offset:32
    v_cvt_pk_bf16_f32 v54, v68, v69
    v_mfma_f32_16x16x32_bf16 v[248:251], a[136:139], v[56:59], v[248:251]
    v_sub_f32 v71, v71, v92
    v_exp_f32 v71, v71
    v_mfma_f32_16x16x32_bf16 v[252:255], a[140:143], v[56:59], v[252:255]
    ds_read_b64_tr_b16 a[118:119], v12 offset:288
    v_cvt_pk_bf16_f32 v55, v70, v71
    v_mfma_f32_16x16x32_bf16 a[244:247], a[248:251], v[56:59], a[244:247]
    ds_read_b64_tr_b16 a[120:121], v12 offset:64
    ds_read_b64_tr_b16 a[122:123], v12 offset:320
    v_mfma_f32_16x16x32_bf16 v[80:83], a[80:83], a[64:67], 0
    v_accvgpr_read_b32 v92, a252
    v_sub_f32 v72, v72, v92
    v_exp_f32 v72, v72
    v_mfma_f32_16x16x32_bf16 v[80:83], a[84:87], a[68:71], v[80:83]
    ds_read_b64_tr_b16 a[124:125], v12 offset:96
    ds_read_b64_tr_b16 a[126:127], v12 offset:352
    v_mfma_f32_16x16x32_bf16 v[80:83], a[88:91], a[72:75], v[80:83]
    v_sub_f32 v73, v73, v92
    v_exp_f32 v73, v73
    v_mfma_f32_16x16x32_bf16 v[80:83], a[92:95], a[76:79], v[80:83]
    ds_read_b64_tr_b16 a[184:185], v13 offset:64
    v_cvt_pk_bf16_f32 v56, v72, v73
    v_mfma_f32_16x16x32_bf16 v[84:87], a[108:111], a[76:79], 0
    s_add_u32 m0, s60, 135232
    v_sub_f32 v74, v74, v92
    v_exp_f32 v74, v74
    v_mfma_f32_16x16x32_bf16 v[84:87], a[104:107], a[72:75], v[84:87]
    buffer_load_dwordx4 v90, s[80:83], s45 offen offset:2048 lds
    v_mfma_f32_16x16x32_bf16 v[84:87], a[100:103], a[68:71], v[84:87]
    v_sub_f32 v75, v75, v92
    v_exp_f32 v75, v75
    v_mfma_f32_16x16x32_bf16 v[84:87], a[96:99], a[64:67], v[84:87]
    ds_read_b64_tr_b16 a[186:187], v13 offset:320
    v_cvt_pk_bf16_f32 v57, v74, v75
    v_mfma_f32_16x16x32_bf16 v[208:211], a[128:131], v[60:63], v[208:211]
    v_sub_f32 v76, v76, v92
    v_exp_f32 v76, v76
    v_mfma_f32_16x16x32_bf16 v[208:211], a[192:195], v[16:19], v[208:211]
    ds_read_b64_tr_b16 a[128:129], v12 offset:128
    ds_read_b64_tr_b16 a[130:131], v12 offset:384
    v_mfma_f32_16x16x32_bf16 v[212:215], a[196:199], v[16:19], v[212:215]
    s_add_u32 m0, s60, 135264
    v_sub_f32 v77, v77, v92
    v_exp_f32 v77, v77
    v_mfma_f32_16x16x32_bf16 v[212:215], a[132:135], v[60:63], v[212:215]
    buffer_load_dwordx4 v90, s[80:83], s45 offen offset:3072 lds
    v_mfma_f32_16x16x32_bf16 v[216:219], a[136:139], v[60:63], v[216:219]
    v_sub_f32 v78, v78, v92
    v_exp_f32 v78, v78
    v_mfma_f32_16x16x32_bf16 v[216:219], a[200:203], v[16:19], v[216:219]
    ds_read_b64_tr_b16 a[192:193], v13 offset:128
    v_cvt_pk_bf16_f32 v58, v76, v77
    v_mfma_f32_16x16x32_bf16 v[220:223], a[204:207], v[16:19], v[220:223]
    v_sub_f32 v79, v79, v92
    v_exp_f32 v79, v79
    v_mfma_f32_16x16x32_bf16 v[220:223], a[140:143], v[60:63], v[220:223]
    ds_read_b64_tr_b16 a[194:195], v13 offset:384
    v_cvt_pk_bf16_f32 v59, v78, v79
    v_mfma_f32_16x16x32_bf16 v[64:67], a[80:83], a[16:19], 0
    v_sub_f32 v80, v80, v9
    v_exp_f32 v80, v80
    v_mfma_f32_16x16x32_bf16 v[64:67], a[84:87], a[20:23], v[64:67]
    ds_read_b64_tr_b16 a[196:197], v13 offset:160
    ds_read_b64_tr_b16 a[198:199], v13 offset:416
    v_mfma_f32_16x16x32_bf16 v[64:67], a[88:91], a[24:27], v[64:67]
    v_sub_f32 v81, v81, v9
    v_exp_f32 v81, v81
    v_mfma_f32_16x16x32_bf16 v[64:67], a[92:95], a[28:31], v[64:67]
    s_xor_b32 s45, s52, 294912
    ds_read_b64_tr_b16 a[132:133], v12 offset:160
    ds_read_b64_tr_b16 a[134:135], v12 offset:416
    v_mfma_f32_16x16x32_bf16 v[68:71], a[108:111], a[28:31], 0
    s_add_u32 m0, s60, 33792
    v_sub_f32 v82, v82, v9
    v_exp_f32 v82, v82
    v_mfma_f32_16x16x32_bf16 v[68:71], a[104:107], a[24:27], v[68:71]
    buffer_load_dwordx4 v90, s[80:83], s45 offen offset:0 lds
    v_mfma_f32_16x16x32_bf16 v[68:71], a[100:103], a[20:23], v[68:71]
    v_sub_f32 v83, v83, v9
    v_exp_f32 v83, v83
    v_mfma_f32_16x16x32_bf16 v[68:71], a[96:99], a[16:19], v[68:71]
    s_waitcnt lgkmcnt(2)
    ds_read_b64_tr_b16 a[136:137], v12 offset:192
    ds_read_b64_tr_b16 a[138:139], v12 offset:448
    v_mfma_f32_16x16x32_bf16 v[96:99], a[112:115], v[52:55], v[96:99]
    v_sub_f32 v84, v84, v9
    v_exp_f32 v84, v84
    v_mfma_f32_16x16x32_bf16 v[96:99], a[176:179], v[56:59], v[96:99]
    ds_read_b64_tr_b16 a[200:201], v13 offset:192
    ds_read_b64_tr_b16 a[202:203], v13 offset:448
    v_mfma_f32_16x16x32_bf16 v[100:103], a[180:183], v[56:59], v[100:103]
    s_add_u32 m0, s60, 33824
    v_sub_f32 v85, v85, v9
    v_exp_f32 v85, v85
    v_mfma_f32_16x16x32_bf16 v[100:103], a[116:119], v[52:55], v[100:103]
    buffer_load_dwordx4 v90, s[80:83], s45 offen offset:1024 lds
    v_mfma_f32_16x16x32_bf16 v[104:107], a[120:123], v[52:55], v[104:107]
    v_sub_f32 v86, v86, v9
    v_exp_f32 v86, v86
    v_mfma_f32_16x16x32_bf16 v[104:107], a[184:187], v[56:59], v[104:107]
    ds_read_b64_tr_b16 a[204:205], v13 offset:224
    v_cvt_pk_bf16_f32 v62, v84, v85
    v_mfma_f32_16x16x32_bf16 v[108:111], a[188:191], v[56:59], v[108:111]
    v_sub_f32 v87, v87, v9
    v_exp_f32 v87, v87
    v_mfma_f32_16x16x32_bf16 v[108:111], a[124:127], v[52:55], v[108:111]
    ds_read_b64_tr_b16 a[206:207], v13 offset:480
    v_cvt_pk_bf16_f32 v63, v86, v87
    v_mfma_f32_16x16x32_bf16 a[240:243], a[248:251], v[52:55], a[240:243]
    ds_read_b64_tr_b16 a[140:141], v12 offset:224
    ds_read_b64_tr_b16 a[142:143], v12 offset:480
    v_mfma_f32_16x16x32_bf16 a[240:243], a[248:251], v[56:59], a[240:243]
    v_cvt_pk_bf16_f32 v61, v82, v83
    v_cvt_pk_bf16_f32 v60, v80, v81
    v_mfma_f32_16x16x32_bf16 v[72:75], a[144:147], a[16:19], 0
    v_accvgpr_read_b32 v92, a253
    v_sub_f32 v64, v64, v92
    v_exp_f32 v64, v64
    v_mfma_f32_16x16x32_bf16 v[72:75], a[148:151], a[20:23], v[72:75]
    v_add_f32 v14, v14, v64
    v_mfma_f32_16x16x32_bf16 v[72:75], a[152:155], a[24:27], v[72:75]
    v_sub_f32 v65, v65, v92
    v_exp_f32 v65, v65
    v_mfma_f32_16x16x32_bf16 v[72:75], a[156:159], a[28:31], v[72:75]
    v_add_f32 v14, v14, v65
    v_cvt_pk_bf16_f32 v16, v64, v65
    v_mfma_f32_16x16x32_bf16 v[76:79], a[172:175], a[28:31], 0
    s_add_u32 m0, s60, 33856
    v_sub_f32 v66, v66, v92
    v_exp_f32 v66, v66
    v_accvgpr_read_b32 v88, a240
    v_mfma_f32_16x16x32_bf16 v[76:79], a[168:171], a[24:27], v[76:79]
    buffer_load_dwordx4 v90, s[80:83], s45 offen offset:2048 lds
    v_rcp_f32 v94, v88
    v_mfma_f32_16x16x32_bf16 v[76:79], a[164:167], a[20:23], v[76:79]
    v_sub_f32 v67, v67, v92
    v_exp_f32 v67, v67
    v_mul_f32 v96, v94, v96
    v_mul_f32 v97, v94, v97
    v_mfma_f32_16x16x32_bf16 v[76:79], a[160:163], a[16:19], v[76:79]
    v_add_f32 v14, v14, v67
    v_cvt_pk_bf16_f32 v17, v66, v67
    v_mul_f32 v98, v94, v98
    v_mul_f32 v99, v94, v99
    v_mul_f32 v100, v94, v100
    v_mfma_f32_16x16x32_bf16 v[112:115], a[128:131], v[52:55], v[112:115]
    v_sub_f32 v68, v68, v92
    v_exp_f32 v68, v68
    v_mul_f32 v101, v94, v101
    v_mul_f32 v102, v94, v102
    v_mfma_f32_16x16x32_bf16 v[112:115], a[192:195], v[56:59], v[112:115]
    s_add_u32 m0, s60, 33888
    v_add_f32 v14, v14, v68
    v_add_f32 v14, v14, v66
    v_mul_f32 v103, v94, v103
    v_cvt_pk_bf16_f32 v96, v96, v97
    v_cvt_pk_bf16_f32 v97, v98, v99
    v_mfma_f32_16x16x32_bf16 v[116:119], a[196:199], v[56:59], v[116:119]
    s_waitcnt lgkmcnt(0)
    v_sub_f32 v69, v69, v92
    v_exp_f32 v69, v69
    v_cvt_pk_bf16_f32 v98, v100, v101
    v_cvt_pk_bf16_f32 v99, v102, v103
    v_mfma_f32_16x16x32_bf16 v[116:119], a[132:135], v[52:55], v[116:119]
    buffer_load_dwordx4 v90, s[80:83], s45 offen offset:3072 lds
    v_mfma_f32_16x16x32_bf16 v[120:123], a[136:139], v[52:55], v[120:123]
    buffer_store_dwordx4 v[96:99], v2, s[36:39], s84 offen offset:0 sc1
    v_sub_f32 v70, v70, v92
    v_exp_f32 v70, v70
    v_mfma_f32_16x16x32_bf16 v[120:123], a[200:203], v[56:59], v[120:123]
    v_add_f32 v14, v14, v70
    v_add_f32 v14, v14, v69
    v_mul_f32 v104, v94, v104
    v_mul_f32 v105, v94, v105
    v_mul_f32 v106, v94, v106
    v_mfma_f32_16x16x32_bf16 v[124:127], a[204:207], v[56:59], v[124:127]
    v_sub_f32 v71, v71, v92
    v_exp_f32 v71, v71
    v_mul_f32 v107, v94, v107
    v_mul_f32 v108, v94, v108
    v_mfma_f32_16x16x32_bf16 v[124:127], a[140:143], v[52:55], v[124:127]
    v_add_f32 v14, v14, v71
    v_cvt_pk_bf16_f32 v19, v70, v71
    v_mul_f32 v109, v94, v109
    v_mul_f32 v110, v94, v110
    v_mul_f32 v111, v94, v111
    v_mfma_f32_16x16x32_bf16 v[80:83], a[80:83], v[20:23], 0
    v_accvgpr_read_b32 v92, a253
    v_sub_f32 v72, v72, v92
    v_exp_f32 v72, v72
    v_cvt_pk_bf16_f32 v104, v104, v105
    v_mfma_f32_16x16x32_bf16 v[80:83], a[84:87], v[24:27], v[80:83]
    v_add_f32 v14, v14, v72
    v_cvt_pk_bf16_f32 v18, v68, v69
    v_cvt_pk_bf16_f32 v105, v106, v107
    v_cvt_pk_bf16_f32 v106, v108, v109
    v_cvt_pk_bf16_f32 v107, v110, v111
    v_mfma_f32_16x16x32_bf16 v[80:83], a[88:91], v[28:31], v[80:83]
    buffer_store_dwordx4 v[104:107], v2, s[36:39], s84 offen offset:1024 sc1
    v_sub_f32 v73, v73, v92
    v_exp_f32 v73, v73
    v_mfma_f32_16x16x32_bf16 v[80:83], a[92:95], v[32:35], v[80:83]
    v_add_f32 v14, v14, v73
    v_cvt_pk_bf16_f32 v52, v72, v73
    v_mul_f32 v112, v94, v112
    v_mul_f32 v113, v94, v113
    v_mul_f32 v114, v94, v114
    v_mfma_f32_16x16x32_bf16 v[84:87], a[108:111], v[32:35], 0
    v_sub_f32 v74, v74, v92
    v_exp_f32 v74, v74
    v_mul_f32 v115, v94, v115
    v_mul_f32 v116, v94, v116
    v_mfma_f32_16x16x32_bf16 v[84:87], a[104:107], v[28:31], v[84:87]
    v_add_f32 v14, v14, v74
    v_mul_f32 v117, v94, v117
    v_mul_f32 v118, v94, v118
    v_mul_f32 v119, v94, v119
    v_cvt_pk_bf16_f32 v112, v112, v113
    v_mfma_f32_16x16x32_bf16 v[84:87], a[100:103], v[24:27], v[84:87]
    v_sub_f32 v75, v75, v92
    v_exp_f32 v75, v75
    v_cvt_pk_bf16_f32 v113, v114, v115
    v_cvt_pk_bf16_f32 v114, v116, v117
    v_mfma_f32_16x16x32_bf16 v[84:87], a[96:99], v[20:23], v[84:87]
    v_add_f32 v14, v14, v75
    v_cvt_pk_bf16_f32 v53, v74, v75
    v_cvt_pk_bf16_f32 v115, v118, v119
    v_mfma_f32_16x16x32_bf16 v[224:227], a[112:115], v[60:63], v[224:227]
    buffer_store_dwordx4 v[112:115], v2, s[36:39], s84 offen offset:2048 sc1
    v_sub_f32 v76, v76, v92
    v_exp_f32 v76, v76
    v_mfma_f32_16x16x32_bf16 v[228:231], a[116:119], v[60:63], v[228:231]
    v_add_f32 v14, v14, v76
    v_mul_f32 v120, v94, v120
    v_mul_f32 v121, v94, v121
    v_mul_f32 v122, v94, v122
    v_mul_f32 v123, v94, v123
    v_mfma_f32_16x16x32_bf16 v[232:235], a[120:123], v[60:63], v[232:235]
    v_sub_f32 v77, v77, v92
    v_exp_f32 v77, v77
    v_mul_f32 v124, v94, v124
    v_mul_f32 v125, v94, v125
    v_mfma_f32_16x16x32_bf16 v[236:239], a[124:127], v[60:63], v[236:239]
    v_add_f32 v14, v14, v77
    v_cvt_pk_bf16_f32 v54, v76, v77
    v_mul_f32 v126, v94, v126
    v_mul_f32 v127, v94, v127
    v_cvt_pk_bf16_f32 v120, v120, v121
    v_mfma_f32_16x16x32_bf16 v[240:243], a[128:131], v[60:63], v[240:243]
    v_sub_f32 v78, v78, v92
    v_exp_f32 v78, v78
    v_cvt_pk_bf16_f32 v121, v122, v123
    v_cvt_pk_bf16_f32 v122, v124, v125
    v_mfma_f32_16x16x32_bf16 v[244:247], a[132:135], v[60:63], v[244:247]
    v_add_f32 v14, v14, v78
    v_cvt_pk_bf16_f32 v123, v126, v127
    v_mfma_f32_16x16x32_bf16 v[248:251], a[136:139], v[60:63], v[248:251]
    buffer_store_dwordx4 v[120:123], v2, s[36:39], s84 offen offset:3072 sc1
    v_sub_f32 v79, v79, v92
    v_exp_f32 v79, v79
    v_mfma_f32_16x16x32_bf16 v[252:255], a[140:143], v[60:63], v[252:255]
    v_add_f32 v14, v14, v79
    v_cvt_pk_bf16_f32 v55, v78, v79
    v_mfma_f32_16x16x32_bf16 a[244:247], a[248:251], v[60:63], a[244:247]
    v_mfma_f32_16x16x32_bf16 v[64:67], a[144:147], v[20:23], 0
    v_accvgpr_read_b32 v92, a254
    v_sub_f32 v80, v80, v92
    v_exp_f32 v80, v80
    v_mfma_f32_16x16x32_bf16 v[64:67], a[148:151], v[24:27], v[64:67]
    v_add_f32 v15, v15, v80
    v_mfma_f32_16x16x32_bf16 v[64:67], a[152:155], v[28:31], v[64:67]
    v_sub_f32 v81, v81, v92
    v_exp_f32 v81, v81
    v_mfma_f32_16x16x32_bf16 v[64:67], a[156:159], v[32:35], v[64:67]
    v_add_f32 v15, v15, v81
    v_cvt_pk_bf16_f32 v56, v80, v81
    v_mfma_f32_16x16x32_bf16 v[68:71], a[172:175], v[32:35], 0
    v_sub_f32 v82, v82, v92
    v_exp_f32 v82, v82
    v_mov_b32 v94, v14
    v_mfma_f32_16x16x32_bf16 v[68:71], a[168:171], v[28:31], v[68:71]
    v_add_f32 v15, v15, v82
    v_accvgpr_read_b32 v91, a244
    s_cmp_eq_u32 s41, 0
    s_cbranch_scc1 L_send_his
    ds_write_b128 v3, v[224:227] offset:0
    ds_write_b128 v3, v[228:231] offset:1024
    ds_write_b128 v3, v[232:235] offset:2048
    ds_write_b128 v3, v[236:239] offset:3072
    v_mov_b32 v224, v240
    v_mov_b32 v225, v241
    v_mov_b32 v226, v242
    v_mov_b32 v227, v243
    v_mov_b32 v228, v244
    v_mov_b32 v229, v245
    v_mov_b32 v230, v246
    v_mov_b32 v231, v247
    v_mov_b32 v232, v248
    v_mov_b32 v233, v249
    v_mov_b32 v234, v250
    v_mov_b32 v235, v251
    v_mov_b32 v236, v252
    v_mov_b32 v237, v253
    v_mov_b32 v238, v254
    v_mov_b32 v239, v255
    s_branch L_sents
L_send_his:
    ds_write_b128 v3, v[240:243] offset:0
    ds_write_b128 v3, v[244:247] offset:1024
    ds_write_b128 v3, v[248:251] offset:2048
    ds_write_b128 v3, v[252:255] offset:3072
L_sents:
    v_mfma_f32_16x16x32_bf16 v[68:71], a[164:167], v[24:27], v[68:71]
    ds_write_b32 v6, v91
    v_sub_f32 v83, v83, v92
    v_exp_f32 v83, v83
    v_permlane32_swap_b32 v94, v14
    v_mfma_f32_16x16x32_bf16 v[68:71], a[160:163], v[20:23], v[68:71]
    v_add_f32 v15, v15, v83
    v_cvt_pk_bf16_f32 v57, v82, v83
    v_add_f32 v14, v14, v94
    v_mov_b32 v94, v14
    v_mfma_f32_16x16x32_bf16 v[128:131], a[112:115], v[16:19], v[128:131]
    v_sub_f32 v84, v84, v92
    v_exp_f32 v84, v84
    v_mfma_f32_16x16x32_bf16 v[128:131], a[176:179], v[52:55], v[128:131]
    v_add_f32 v15, v15, v84
    v_permlane16_swap_b32 v94, v14
    v_add_f32 v14, v14, v94
    v_rcp_f32 v94, v14
    v_mfma_f32_16x16x32_bf16 v[132:135], a[180:183], v[52:55], v[132:135]
    v_sub_f32 v85, v85, v92
    v_exp_f32 v85, v85
    v_mfma_f32_16x16x32_bf16 v[132:135], a[116:119], v[16:19], v[132:135]
    v_add_f32 v15, v15, v85
    v_cvt_pk_bf16_f32 v58, v84, v85
    v_mfma_f32_16x16x32_bf16 v[136:139], a[120:123], v[16:19], v[136:139]
    v_sub_f32 v86, v86, v92
    v_exp_f32 v86, v86
    v_mfma_f32_16x16x32_bf16 v[136:139], a[184:187], v[52:55], v[136:139]
    v_add_f32 v15, v15, v86
    v_mfma_f32_16x16x32_bf16 v[140:143], a[188:191], v[52:55], v[140:143]
    v_sub_f32 v87, v87, v92
    v_exp_f32 v87, v87
    v_mfma_f32_16x16x32_bf16 v[140:143], a[124:127], v[16:19], v[140:143]
    v_add_f32 v15, v15, v87
    v_cvt_pk_bf16_f32 v59, v86, v87
    s_waitcnt lgkmcnt(0)
    s_barrier
    v_mfma_f32_16x16x32_bf16 v[72:75], a[80:83], v[36:39], 0
    ds_read_b32 v95, v7
    v_accvgpr_read_b32 v92, a254
    v_sub_f32 v64, v64, v92
    v_exp_f32 v64, v64
    v_mfma_f32_16x16x32_bf16 v[72:75], a[84:87], v[40:43], v[72:75]
    s_xor_b32 s45, s52, 327680
    v_add_f32 v15, v15, v64
    v_mul_f32 v128, v94, v128
    v_mul_f32 v129, v94, v129
    v_mul_f32 v130, v94, v130
    v_mul_f32 v131, v94, v131
    v_mfma_f32_16x16x32_bf16 v[72:75], a[88:91], v[44:47], v[72:75]
    s_add_u32 m0, s60, 0
    ds_read_b128 v[240:243], v4 offset:0
    v_sub_f32 v65, v65, v92
    v_exp_f32 v65, v65
    v_mul_f32 v132, v94, v132
    v_mfma_f32_16x16x32_bf16 v[72:75], a[92:95], v[48:51], v[72:75]
    buffer_load_dwordx4 v90, s[80:83], s45 offen offset:0 lds
    v_mul_f32 v133, v94, v133
    v_mul_f32 v134, v94, v134
    v_mul_f32 v135, v94, v135
    v_mfma_f32_16x16x32_bf16 v[76:79], a[108:111], v[48:51], 0
    ds_read_b128 v[244:247], v4 offset:1024
    v_sub_f32 v66, v66, v92
    v_exp_f32 v66, v66
    v_cvt_pk_bf16_f32 v128, v128, v129
    v_mfma_f32_16x16x32_bf16 v[76:79], a[104:107], v[44:47], v[76:79]
    v_add_f32 v15, v15, v66
    v_add_f32 v15, v15, v65
    v_cvt_pk_bf16_f32 v129, v130, v131
    v_cvt_pk_bf16_f32 v130, v132, v133
    v_cvt_pk_bf16_f32 v131, v134, v135
    v_mfma_f32_16x16x32_bf16 v[76:79], a[100:103], v[40:43], v[76:79]
    ds_read_b128 v[248:251], v4 offset:2048
    v_sub_f32 v67, v67, v92
    v_exp_f32 v67, v67
    v_mfma_f32_16x16x32_bf16 v[76:79], a[96:99], v[36:39], v[76:79]
    buffer_store_dwordx4 v[128:131], v2, s[36:39], s85 offen offset:0 sc1
    v_add_f32 v15, v15, v67
    v_cvt_pk_bf16_f32 v61, v66, v67
    v_mul_f32 v136, v94, v136
    v_mfma_f32_16x16x32_bf16 v[144:147], a[128:131], v[16:19], v[144:147]
    ds_read_b128 v[252:255], v4 offset:3072
    v_sub_f32 v68, v68, v92
    v_exp_f32 v68, v68
    v_mul_f32 v137, v94, v137
    v_mfma_f32_16x16x32_bf16 v[144:147], a[192:195], v[52:55], v[144:147]
    v_add_f32 v15, v15, v68
    v_cvt_pk_bf16_f32 v60, v64, v65
    v_mul_f32 v138, v94, v138
    v_mul_f32 v139, v94, v139
    v_mul_f32 v140, v94, v140
    v_mfma_f32_16x16x32_bf16 v[148:151], a[196:199], v[52:55], v[148:151]
    s_add_u32 m0, s60, 32
    v_sub_f32 v69, v69, v92
    v_exp_f32 v69, v69
    v_mul_f32 v141, v94, v141
    v_mul_f32 v142, v94, v142
    v_mfma_f32_16x16x32_bf16 v[148:151], a[132:135], v[16:19], v[148:151]
    buffer_load_dwordx4 v90, s[80:83], s45 offen offset:1024 lds
    v_mul_f32 v143, v94, v143
    v_cvt_pk_bf16_f32 v136, v136, v137
    v_cvt_pk_bf16_f32 v137, v138, v139
    v_mfma_f32_16x16x32_bf16 v[152:155], a[136:139], v[16:19], v[152:155]
    v_sub_f32 v70, v70, v92
    v_exp_f32 v70, v70
    v_cvt_pk_bf16_f32 v138, v140, v141
    v_cvt_pk_bf16_f32 v139, v142, v143
    v_mfma_f32_16x16x32_bf16 v[152:155], a[200:203], v[52:55], v[152:155]
    buffer_store_dwordx4 v[136:139], v2, s[36:39], s85 offen offset:1024 sc1
    v_add_f32 v15, v15, v70
    v_add_f32 v15, v15, v69
    v_mfma_f32_16x16x32_bf16 v[156:159], a[204:207], v[52:55], v[156:159]
    v_sub_f32 v71, v71, v92
    v_exp_f32 v71, v71
    v_mfma_f32_16x16x32_bf16 v[156:159], a[140:143], v[16:19], v[156:159]
    v_add_f32 v15, v15, v71
    v_cvt_pk_bf16_f32 v63, v70, v71
    v_mfma_f32_16x16x32_bf16 v[80:83], a[144:147], v[36:39], 0
    v_accvgpr_read_b32 v92, a255
    v_sub_f32 v72, v72, v92
    v_exp_f32 v72, v72
    v_mul_f32 v144, v94, v144
    v_mfma_f32_16x16x32_bf16 v[80:83], a[148:151], v[40:43], v[80:83]
    v_cvt_pk_bf16_f32 v62, v68, v69
    v_add_f32 v89, v89, v72
    v_mul_f32 v145, v94, v145
    v_mul_f32 v146, v94, v146
    v_mul_f32 v147, v94, v147
    v_mfma_f32_16x16x32_bf16 v[80:83], a[152:155], v[44:47], v[80:83]
    s_add_u32 m0, s60, 64
    v_sub_f32 v73, v73, v92
    v_exp_f32 v73, v73
    v_mul_f32 v148, v94, v148
    v_mul_f32 v149, v94, v149
    v_mfma_f32_16x16x32_bf16 v[80:83], a[156:159], v[48:51], v[80:83]
    buffer_load_dwordx4 v90, s[80:83], s45 offen offset:2048 lds
    v_mul_f32 v150, v94, v150
    v_mul_f32 v151, v94, v151
    v_cvt_pk_bf16_f32 v144, v144, v145
    v_mfma_f32_16x16x32_bf16 v[84:87], a[172:175], v[48:51], 0
    v_sub_f32 v74, v74, v92
    v_exp_f32 v74, v74
    v_cvt_pk_bf16_f32 v145, v146, v147
    v_cvt_pk_bf16_f32 v146, v148, v149
    v_mfma_f32_16x16x32_bf16 v[84:87], a[168:171], v[44:47], v[84:87]
    v_add_f32 v89, v89, v74
    v_add_f32 v89, v89, v73
    v_cvt_pk_bf16_f32 v147, v150, v151
    v_mfma_f32_16x16x32_bf16 v[84:87], a[164:167], v[40:43], v[84:87]
    buffer_store_dwordx4 v[144:147], v2, s[36:39], s85 offen offset:2048 sc1
    v_sub_f32 v75, v75, v92
    v_exp_f32 v75, v75
    v_mfma_f32_16x16x32_bf16 v[84:87], a[160:163], v[36:39], v[84:87]
    v_add_f32 v89, v89, v75
    v_cvt_pk_bf16_f32 v17, v74, v75
    v_mul_f32 v152, v94, v152
    v_mul_f32 v153, v94, v153
    v_mul_f32 v154, v94, v154
    v_mfma_f32_16x16x32_bf16 v[160:163], a[112:115], v[56:59], v[160:163]
    v_sub_f32 v76, v76, v92
    v_exp_f32 v76, v76
    v_mul_f32 v155, v94, v155
    v_mul_f32 v156, v94, v156
    v_mfma_f32_16x16x32_bf16 v[160:163], a[176:179], v[60:63], v[160:163]
    v_add_f32 v89, v89, v76
    v_cvt_pk_bf16_f32 v16, v72, v73
    v_mul_f32 v157, v94, v157
    v_mul_f32 v158, v94, v158
    v_mul_f32 v159, v94, v159
    v_mfma_f32_16x16x32_bf16 v[164:167], a[180:183], v[60:63], v[164:167]
    s_add_u32 m0, s60, 96
    v_sub_f32 v77, v77, v92
    v_exp_f32 v77, v77
    v_cvt_pk_bf16_f32 v152, v152, v153
    v_cvt_pk_bf16_f32 v153, v154, v155
    v_mfma_f32_16x16x32_bf16 v[164:167], a[116:119], v[56:59], v[164:167]
    buffer_load_dwordx4 v90, s[80:83], s45 offen offset:3072 lds
    v_cvt_pk_bf16_f32 v154, v156, v157
    v_cvt_pk_bf16_f32 v155, v158, v159
    v_mfma_f32_16x16x32_bf16 v[168:171], a[120:123], v[56:59], v[168:171]
    buffer_store_dwordx4 v[152:155], v2, s[36:39], s85 offen offset:3072 sc1
    v_sub_f32 v78, v78, v92
    v_exp_f32 v78, v78
    v_mfma_f32_16x16x32_bf16 v[168:171], a[184:187], v[60:63], v[168:171]
    s_waitcnt lgkmcnt(0)
    v_add_f32 v89, v89, v78
    v_add_f32 v89, v89, v77
    v_cvt_pk_bf16_f32 v18, v76, v77
    v_add_f32 v95, v91, v95
    v_mfma_f32_16x16x32_bf16 v[172:175], a[188:191], v[60:63], v[172:175]
    v_sub_f32 v79, v79, v92
    v_exp_f32 v79, v79
    v_rcp_f32 v95, v95
    v_mfma_f32_16x16x32_bf16 v[172:175], a[124:127], v[56:59], v[172:175]
    s_xor_b32 s45, s52, 360448
    v_add_f32 v89, v89, v79
    v_cvt_pk_bf16_f32 v19, v78, v79
    v_add_f32 v224, v224, v240
    v_add_f32 v225, v225, v241
    v_add_f32 v226, v226, v242
    s_nop 0
    s_add_u32 m0, s60, 16896
    v_accvgpr_read_b32 v92, a255
    v_sub_f32 v80, v80, v92
    v_exp_f32 v80, v80
    v_add_f32 v227, v227, v243
    s_nop 0
    buffer_load_dwordx4 v90, s[80:83], s45 offen offset:0 lds
    v_add_f32 v228, v228, v244
    v_add_f32 v229, v229, v245
    v_add_f32 v230, v230, v246
    s_nop 0
    v_sub_f32 v81, v81, v92
    v_exp_f32 v81, v81
    v_add_f32 v231, v231, v247
    v_add_f32 v232, v232, v248
    s_nop 0
    v_add_f32 v89, v89, v81
    v_cvt_pk_bf16_f32 v52, v80, v81
    v_add_f32 v89, v89, v80
    v_add_f32 v233, v233, v249
    v_add_f32 v234, v234, v250
    s_nop 0
    s_add_u32 m0, s60, 16928
    v_sub_f32 v82, v82, v92
    v_exp_f32 v82, v82
    v_add_f32 v235, v235, v251
    v_add_f32 v236, v236, v252
    s_nop 0
    buffer_load_dwordx4 v90, s[80:83], s45 offen offset:1024 lds
    v_add_f32 v237, v237, v253
    v_add_f32 v238, v238, v254
    v_add_f32 v239, v239, v255
    s_nop 0
    v_sub_f32 v83, v83, v92
    v_exp_f32 v83, v83
    v_mul_f32 v224, v95, v224
    v_mul_f32 v225, v95, v225
    s_nop 0
    v_add_f32 v89, v89, v83
    v_cvt_pk_bf16_f32 v53, v82, v83
    v_add_f32 v89, v89, v82
    v_mul_f32 v226, v95, v226
    v_mul_f32 v227, v95, v227
    v_mfma_f32_16x16x32_bf16 v[176:179], a[128:131], v[56:59], v[176:179]
    s_add_u32 m0, s60, 16960
    v_sub_f32 v84, v84, v92
    v_exp_f32 v84, v84
    v_mul_f32 v228, v95, v228
    v_mul_f32 v229, v95, v229
    v_mfma_f32_16x16x32_bf16 v[176:179], a[192:195], v[60:63], v[176:179]
    buffer_load_dwordx4 v90, s[80:83], s45 offen offset:2048 lds
    v_mul_f32 v230, v95, v230
    v_mul_f32 v231, v95, v231
    v_cvt_pk_bf16_f32 v224, v224, v225
    v_mfma_f32_16x16x32_bf16 v[180:183], a[196:199], v[60:63], v[180:183]
    v_sub_f32 v85, v85, v92
    v_exp_f32 v85, v85
    v_cvt_pk_bf16_f32 v225, v226, v227
    v_cvt_pk_bf16_f32 v226, v228, v229
    v_mfma_f32_16x16x32_bf16 v[180:183], a[132:135], v[56:59], v[180:183]
    s_add_u32 m0, s60, 16992
    v_add_f32 v89, v89, v85
    v_cvt_pk_bf16_f32 v54, v84, v85
    v_add_f32 v89, v89, v84
    v_cvt_pk_bf16_f32 v227, v230, v231
    v_mfma_f32_16x16x32_bf16 v[184:187], a[136:139], v[56:59], v[184:187]
    buffer_store_dwordx4 v[224:227], v2, s[36:39], s88 offen offset:0 sc1
    v_sub_f32 v86, v86, v92
    v_exp_f32 v86, v86
    v_mfma_f32_16x16x32_bf16 v[184:187], a[200:203], v[60:63], v[184:187]
    buffer_load_dwordx4 v90, s[80:83], s45 offen offset:3072 lds
    v_mul_f32 v232, v95, v232
    v_mul_f32 v233, v95, v233
    v_mul_f32 v234, v95, v234
    v_mfma_f32_16x16x32_bf16 v[188:191], a[204:207], v[60:63], v[188:191]
    v_sub_f32 v87, v87, v92
    v_exp_f32 v87, v87
    v_mul_f32 v235, v95, v235
    v_mul_f32 v236, v95, v236
    v_mfma_f32_16x16x32_bf16 v[188:191], a[140:143], v[56:59], v[188:191]
    v_add_f32 v89, v89, v87
    v_cvt_pk_bf16_f32 v55, v86, v87
    v_add_f32 v89, v89, v86
    v_mul_f32 v237, v95, v237
    v_mul_f32 v238, v95, v238
    s_nop 1
    v_mfma_f32_16x16x32_bf16 v[192:195], a[112:115], v[16:19], v[192:195]
    s_waitcnt vmcnt(37)
    ds_read_b64_tr_b16 a[0:1], v1 offset:50688
    v_mul_f32 v239, v95, v239
    v_cvt_pk_bf16_f32 v232, v232, v233
    v_cvt_pk_bf16_f32 v233, v234, v235
    v_cvt_pk_bf16_f32 v234, v236, v237
    v_mfma_f32_16x16x32_bf16 v[192:195], a[176:179], v[52:55], v[192:195]
    ds_read_b64_tr_b16 a[2:3], v1 offset:51200
    v_cvt_pk_bf16_f32 v235, v238, v239
    v_mfma_f32_16x16x32_bf16 v[196:199], a[180:183], v[52:55], v[196:199]
    ds_read_b64_tr_b16 a[4:5], v1 offset:50720
    buffer_store_dwordx4 v[232:235], v2, s[36:39], s88 offen offset:1024 sc1
    v_mov_b32 v94, v15
    v_mfma_f32_16x16x32_bf16 v[196:199], a[116:119], v[16:19], v[196:199]
    ds_read_b64_tr_b16 a[6:7], v1 offset:51232
    v_mfma_f32_16x16x32_bf16 v[200:203], a[120:123], v[16:19], v[200:203]
    ds_read_b64_tr_b16 a[8:9], v1 offset:50752
    v_permlane32_swap_b32 v94, v15
    v_add_f32 v15, v15, v94
    v_mov_b32 v94, v15
    v_mfma_f32_16x16x32_bf16 v[200:203], a[184:187], v[52:55], v[200:203]
    ds_read_b64_tr_b16 a[10:11], v1 offset:51264
    v_mfma_f32_16x16x32_bf16 v[204:207], a[188:191], v[52:55], v[204:207]
    ds_read_b64_tr_b16 a[12:13], v1 offset:50784
    v_permlane16_swap_b32 v94, v15
    v_add_f32 v15, v15, v94
    v_rcp_f32 v94, v15
    v_mfma_f32_16x16x32_bf16 v[204:207], a[124:127], v[16:19], v[204:207]
    ds_read_b64_tr_b16 a[14:15], v1 offset:51296
    v_mul_f32 v160, v94, v160
    v_mul_f32 v161, v94, v161
    v_mul_f32 v162, v94, v162
    v_mul_f32 v163, v94, v163
    v_mfma_f32_16x16x32_bf16 v[208:211], a[128:131], v[16:19], v[208:211]
    s_waitcnt vmcnt(34)
    ds_read_b64_tr_b16 a[64:65], v5 offset:33792
    v_mul_f32 v164, v94, v164
    v_mul_f32 v165, v94, v165
    v_mul_f32 v166, v94, v166
    v_mul_f32 v167, v94, v167
    v_mfma_f32_16x16x32_bf16 v[208:211], a[192:195], v[52:55], v[208:211]
    ds_read_b64_tr_b16 a[66:67], v5 offset:34304
    v_cvt_pk_bf16_f32 v160, v160, v161
    v_cvt_pk_bf16_f32 v161, v162, v163
    v_cvt_pk_bf16_f32 v162, v164, v165
    v_cvt_pk_bf16_f32 v163, v166, v167
    v_mfma_f32_16x16x32_bf16 v[212:215], a[196:199], v[52:55], v[212:215]
    ds_read_b64_tr_b16 a[68:69], v5 offset:33824
    buffer_store_dwordx4 v[160:163], v2, s[36:39], s86 offen offset:0 sc1
    v_mul_f32 v168, v94, v168
    v_mul_f32 v169, v94, v169
    v_mfma_f32_16x16x32_bf16 v[212:215], a[132:135], v[16:19], v[212:215]
    ds_read_b64_tr_b16 a[70:71], v5 offset:34336
    v_mul_f32 v170, v94, v170
    v_mul_f32 v171, v94, v171
    v_mul_f32 v172, v94, v172
    v_mul_f32 v173, v94, v173
    v_mfma_f32_16x16x32_bf16 v[216:219], a[136:139], v[16:19], v[216:219]
    ds_read_b64_tr_b16 a[72:73], v5 offset:33856
    v_mul_f32 v174, v94, v174
    v_mul_f32 v175, v94, v175
    v_cvt_pk_bf16_f32 v168, v168, v169
    v_cvt_pk_bf16_f32 v169, v170, v171
    v_mfma_f32_16x16x32_bf16 v[216:219], a[200:203], v[52:55], v[216:219]
    ds_read_b64_tr_b16 a[74:75], v5 offset:34368
    v_cvt_pk_bf16_f32 v170, v172, v173
    v_cvt_pk_bf16_f32 v171, v174, v175
    v_mfma_f32_16x16x32_bf16 v[220:223], a[204:207], v[52:55], v[220:223]
    ds_read_b64_tr_b16 a[76:77], v5 offset:33888
    buffer_store_dwordx4 v[168:171], v2, s[36:39], s86 offen offset:1024 sc1
    v_mul_f32 v176, v94, v176
    v_mul_f32 v177, v94, v177
    v_mfma_f32_16x16x32_bf16 v[220:223], a[140:143], v[16:19], v[220:223]
    ds_read_b64_tr_b16 a[78:79], v5 offset:34400
    v_mul_f32 v178, v94, v178
    v_mul_f32 v179, v94, v179
    v_mul_f32 v180, v94, v180
    v_mul_f32 v181, v94, v181
    s_nop 1
    v_mul_f32 v182, v94, v182
    v_mul_f32 v183, v94, v183
    v_cvt_pk_bf16_f32 v176, v176, v177
    v_cvt_pk_bf16_f32 v177, v178, v179
    v_cvt_pk_bf16_f32 v178, v180, v181
    v_cvt_pk_bf16_f32 v179, v182, v183
    buffer_store_dwordx4 v[176:179], v2, s[36:39], s86 offen offset:2048 sc1
    v_mul_f32 v184, v94, v184
    v_mul_f32 v185, v94, v185
    v_mul_f32 v186, v94, v186
    v_mul_f32 v187, v94, v187
    v_mul_f32 v188, v94, v188
    v_mul_f32 v189, v94, v189
    v_mul_f32 v190, v94, v190
    v_mul_f32 v191, v94, v191
    v_cvt_pk_bf16_f32 v184, v184, v185
    v_cvt_pk_bf16_f32 v185, v186, v187
    v_cvt_pk_bf16_f32 v186, v188, v189
    v_cvt_pk_bf16_f32 v187, v190, v191
    buffer_store_dwordx4 v[184:187], v2, s[36:39], s86 offen offset:3072 sc1
    v_mov_b32 v94, v89
    s_nop 1
    v_permlane32_swap_b32 v94, v89
    v_add_f32 v89, v89, v94
    v_mov_b32 v94, v89
    s_nop 1
    v_permlane16_swap_b32 v94, v89
    v_add_f32 v89, v89, v94
    s_waitcnt vmcnt(0)
    s_branch L_tail

.section .rodata,"a"
.p2align 6
.amdhsa_kernel standalone__mha_block_cached__near_ridge_kernel
  .amdhsa_next_free_vgpr 512
  .amdhsa_next_free_sgpr 102
  .amdhsa_accum_offset 256
  .amdhsa_group_segment_fixed_size 0
  .amdhsa_kernarg_size 64
  .amdhsa_user_sgpr_count 2
  .amdhsa_user_sgpr_kernarg_segment_ptr 1
  .amdhsa_system_sgpr_workgroup_id_x 1
.end_amdhsa_kernel
```
